```python
import torch

def _softmax(x, axis=-1):
    return torch.softmax(x, dim=axis)
def _gelu(x):
    return torch.nn.functional.gelu(x, approximate="tanh")
def _silu(x):
    return torch.nn.functional.silu(x)
def _sigmoid(x):
    return torch.sigmoid(x)
def _layernorm(x, axis=-1, eps=1e-5):
    m = x.mean(dim=axis, keepdim=True)
    v = x.var(dim=axis, keepdim=True, unbiased=False)
    return (x - m) / torch.sqrt(v + eps)
def _scatter_add(tgt, idx, src, axis=0):
    return tgt.clone().index_add_(axis, idx, src)
def _segment_sum(src, seg, n):
    out = torch.zeros((n,) + src.shape[1:], dtype=src.dtype)
    return out.index_add_(0, seg, src)
def _pad(x, pw):
    flat = tuple(v for pair in reversed(pw) for v in pair)
    return torch.nn.functional.pad(x, flat)

kernel_name = 'sequential_preLN__grouped_kv_mqa__mixer_s_mlp__prompt'

def setup_inputs():

    _w = (lambda a: (lambda t: t.to(torch.bfloat16) if t.is_floating_point() else t)(torch.as_tensor(a)))
    def _A_setup():
        B, S, D, H = 1, 2048, 640, 32
        Dh = D // H
        return {
            "x": _w((lambda *s: torch.randn(*s, dtype=torch.bfloat16) * 0.05)(B, S, D)),
            "wq": _w((lambda *s: torch.randn(*s, dtype=torch.bfloat16) * 0.05)(D, H * Dh)),
            "wk": _w((lambda *s: torch.randn(*s, dtype=torch.bfloat16) * 0.05)(D, Dh)),
            "wv": _w((lambda *s: torch.randn(*s, dtype=torch.bfloat16) * 0.05)(D, Dh)),
            "wo": _w((lambda *s: torch.randn(*s, dtype=torch.bfloat16) * 0.05)(H * Dh, D)),
        }
    _A_in = _A_setup()

    def _B_setup():
        B, S, D, F = 1, 2048, 640, 1728
        return {
            "x":  _w((lambda *s: torch.randn(*s, dtype=torch.bfloat16) * 0.05)(B, S, D)),
            "w1": _w((lambda *s: torch.randn(*s, dtype=torch.bfloat16) * 3.2)(D, D) * (D ** -0.5)),
            "w2": _w((lambda *s: torch.randn(*s, dtype=torch.bfloat16) * 3.2)(D, D) * (D ** -0.5)),
            "w3": _w((lambda *s: torch.randn(*s, dtype=torch.bfloat16) * 3.2)(D, F) * (D ** -0.5)),
            "w4": _w((lambda *s: torch.randn(*s, dtype=torch.bfloat16) * 3.2)(F, D) * (F ** -0.5)),
        }
    _B_in = _B_setup()

    return {
        "A_x": _A_in["x"],
        "A_wq": _A_in["wq"],
        "A_wk": _A_in["wk"],
        "A_wv": _A_in["wv"],
        "A_wo": _A_in["wo"],
        "B_x": _B_in["x"],
        "B_w1": _B_in["w1"],
        "B_w2": _B_in["w2"],
        "B_w3": _B_in["w3"],
        "B_w4": _B_in["w4"],
    }

def reference(A_x, A_wq, A_wk, A_wv, A_wo, B_x, B_w1, B_w2, B_w3, B_w4):
    def _A_ref(x, wq, wk, wv, wo):
        B, S, D = x.shape
        H = 32
        Dh = D // H
        q = (lambda x, *d: x.permute(*d))((x @ wq).reshape(B, S, H, Dh), 0, 2, 1, 3)
        k = x @ wk
        v = x @ wv
        scores = torch.einsum("bhqd,bkd->bhqk", q, k) * (Dh ** -0.5)
        p = _softmax(scores, axis=-1)
        o = torch.einsum("bhqk,bkd->bhqd", p, v)
        return (lambda x, *d: x.permute(*d))(o, 0, 2, 1, 3).reshape(B, S, H * Dh) @ wo

    def _B_ref(x, w1, w2, w3, w4):
        B, S, D = x.shape
        h = _gelu(_layernorm(x, axis=-1) @ w1)
        c = D // 4
        g0 = _pad(h[:, :, 0*c:1*c], ((0, 0), (1, 0), (0, 0)))[:, :S, :]
        g1 = _pad(h[:, :, 1*c:2*c], ((0, 0), (0, 1), (0, 0)))[:, 1:, :]
        g2 = _pad(h[:, :, 2*c:3*c], ((0, 0), (2, 0), (0, 0)))[:, :S, :]
        g3 = _pad(h[:, :, 3*c:   ], ((0, 0), (0, 2), (0, 0)))[:, 2:, :]
        hs = torch.concatenate([g0, g1, g2, g3], axis=-1) @ w2
        x1 = x + hs
        h2 = _gelu(_layernorm(x1, axis=-1) @ w3) @ w4
        return x1 + h2

    x = A_x
    h = x + _A_ref(_layernorm(x, axis=-1), A_wq, A_wk, A_wv, A_wo)
    h2 = h + _B_ref(_layernorm(h, axis=-1), B_w1, B_w2, B_w3, B_w4)
    return h2
```

```asm
; @launch kernel=k1_qkv_kernel grid=(288,1,1) block=(256,1,1) lds=81920
; @launch kernel=k2_attn_kernel grid=(256,1,1) block=(256,1,1) lds=0
; @launch kernel=k3_wo_kernel grid=(256,1,1) block=(256,1,1) lds=53760
; @launch kernel=k4_w1_kernel grid=(256,1,1) block=(256,1,1) lds=53760
; @launch kernel=k5_w2_kernel grid=(256,1,1) block=(256,1,1) lds=53760
; @launch kernel=k6_w3_kernel grid=(192,1,1) block=(512,1,1) lds=96768
; @launch kernel=k7_w4_kernel grid=(256,1,1) block=(256,1,1) lds=92160
.amdgcn_target "amdgcn-amd-amdhsa--gfx950"
.text
.globl k1_qkv_kernel
.p2align 8
.type k1_qkv_kernel,@function
k1_qkv_kernel:
    s_cmp_ge_u32 s2, 288
    s_cbranch_scc1 L_END_k1_qkv_kernel
    s_load_dwordx16 s[36:51], s[0:1], 0
    s_load_dwordx8 s[52:59], s[0:1], 64
    s_load_dwordx2 s[60:61], s[0:1], 96
    s_and_b32 s3, s2, 31
    s_lshr_b32 s4, s2, 5
    s_waitcnt lgkmcnt(0)
    s_cmp_eq_u32 s4, 8
    s_cbranch_scc1 L_k1_qkv_kernel_extra
    s_mov_b32 s8, s36
    s_mov_b32 s9, s37
    s_mov_b32 s10, 0x280000
    s_mov_b32 s11, 0x00020000
    s_mov_b32 s12, s38
    s_mov_b32 s13, s39
    s_mov_b32 s14, 0xc8000
    s_mov_b32 s15, 0x00020000
    s_mov_b32 s16, s60
    s_mov_b32 s17, s61
    s_mov_b32 s18, 0x280000
    s_mov_b32 s19, 0x00020000
    v_and_b32 v1, 15, v0
    v_bfe_u32 v2, v0, 4, 2
    v_lshrrev_b32 v3, 6, v0
    v_lshlrev_b32 v3, 4, v3
    v_add_u32 v3, v3, v1
    s_mul_i32 s5, s3, 64
    v_add_u32 v3, s5, v3
    v_mov_b32 v10, v3
    v_and_b32 v4, 63, v0
    v_xor_b32 v17, 32, v4
    v_lshlrev_b32 v17, 2, v17
    s_mov_b32 s6, 1280
    v_lshlrev_b32 v5, 4, v2
    v_mov_b32 v4, v3
    v_mul_lo_u32 v4, v4, s6
    v_add_u32 v18, v4, v5
    v_mov_b32 v28, 0
    v_mov_b32 v29, 0
    v_mov_b32 v30, 0
    v_mov_b32 v31, 0
    v_mov_b32 v32, 0
    v_mov_b32 v33, 0
    v_mov_b32 v34, 0
    v_mov_b32 v35, 0
    v_mov_b32 v36, 0
    v_mov_b32 v37, 0
    v_mov_b32 v38, 0
    v_mov_b32 v39, 0
    v_mov_b32 v40, 0
    v_mov_b32 v41, 0
    v_mov_b32 v42, 0
    v_mov_b32 v43, 0
    v_mov_b32 v44, 0
    v_mov_b32 v45, 0
    v_mov_b32 v46, 0
    v_mov_b32 v47, 0
    v_lshrrev_b32 v4, 2, v1
    v_lshl_add_u32 v4, v2, 3, v4
    s_mov_b32 s7, 160
    v_mul_lo_u32 v4, v4, s7
    v_and_b32 v5, 3, v1
    v_lshl_add_u32 v23, v5, 3, v4
    s_mul_i32 s4, s4, 160
    v_and_b32 v4, 63, v0
    v_mul_u32_u24 v5, 6554, v4
    v_lshrrev_b32 v5, 16, v5
    v_mul_u32_u24 v6, 10, v5
    v_sub_u32 v6, v4, v6
    s_mov_b32 s66, 1280
    v_mul_lo_u32 v5, v5, s66
    v_lshl_add_u32 v25, v6, 4, v5
    v_lshrrev_b32 v4, 6, v0
    s_nop 1
    v_readfirstlane_b32 s64, v4
    s_nop 3
    s_mul_i32 s65, s64, 960
    s_mul_i32 s67, s64, 7680
    s_add_u32 s67, s67, s4
    buffer_load_dwordx4 v[136:139], v18, s[8:11], 0 offen offset:0
    buffer_load_dwordx4 v[140:143], v18, s[8:11], 0 offen offset:64
    buffer_load_dwordx4 v[144:147], v18, s[8:11], 0 offen offset:128
    buffer_load_dwordx4 v[148:151], v18, s[8:11], 0 offen offset:192
    buffer_load_dwordx4 v[152:155], v18, s[8:11], 0 offen offset:256
    buffer_load_dwordx4 v[156:159], v18, s[8:11], 0 offen offset:320
    buffer_load_dwordx4 v[160:163], v18, s[8:11], 0 offen offset:384
    buffer_load_dwordx4 v[164:167], v18, s[8:11], 0 offen offset:448
    buffer_load_dwordx4 v[168:171], v18, s[8:11], 0 offen offset:512
    buffer_load_dwordx4 v[172:175], v18, s[8:11], 0 offen offset:576
    buffer_load_dwordx4 v[176:179], v18, s[8:11], 0 offen offset:640
    buffer_load_dwordx4 v[180:183], v18, s[8:11], 0 offen offset:704
    buffer_load_dwordx4 v[184:187], v18, s[8:11], 0 offen offset:768
    buffer_load_dwordx4 v[188:191], v18, s[8:11], 0 offen offset:832
    buffer_load_dwordx4 v[192:195], v18, s[8:11], 0 offen offset:896
    buffer_load_dwordx4 v[196:199], v18, s[8:11], 0 offen offset:960
    buffer_load_dwordx4 v[200:203], v18, s[8:11], 0 offen offset:1024
    buffer_load_dwordx4 v[204:207], v18, s[8:11], 0 offen offset:1088
    buffer_load_dwordx4 v[208:211], v18, s[8:11], 0 offen offset:1152
    buffer_load_dwordx4 v[212:215], v18, s[8:11], 0 offen offset:1216
    s_mov_b32 s6, 1280
    v_mul_lo_u32 v24, v10, s6
    v_lshl_add_u32 v24, v2, 3, v24
    v_add_u32 v24, s4, v24
    s_mov_b64 s[68:69], exec
    s_mov_b32 exec_hi, 0xfffffff
    s_add_u32 m0, s65, 0
    s_add_u32 s70, s67, 0
    buffer_load_dwordx4 v25, s[12:15], s70 offen lds
    s_add_u32 m0, s65, 3840
    s_add_u32 s70, s67, 30720
    buffer_load_dwordx4 v25, s[12:15], s70 offen lds
    s_add_u32 m0, s65, 7680
    s_add_u32 s70, s67, 61440
    buffer_load_dwordx4 v25, s[12:15], s70 offen lds
    s_add_u32 m0, s65, 11520
    s_add_u32 s70, s67, 92160
    buffer_load_dwordx4 v25, s[12:15], s70 offen lds
    s_add_u32 m0, s65, 15360
    s_add_u32 s70, s67, 122880
    buffer_load_dwordx4 v25, s[12:15], s70 offen lds
    s_add_u32 m0, s65, 19200
    s_add_u32 s70, s67, 153600
    buffer_load_dwordx4 v25, s[12:15], s70 offen lds
    s_add_u32 m0, s65, 23040
    s_add_u32 s70, s67, 184320
    buffer_load_dwordx4 v25, s[12:15], s70 offen lds
    s_mov_b64 exec, s[68:69]
    s_waitcnt vmcnt(7)
    v_mov_b32 v11, 0
    v_mov_b32 v12, 0
    v_mov_b32 v15, 0x3f803f80
    s_nop 0
    v_dot2c_f32_bf16 v11, v136, v15
    v_dot2c_f32_bf16 v12, v136, v136
    v_dot2c_f32_bf16 v11, v137, v15
    v_dot2c_f32_bf16 v12, v137, v137
    v_dot2c_f32_bf16 v11, v138, v15
    v_dot2c_f32_bf16 v12, v138, v138
    v_dot2c_f32_bf16 v11, v139, v15
    v_dot2c_f32_bf16 v12, v139, v139
    v_dot2c_f32_bf16 v11, v140, v15
    v_dot2c_f32_bf16 v12, v140, v140
    v_dot2c_f32_bf16 v11, v141, v15
    v_dot2c_f32_bf16 v12, v141, v141
    v_dot2c_f32_bf16 v11, v142, v15
    v_dot2c_f32_bf16 v12, v142, v142
    v_dot2c_f32_bf16 v11, v143, v15
    v_dot2c_f32_bf16 v12, v143, v143
    v_dot2c_f32_bf16 v11, v144, v15
    v_dot2c_f32_bf16 v12, v144, v144
    v_dot2c_f32_bf16 v11, v145, v15
    v_dot2c_f32_bf16 v12, v145, v145
    v_dot2c_f32_bf16 v11, v146, v15
    v_dot2c_f32_bf16 v12, v146, v146
    v_dot2c_f32_bf16 v11, v147, v15
    v_dot2c_f32_bf16 v12, v147, v147
    v_dot2c_f32_bf16 v11, v148, v15
    v_dot2c_f32_bf16 v12, v148, v148
    v_dot2c_f32_bf16 v11, v149, v15
    v_dot2c_f32_bf16 v12, v149, v149
    v_dot2c_f32_bf16 v11, v150, v15
    v_dot2c_f32_bf16 v12, v150, v150
    v_dot2c_f32_bf16 v11, v151, v15
    v_dot2c_f32_bf16 v12, v151, v151
    v_dot2c_f32_bf16 v11, v152, v15
    v_dot2c_f32_bf16 v12, v152, v152
    v_dot2c_f32_bf16 v11, v153, v15
    v_dot2c_f32_bf16 v12, v153, v153
    v_dot2c_f32_bf16 v11, v154, v15
    v_dot2c_f32_bf16 v12, v154, v154
    v_dot2c_f32_bf16 v11, v155, v15
    v_dot2c_f32_bf16 v12, v155, v155
    v_dot2c_f32_bf16 v11, v156, v15
    v_dot2c_f32_bf16 v12, v156, v156
    v_dot2c_f32_bf16 v11, v157, v15
    v_dot2c_f32_bf16 v12, v157, v157
    v_dot2c_f32_bf16 v11, v158, v15
    v_dot2c_f32_bf16 v12, v158, v158
    v_dot2c_f32_bf16 v11, v159, v15
    v_dot2c_f32_bf16 v12, v159, v159
    v_dot2c_f32_bf16 v11, v160, v15
    v_dot2c_f32_bf16 v12, v160, v160
    v_dot2c_f32_bf16 v11, v161, v15
    v_dot2c_f32_bf16 v12, v161, v161
    v_dot2c_f32_bf16 v11, v162, v15
    v_dot2c_f32_bf16 v12, v162, v162
    v_dot2c_f32_bf16 v11, v163, v15
    v_dot2c_f32_bf16 v12, v163, v163
    v_dot2c_f32_bf16 v11, v164, v15
    v_dot2c_f32_bf16 v12, v164, v164
    v_dot2c_f32_bf16 v11, v165, v15
    v_dot2c_f32_bf16 v12, v165, v165
    v_dot2c_f32_bf16 v11, v166, v15
    v_dot2c_f32_bf16 v12, v166, v166
    v_dot2c_f32_bf16 v11, v167, v15
    v_dot2c_f32_bf16 v12, v167, v167
    v_dot2c_f32_bf16 v11, v168, v15
    v_dot2c_f32_bf16 v12, v168, v168
    v_dot2c_f32_bf16 v11, v169, v15
    v_dot2c_f32_bf16 v12, v169, v169
    v_dot2c_f32_bf16 v11, v170, v15
    v_dot2c_f32_bf16 v12, v170, v170
    v_dot2c_f32_bf16 v11, v171, v15
    v_dot2c_f32_bf16 v12, v171, v171
    v_dot2c_f32_bf16 v11, v172, v15
    v_dot2c_f32_bf16 v12, v172, v172
    v_dot2c_f32_bf16 v11, v173, v15
    v_dot2c_f32_bf16 v12, v173, v173
    v_dot2c_f32_bf16 v11, v174, v15
    v_dot2c_f32_bf16 v12, v174, v174
    v_dot2c_f32_bf16 v11, v175, v15
    v_dot2c_f32_bf16 v12, v175, v175
    v_dot2c_f32_bf16 v11, v176, v15
    v_dot2c_f32_bf16 v12, v176, v176
    v_dot2c_f32_bf16 v11, v177, v15
    v_dot2c_f32_bf16 v12, v177, v177
    v_dot2c_f32_bf16 v11, v178, v15
    v_dot2c_f32_bf16 v12, v178, v178
    v_dot2c_f32_bf16 v11, v179, v15
    v_dot2c_f32_bf16 v12, v179, v179
    v_dot2c_f32_bf16 v11, v180, v15
    v_dot2c_f32_bf16 v12, v180, v180
    v_dot2c_f32_bf16 v11, v181, v15
    v_dot2c_f32_bf16 v12, v181, v181
    v_dot2c_f32_bf16 v11, v182, v15
    v_dot2c_f32_bf16 v12, v182, v182
    v_dot2c_f32_bf16 v11, v183, v15
    v_dot2c_f32_bf16 v12, v183, v183
    v_dot2c_f32_bf16 v11, v184, v15
    v_dot2c_f32_bf16 v12, v184, v184
    v_dot2c_f32_bf16 v11, v185, v15
    v_dot2c_f32_bf16 v12, v185, v185
    v_dot2c_f32_bf16 v11, v186, v15
    v_dot2c_f32_bf16 v12, v186, v186
    v_dot2c_f32_bf16 v11, v187, v15
    v_dot2c_f32_bf16 v12, v187, v187
    v_dot2c_f32_bf16 v11, v188, v15
    v_dot2c_f32_bf16 v12, v188, v188
    v_dot2c_f32_bf16 v11, v189, v15
    v_dot2c_f32_bf16 v12, v189, v189
    v_dot2c_f32_bf16 v11, v190, v15
    v_dot2c_f32_bf16 v12, v190, v190
    v_dot2c_f32_bf16 v11, v191, v15
    v_dot2c_f32_bf16 v12, v191, v191
    v_dot2c_f32_bf16 v11, v192, v15
    v_dot2c_f32_bf16 v12, v192, v192
    v_dot2c_f32_bf16 v11, v193, v15
    v_dot2c_f32_bf16 v12, v193, v193
    v_dot2c_f32_bf16 v11, v194, v15
    v_dot2c_f32_bf16 v12, v194, v194
    v_dot2c_f32_bf16 v11, v195, v15
    v_dot2c_f32_bf16 v12, v195, v195
    v_dot2c_f32_bf16 v11, v196, v15
    v_dot2c_f32_bf16 v12, v196, v196
    v_dot2c_f32_bf16 v11, v197, v15
    v_dot2c_f32_bf16 v12, v197, v197
    v_dot2c_f32_bf16 v11, v198, v15
    v_dot2c_f32_bf16 v12, v198, v198
    v_dot2c_f32_bf16 v11, v199, v15
    v_dot2c_f32_bf16 v12, v199, v199
    v_dot2c_f32_bf16 v11, v200, v15
    v_dot2c_f32_bf16 v12, v200, v200
    v_dot2c_f32_bf16 v11, v201, v15
    v_dot2c_f32_bf16 v12, v201, v201
    v_dot2c_f32_bf16 v11, v202, v15
    v_dot2c_f32_bf16 v12, v202, v202
    v_dot2c_f32_bf16 v11, v203, v15
    v_dot2c_f32_bf16 v12, v203, v203
    v_dot2c_f32_bf16 v11, v204, v15
    v_dot2c_f32_bf16 v12, v204, v204
    v_dot2c_f32_bf16 v11, v205, v15
    v_dot2c_f32_bf16 v12, v205, v205
    v_dot2c_f32_bf16 v11, v206, v15
    v_dot2c_f32_bf16 v12, v206, v206
    v_dot2c_f32_bf16 v11, v207, v15
    v_dot2c_f32_bf16 v12, v207, v207
    v_dot2c_f32_bf16 v11, v208, v15
    v_dot2c_f32_bf16 v12, v208, v208
    v_dot2c_f32_bf16 v11, v209, v15
    v_dot2c_f32_bf16 v12, v209, v209
    v_dot2c_f32_bf16 v11, v210, v15
    v_dot2c_f32_bf16 v12, v210, v210
    v_dot2c_f32_bf16 v11, v211, v15
    v_dot2c_f32_bf16 v12, v211, v211
    v_dot2c_f32_bf16 v11, v212, v15
    v_dot2c_f32_bf16 v12, v212, v212
    v_dot2c_f32_bf16 v11, v213, v15
    v_dot2c_f32_bf16 v12, v213, v213
    v_dot2c_f32_bf16 v11, v214, v15
    v_dot2c_f32_bf16 v12, v214, v214
    v_dot2c_f32_bf16 v11, v215, v15
    v_dot2c_f32_bf16 v12, v215, v215
    s_nop 3
    ds_swizzle_b32 v3, v11 offset:0x401F
    s_waitcnt lgkmcnt(0)
    v_add_f32 v11, v11, v3
    s_nop 0
    ds_bpermute_b32 v3, v17, v11
    s_waitcnt lgkmcnt(0)
    v_add_f32 v11, v11, v3
    ds_swizzle_b32 v3, v12 offset:0x401F
    s_waitcnt lgkmcnt(0)
    v_add_f32 v12, v12, v3
    s_nop 0
    ds_bpermute_b32 v3, v17, v12
    s_waitcnt lgkmcnt(0)
    v_add_f32 v12, v12, v3
    v_mul_f32 v11, 0x3acccccd, v11
    v_mul_f32 v12, 0x3acccccd, v12
    v_fma_f32 v12, -v11, v11, v12
    v_max_f32 v12, 0, v12
    v_add_f32 v12, 0x3727c5ac, v12
    v_rsq_f32 v13, v12
    s_nop 0
    v_mul_f32 v14, v11, v13
    v_sub_f32 v14, 0, v14
    v_lshlrev_b32 v3, 16, v136
    v_and_b32 v4, 0xffff0000, v136
    v_fma_f32 v3, v3, v13, v14
    v_fma_f32 v4, v4, v13, v14
    v_cvt_pk_bf16_f32 v136, v3, v4
    v_lshlrev_b32 v5, 16, v137
    v_and_b32 v6, 0xffff0000, v137
    v_fma_f32 v5, v5, v13, v14
    v_fma_f32 v6, v6, v13, v14
    v_cvt_pk_bf16_f32 v137, v5, v6
    v_lshlrev_b32 v3, 16, v138
    v_and_b32 v4, 0xffff0000, v138
    v_fma_f32 v3, v3, v13, v14
    v_fma_f32 v4, v4, v13, v14
    v_cvt_pk_bf16_f32 v138, v3, v4
    v_lshlrev_b32 v5, 16, v139
    v_and_b32 v6, 0xffff0000, v139
    v_fma_f32 v5, v5, v13, v14
    v_fma_f32 v6, v6, v13, v14
    v_cvt_pk_bf16_f32 v139, v5, v6
    v_lshlrev_b32 v3, 16, v140
    v_and_b32 v4, 0xffff0000, v140
    v_fma_f32 v3, v3, v13, v14
    v_fma_f32 v4, v4, v13, v14
    v_cvt_pk_bf16_f32 v140, v3, v4
    v_lshlrev_b32 v5, 16, v141
    v_and_b32 v6, 0xffff0000, v141
    v_fma_f32 v5, v5, v13, v14
    v_fma_f32 v6, v6, v13, v14
    v_cvt_pk_bf16_f32 v141, v5, v6
    v_lshlrev_b32 v3, 16, v142
    v_and_b32 v4, 0xffff0000, v142
    v_fma_f32 v3, v3, v13, v14
    v_fma_f32 v4, v4, v13, v14
    v_cvt_pk_bf16_f32 v142, v3, v4
    v_lshlrev_b32 v5, 16, v143
    v_and_b32 v6, 0xffff0000, v143
    v_fma_f32 v5, v5, v13, v14
    v_fma_f32 v6, v6, v13, v14
    v_cvt_pk_bf16_f32 v143, v5, v6
    v_lshlrev_b32 v3, 16, v144
    v_and_b32 v4, 0xffff0000, v144
    v_fma_f32 v3, v3, v13, v14
    v_fma_f32 v4, v4, v13, v14
    v_cvt_pk_bf16_f32 v144, v3, v4
    v_lshlrev_b32 v5, 16, v145
    v_and_b32 v6, 0xffff0000, v145
    v_fma_f32 v5, v5, v13, v14
    v_fma_f32 v6, v6, v13, v14
    v_cvt_pk_bf16_f32 v145, v5, v6
    v_lshlrev_b32 v3, 16, v146
    v_and_b32 v4, 0xffff0000, v146
    v_fma_f32 v3, v3, v13, v14
    v_fma_f32 v4, v4, v13, v14
    v_cvt_pk_bf16_f32 v146, v3, v4
    v_lshlrev_b32 v5, 16, v147
    v_and_b32 v6, 0xffff0000, v147
    v_fma_f32 v5, v5, v13, v14
    v_fma_f32 v6, v6, v13, v14
    v_cvt_pk_bf16_f32 v147, v5, v6
    v_lshlrev_b32 v3, 16, v148
    v_and_b32 v4, 0xffff0000, v148
    v_fma_f32 v3, v3, v13, v14
    v_fma_f32 v4, v4, v13, v14
    v_cvt_pk_bf16_f32 v148, v3, v4
    v_lshlrev_b32 v5, 16, v149
    v_and_b32 v6, 0xffff0000, v149
    v_fma_f32 v5, v5, v13, v14
    v_fma_f32 v6, v6, v13, v14
    v_cvt_pk_bf16_f32 v149, v5, v6
    v_lshlrev_b32 v3, 16, v150
    v_and_b32 v4, 0xffff0000, v150
    v_fma_f32 v3, v3, v13, v14
    v_fma_f32 v4, v4, v13, v14
    v_cvt_pk_bf16_f32 v150, v3, v4
    v_lshlrev_b32 v5, 16, v151
    v_and_b32 v6, 0xffff0000, v151
    v_fma_f32 v5, v5, v13, v14
    v_fma_f32 v6, v6, v13, v14
    v_cvt_pk_bf16_f32 v151, v5, v6
    v_lshlrev_b32 v3, 16, v152
    v_and_b32 v4, 0xffff0000, v152
    v_fma_f32 v3, v3, v13, v14
    v_fma_f32 v4, v4, v13, v14
    v_cvt_pk_bf16_f32 v152, v3, v4
    v_lshlrev_b32 v5, 16, v153
    v_and_b32 v6, 0xffff0000, v153
    v_fma_f32 v5, v5, v13, v14
    v_fma_f32 v6, v6, v13, v14
    v_cvt_pk_bf16_f32 v153, v5, v6
    v_lshlrev_b32 v3, 16, v154
    v_and_b32 v4, 0xffff0000, v154
    v_fma_f32 v3, v3, v13, v14
    v_fma_f32 v4, v4, v13, v14
    v_cvt_pk_bf16_f32 v154, v3, v4
    v_lshlrev_b32 v5, 16, v155
    v_and_b32 v6, 0xffff0000, v155
    v_fma_f32 v5, v5, v13, v14
    v_fma_f32 v6, v6, v13, v14
    v_cvt_pk_bf16_f32 v155, v5, v6
    v_lshlrev_b32 v3, 16, v156
    v_and_b32 v4, 0xffff0000, v156
    v_fma_f32 v3, v3, v13, v14
    v_fma_f32 v4, v4, v13, v14
    v_cvt_pk_bf16_f32 v156, v3, v4
    v_lshlrev_b32 v5, 16, v157
    v_and_b32 v6, 0xffff0000, v157
    v_fma_f32 v5, v5, v13, v14
    v_fma_f32 v6, v6, v13, v14
    v_cvt_pk_bf16_f32 v157, v5, v6
    v_lshlrev_b32 v3, 16, v158
    v_and_b32 v4, 0xffff0000, v158
    v_fma_f32 v3, v3, v13, v14
    v_fma_f32 v4, v4, v13, v14
    v_cvt_pk_bf16_f32 v158, v3, v4
    v_lshlrev_b32 v5, 16, v159
    v_and_b32 v6, 0xffff0000, v159
    v_fma_f32 v5, v5, v13, v14
    v_fma_f32 v6, v6, v13, v14
    v_cvt_pk_bf16_f32 v159, v5, v6
    v_lshlrev_b32 v3, 16, v160
    v_and_b32 v4, 0xffff0000, v160
    v_fma_f32 v3, v3, v13, v14
    v_fma_f32 v4, v4, v13, v14
    v_cvt_pk_bf16_f32 v160, v3, v4
    v_lshlrev_b32 v5, 16, v161
    v_and_b32 v6, 0xffff0000, v161
    v_fma_f32 v5, v5, v13, v14
    v_fma_f32 v6, v6, v13, v14
    v_cvt_pk_bf16_f32 v161, v5, v6
    v_lshlrev_b32 v3, 16, v162
    v_and_b32 v4, 0xffff0000, v162
    v_fma_f32 v3, v3, v13, v14
    v_fma_f32 v4, v4, v13, v14
    v_cvt_pk_bf16_f32 v162, v3, v4
    v_lshlrev_b32 v5, 16, v163
    v_and_b32 v6, 0xffff0000, v163
    v_fma_f32 v5, v5, v13, v14
    v_fma_f32 v6, v6, v13, v14
    v_cvt_pk_bf16_f32 v163, v5, v6
    v_lshlrev_b32 v3, 16, v164
    v_and_b32 v4, 0xffff0000, v164
    v_fma_f32 v3, v3, v13, v14
    v_fma_f32 v4, v4, v13, v14
    v_cvt_pk_bf16_f32 v164, v3, v4
    v_lshlrev_b32 v5, 16, v165
    v_and_b32 v6, 0xffff0000, v165
    v_fma_f32 v5, v5, v13, v14
    v_fma_f32 v6, v6, v13, v14
    v_cvt_pk_bf16_f32 v165, v5, v6
    v_lshlrev_b32 v3, 16, v166
    v_and_b32 v4, 0xffff0000, v166
    v_fma_f32 v3, v3, v13, v14
    v_fma_f32 v4, v4, v13, v14
    v_cvt_pk_bf16_f32 v166, v3, v4
    v_lshlrev_b32 v5, 16, v167
    v_and_b32 v6, 0xffff0000, v167
    v_fma_f32 v5, v5, v13, v14
    v_fma_f32 v6, v6, v13, v14
    v_cvt_pk_bf16_f32 v167, v5, v6
    v_lshlrev_b32 v3, 16, v168
    v_and_b32 v4, 0xffff0000, v168
    v_fma_f32 v3, v3, v13, v14
    v_fma_f32 v4, v4, v13, v14
    v_cvt_pk_bf16_f32 v168, v3, v4
    v_lshlrev_b32 v5, 16, v169
    v_and_b32 v6, 0xffff0000, v169
    v_fma_f32 v5, v5, v13, v14
    v_fma_f32 v6, v6, v13, v14
    v_cvt_pk_bf16_f32 v169, v5, v6
    v_lshlrev_b32 v3, 16, v170
    v_and_b32 v4, 0xffff0000, v170
    v_fma_f32 v3, v3, v13, v14
    v_fma_f32 v4, v4, v13, v14
    v_cvt_pk_bf16_f32 v170, v3, v4
    v_lshlrev_b32 v5, 16, v171
    v_and_b32 v6, 0xffff0000, v171
    v_fma_f32 v5, v5, v13, v14
    v_fma_f32 v6, v6, v13, v14
    v_cvt_pk_bf16_f32 v171, v5, v6
    v_lshlrev_b32 v3, 16, v172
    v_and_b32 v4, 0xffff0000, v172
    v_fma_f32 v3, v3, v13, v14
    v_fma_f32 v4, v4, v13, v14
    v_cvt_pk_bf16_f32 v172, v3, v4
    v_lshlrev_b32 v5, 16, v173
    v_and_b32 v6, 0xffff0000, v173
    v_fma_f32 v5, v5, v13, v14
    v_fma_f32 v6, v6, v13, v14
    v_cvt_pk_bf16_f32 v173, v5, v6
    v_lshlrev_b32 v3, 16, v174
    v_and_b32 v4, 0xffff0000, v174
    v_fma_f32 v3, v3, v13, v14
    v_fma_f32 v4, v4, v13, v14
    v_cvt_pk_bf16_f32 v174, v3, v4
    v_lshlrev_b32 v5, 16, v175
    v_and_b32 v6, 0xffff0000, v175
    v_fma_f32 v5, v5, v13, v14
    v_fma_f32 v6, v6, v13, v14
    v_cvt_pk_bf16_f32 v175, v5, v6
    v_lshlrev_b32 v3, 16, v176
    v_and_b32 v4, 0xffff0000, v176
    v_fma_f32 v3, v3, v13, v14
    v_fma_f32 v4, v4, v13, v14
    v_cvt_pk_bf16_f32 v176, v3, v4
    v_lshlrev_b32 v5, 16, v177
    v_and_b32 v6, 0xffff0000, v177
    v_fma_f32 v5, v5, v13, v14
    v_fma_f32 v6, v6, v13, v14
    v_cvt_pk_bf16_f32 v177, v5, v6
    v_lshlrev_b32 v3, 16, v178
    v_and_b32 v4, 0xffff0000, v178
    v_fma_f32 v3, v3, v13, v14
    v_fma_f32 v4, v4, v13, v14
    v_cvt_pk_bf16_f32 v178, v3, v4
    v_lshlrev_b32 v5, 16, v179
    v_and_b32 v6, 0xffff0000, v179
    v_fma_f32 v5, v5, v13, v14
    v_fma_f32 v6, v6, v13, v14
    v_cvt_pk_bf16_f32 v179, v5, v6
    v_lshlrev_b32 v3, 16, v180
    v_and_b32 v4, 0xffff0000, v180
    v_fma_f32 v3, v3, v13, v14
    v_fma_f32 v4, v4, v13, v14
    v_cvt_pk_bf16_f32 v180, v3, v4
    v_lshlrev_b32 v5, 16, v181
    v_and_b32 v6, 0xffff0000, v181
    v_fma_f32 v5, v5, v13, v14
    v_fma_f32 v6, v6, v13, v14
    v_cvt_pk_bf16_f32 v181, v5, v6
    v_lshlrev_b32 v3, 16, v182
    v_and_b32 v4, 0xffff0000, v182
    v_fma_f32 v3, v3, v13, v14
    v_fma_f32 v4, v4, v13, v14
    v_cvt_pk_bf16_f32 v182, v3, v4
    v_lshlrev_b32 v5, 16, v183
    v_and_b32 v6, 0xffff0000, v183
    v_fma_f32 v5, v5, v13, v14
    v_fma_f32 v6, v6, v13, v14
    v_cvt_pk_bf16_f32 v183, v5, v6
    v_lshlrev_b32 v3, 16, v184
    v_and_b32 v4, 0xffff0000, v184
    v_fma_f32 v3, v3, v13, v14
    v_fma_f32 v4, v4, v13, v14
    v_cvt_pk_bf16_f32 v184, v3, v4
    v_lshlrev_b32 v5, 16, v185
    v_and_b32 v6, 0xffff0000, v185
    v_fma_f32 v5, v5, v13, v14
    v_fma_f32 v6, v6, v13, v14
    v_cvt_pk_bf16_f32 v185, v5, v6
    v_lshlrev_b32 v3, 16, v186
    v_and_b32 v4, 0xffff0000, v186
    v_fma_f32 v3, v3, v13, v14
    v_fma_f32 v4, v4, v13, v14
    v_cvt_pk_bf16_f32 v186, v3, v4
    v_lshlrev_b32 v5, 16, v187
    v_and_b32 v6, 0xffff0000, v187
    v_fma_f32 v5, v5, v13, v14
    v_fma_f32 v6, v6, v13, v14
    v_cvt_pk_bf16_f32 v187, v5, v6
    v_lshlrev_b32 v3, 16, v188
    v_and_b32 v4, 0xffff0000, v188
    v_fma_f32 v3, v3, v13, v14
    v_fma_f32 v4, v4, v13, v14
    v_cvt_pk_bf16_f32 v188, v3, v4
    v_lshlrev_b32 v5, 16, v189
    v_and_b32 v6, 0xffff0000, v189
    v_fma_f32 v5, v5, v13, v14
    v_fma_f32 v6, v6, v13, v14
    v_cvt_pk_bf16_f32 v189, v5, v6
    v_lshlrev_b32 v3, 16, v190
    v_and_b32 v4, 0xffff0000, v190
    v_fma_f32 v3, v3, v13, v14
    v_fma_f32 v4, v4, v13, v14
    v_cvt_pk_bf16_f32 v190, v3, v4
    v_lshlrev_b32 v5, 16, v191
    v_and_b32 v6, 0xffff0000, v191
    v_fma_f32 v5, v5, v13, v14
    v_fma_f32 v6, v6, v13, v14
    v_cvt_pk_bf16_f32 v191, v5, v6
    v_lshlrev_b32 v3, 16, v192
    v_and_b32 v4, 0xffff0000, v192
    v_fma_f32 v3, v3, v13, v14
    v_fma_f32 v4, v4, v13, v14
    v_cvt_pk_bf16_f32 v192, v3, v4
    v_lshlrev_b32 v5, 16, v193
    v_and_b32 v6, 0xffff0000, v193
    v_fma_f32 v5, v5, v13, v14
    v_fma_f32 v6, v6, v13, v14
    v_cvt_pk_bf16_f32 v193, v5, v6
    v_lshlrev_b32 v3, 16, v194
    v_and_b32 v4, 0xffff0000, v194
    v_fma_f32 v3, v3, v13, v14
    v_fma_f32 v4, v4, v13, v14
    v_cvt_pk_bf16_f32 v194, v3, v4
    v_lshlrev_b32 v5, 16, v195
    v_and_b32 v6, 0xffff0000, v195
    v_fma_f32 v5, v5, v13, v14
    v_fma_f32 v6, v6, v13, v14
    v_cvt_pk_bf16_f32 v195, v5, v6
    v_lshlrev_b32 v3, 16, v196
    v_and_b32 v4, 0xffff0000, v196
    v_fma_f32 v3, v3, v13, v14
    v_fma_f32 v4, v4, v13, v14
    v_cvt_pk_bf16_f32 v196, v3, v4
    v_lshlrev_b32 v5, 16, v197
    v_and_b32 v6, 0xffff0000, v197
    v_fma_f32 v5, v5, v13, v14
    v_fma_f32 v6, v6, v13, v14
    v_cvt_pk_bf16_f32 v197, v5, v6
    v_lshlrev_b32 v3, 16, v198
    v_and_b32 v4, 0xffff0000, v198
    v_fma_f32 v3, v3, v13, v14
    v_fma_f32 v4, v4, v13, v14
    v_cvt_pk_bf16_f32 v198, v3, v4
    v_lshlrev_b32 v5, 16, v199
    v_and_b32 v6, 0xffff0000, v199
    v_fma_f32 v5, v5, v13, v14
    v_fma_f32 v6, v6, v13, v14
    v_cvt_pk_bf16_f32 v199, v5, v6
    v_lshlrev_b32 v3, 16, v200
    v_and_b32 v4, 0xffff0000, v200
    v_fma_f32 v3, v3, v13, v14
    v_fma_f32 v4, v4, v13, v14
    v_cvt_pk_bf16_f32 v200, v3, v4
    v_lshlrev_b32 v5, 16, v201
    v_and_b32 v6, 0xffff0000, v201
    v_fma_f32 v5, v5, v13, v14
    v_fma_f32 v6, v6, v13, v14
    v_cvt_pk_bf16_f32 v201, v5, v6
    v_lshlrev_b32 v3, 16, v202
    v_and_b32 v4, 0xffff0000, v202
    v_fma_f32 v3, v3, v13, v14
    v_fma_f32 v4, v4, v13, v14
    v_cvt_pk_bf16_f32 v202, v3, v4
    v_lshlrev_b32 v5, 16, v203
    v_and_b32 v6, 0xffff0000, v203
    v_fma_f32 v5, v5, v13, v14
    v_fma_f32 v6, v6, v13, v14
    v_cvt_pk_bf16_f32 v203, v5, v6
    v_lshlrev_b32 v3, 16, v204
    v_and_b32 v4, 0xffff0000, v204
    v_fma_f32 v3, v3, v13, v14
    v_fma_f32 v4, v4, v13, v14
    v_cvt_pk_bf16_f32 v204, v3, v4
    v_lshlrev_b32 v5, 16, v205
    v_and_b32 v6, 0xffff0000, v205
    v_fma_f32 v5, v5, v13, v14
    v_fma_f32 v6, v6, v13, v14
    v_cvt_pk_bf16_f32 v205, v5, v6
    v_lshlrev_b32 v3, 16, v206
    v_and_b32 v4, 0xffff0000, v206
    v_fma_f32 v3, v3, v13, v14
    v_fma_f32 v4, v4, v13, v14
    v_cvt_pk_bf16_f32 v206, v3, v4
    v_lshlrev_b32 v5, 16, v207
    v_and_b32 v6, 0xffff0000, v207
    v_fma_f32 v5, v5, v13, v14
    v_fma_f32 v6, v6, v13, v14
    v_cvt_pk_bf16_f32 v207, v5, v6
    v_lshlrev_b32 v3, 16, v208
    v_and_b32 v4, 0xffff0000, v208
    v_fma_f32 v3, v3, v13, v14
    v_fma_f32 v4, v4, v13, v14
    v_cvt_pk_bf16_f32 v208, v3, v4
    v_lshlrev_b32 v5, 16, v209
    v_and_b32 v6, 0xffff0000, v209
    v_fma_f32 v5, v5, v13, v14
    v_fma_f32 v6, v6, v13, v14
    v_cvt_pk_bf16_f32 v209, v5, v6
    v_lshlrev_b32 v3, 16, v210
    v_and_b32 v4, 0xffff0000, v210
    v_fma_f32 v3, v3, v13, v14
    v_fma_f32 v4, v4, v13, v14
    v_cvt_pk_bf16_f32 v210, v3, v4
    v_lshlrev_b32 v5, 16, v211
    v_and_b32 v6, 0xffff0000, v211
    v_fma_f32 v5, v5, v13, v14
    v_fma_f32 v6, v6, v13, v14
    v_cvt_pk_bf16_f32 v211, v5, v6
    v_lshlrev_b32 v3, 16, v212
    v_and_b32 v4, 0xffff0000, v212
    v_fma_f32 v3, v3, v13, v14
    v_fma_f32 v4, v4, v13, v14
    v_cvt_pk_bf16_f32 v212, v3, v4
    v_lshlrev_b32 v5, 16, v213
    v_and_b32 v6, 0xffff0000, v213
    v_fma_f32 v5, v5, v13, v14
    v_fma_f32 v6, v6, v13, v14
    v_cvt_pk_bf16_f32 v213, v5, v6
    v_lshlrev_b32 v3, 16, v214
    v_and_b32 v4, 0xffff0000, v214
    v_fma_f32 v3, v3, v13, v14
    v_fma_f32 v4, v4, v13, v14
    v_cvt_pk_bf16_f32 v214, v3, v4
    v_lshlrev_b32 v5, 16, v215
    v_and_b32 v6, 0xffff0000, v215
    v_fma_f32 v5, v5, v13, v14
    v_fma_f32 v6, v6, v13, v14
    v_cvt_pk_bf16_f32 v215, v5, v6
    s_mov_b64 s[68:69], exec
    s_mov_b32 exec_hi, 0xfffffff
    s_add_u32 m0, s65, 26880
    s_add_u32 s70, s67, 204800
    buffer_load_dwordx4 v25, s[12:15], s70 offen lds
    s_add_u32 m0, s65, 30720
    s_add_u32 s70, s67, 235520
    buffer_load_dwordx4 v25, s[12:15], s70 offen lds
    s_add_u32 m0, s65, 34560
    s_add_u32 s70, s67, 266240
    buffer_load_dwordx4 v25, s[12:15], s70 offen lds
    s_add_u32 m0, s65, 38400
    s_add_u32 s70, s67, 296960
    buffer_load_dwordx4 v25, s[12:15], s70 offen lds
    s_add_u32 m0, s65, 42240
    s_add_u32 s70, s67, 327680
    buffer_load_dwordx4 v25, s[12:15], s70 offen lds
    s_add_u32 m0, s65, 46080
    s_add_u32 s70, s67, 358400
    buffer_load_dwordx4 v25, s[12:15], s70 offen lds
    s_add_u32 m0, s65, 49920
    s_add_u32 s70, s67, 389120
    buffer_load_dwordx4 v25, s[12:15], s70 offen lds
    s_mov_b64 exec, s[68:69]
    s_waitcnt vmcnt(7)
    s_barrier
    v_add_u32 v22, 0, v23
    ds_read_b64_tr_b16 v[64:65], v22 offset:0
    ds_read_b64_tr_b16 v[66:67], v22 offset:640
    ds_read_b64_tr_b16 v[68:69], v22 offset:32
    ds_read_b64_tr_b16 v[70:71], v22 offset:672
    ds_read_b64_tr_b16 v[72:73], v22 offset:64
    ds_read_b64_tr_b16 v[74:75], v22 offset:704
    ds_read_b64_tr_b16 v[76:77], v22 offset:96
    ds_read_b64_tr_b16 v[78:79], v22 offset:736
    ds_read_b64_tr_b16 v[80:81], v22 offset:128
    ds_read_b64_tr_b16 v[82:83], v22 offset:768
    v_add_u32 v22, 5120, v23
    ds_read_b64_tr_b16 v[100:101], v22 offset:0
    ds_read_b64_tr_b16 v[102:103], v22 offset:640
    ds_read_b64_tr_b16 v[104:105], v22 offset:32
    ds_read_b64_tr_b16 v[106:107], v22 offset:672
    ds_read_b64_tr_b16 v[108:109], v22 offset:64
    ds_read_b64_tr_b16 v[110:111], v22 offset:704
    ds_read_b64_tr_b16 v[112:113], v22 offset:96
    ds_read_b64_tr_b16 v[114:115], v22 offset:736
    ds_read_b64_tr_b16 v[116:117], v22 offset:128
    ds_read_b64_tr_b16 v[118:119], v22 offset:768
    s_waitcnt lgkmcnt(10)
    v_mfma_f32_16x16x32_bf16 v[28:31], v[64:67], v[136:139], v[28:31]
    v_mfma_f32_16x16x32_bf16 v[32:35], v[68:71], v[136:139], v[32:35]
    v_mfma_f32_16x16x32_bf16 v[36:39], v[72:75], v[136:139], v[36:39]
    v_mfma_f32_16x16x32_bf16 v[40:43], v[76:79], v[136:139], v[40:43]
    v_mfma_f32_16x16x32_bf16 v[44:47], v[80:83], v[136:139], v[44:47]
    v_add_u32 v22, 10240, v23
    ds_read_b64_tr_b16 v[64:65], v22 offset:0
    ds_read_b64_tr_b16 v[66:67], v22 offset:640
    ds_read_b64_tr_b16 v[68:69], v22 offset:32
    ds_read_b64_tr_b16 v[70:71], v22 offset:672
    ds_read_b64_tr_b16 v[72:73], v22 offset:64
    ds_read_b64_tr_b16 v[74:75], v22 offset:704
    ds_read_b64_tr_b16 v[76:77], v22 offset:96
    ds_read_b64_tr_b16 v[78:79], v22 offset:736
    ds_read_b64_tr_b16 v[80:81], v22 offset:128
    ds_read_b64_tr_b16 v[82:83], v22 offset:768
    s_waitcnt lgkmcnt(10)
    v_mfma_f32_16x16x32_bf16 v[28:31], v[100:103], v[140:143], v[28:31]
    v_mfma_f32_16x16x32_bf16 v[32:35], v[104:107], v[140:143], v[32:35]
    v_mfma_f32_16x16x32_bf16 v[36:39], v[108:111], v[140:143], v[36:39]
    v_mfma_f32_16x16x32_bf16 v[40:43], v[112:115], v[140:143], v[40:43]
    v_mfma_f32_16x16x32_bf16 v[44:47], v[116:119], v[140:143], v[44:47]
    v_add_u32 v22, 15360, v23
    ds_read_b64_tr_b16 v[100:101], v22 offset:0
    ds_read_b64_tr_b16 v[102:103], v22 offset:640
    ds_read_b64_tr_b16 v[104:105], v22 offset:32
    ds_read_b64_tr_b16 v[106:107], v22 offset:672
    ds_read_b64_tr_b16 v[108:109], v22 offset:64
    ds_read_b64_tr_b16 v[110:111], v22 offset:704
    ds_read_b64_tr_b16 v[112:113], v22 offset:96
    ds_read_b64_tr_b16 v[114:115], v22 offset:736
    ds_read_b64_tr_b16 v[116:117], v22 offset:128
    ds_read_b64_tr_b16 v[118:119], v22 offset:768
    s_waitcnt lgkmcnt(10)
    v_mfma_f32_16x16x32_bf16 v[28:31], v[64:67], v[144:147], v[28:31]
    v_mfma_f32_16x16x32_bf16 v[32:35], v[68:71], v[144:147], v[32:35]
    v_mfma_f32_16x16x32_bf16 v[36:39], v[72:75], v[144:147], v[36:39]
    v_mfma_f32_16x16x32_bf16 v[40:43], v[76:79], v[144:147], v[40:43]
    v_mfma_f32_16x16x32_bf16 v[44:47], v[80:83], v[144:147], v[44:47]
    v_add_u32 v22, 20480, v23
    ds_read_b64_tr_b16 v[64:65], v22 offset:0
    ds_read_b64_tr_b16 v[66:67], v22 offset:640
    ds_read_b64_tr_b16 v[68:69], v22 offset:32
    ds_read_b64_tr_b16 v[70:71], v22 offset:672
    ds_read_b64_tr_b16 v[72:73], v22 offset:64
    ds_read_b64_tr_b16 v[74:75], v22 offset:704
    ds_read_b64_tr_b16 v[76:77], v22 offset:96
    ds_read_b64_tr_b16 v[78:79], v22 offset:736
    ds_read_b64_tr_b16 v[80:81], v22 offset:128
    ds_read_b64_tr_b16 v[82:83], v22 offset:768
    s_waitcnt lgkmcnt(10)
    v_mfma_f32_16x16x32_bf16 v[28:31], v[100:103], v[148:151], v[28:31]
    v_mfma_f32_16x16x32_bf16 v[32:35], v[104:107], v[148:151], v[32:35]
    v_mfma_f32_16x16x32_bf16 v[36:39], v[108:111], v[148:151], v[36:39]
    v_mfma_f32_16x16x32_bf16 v[40:43], v[112:115], v[148:151], v[40:43]
    v_mfma_f32_16x16x32_bf16 v[44:47], v[116:119], v[148:151], v[44:47]
    s_waitcnt lgkmcnt(0)
    v_mfma_f32_16x16x32_bf16 v[28:31], v[64:67], v[152:155], v[28:31]
    v_mfma_f32_16x16x32_bf16 v[32:35], v[68:71], v[152:155], v[32:35]
    v_mfma_f32_16x16x32_bf16 v[36:39], v[72:75], v[152:155], v[36:39]
    v_mfma_f32_16x16x32_bf16 v[40:43], v[76:79], v[152:155], v[40:43]
    v_mfma_f32_16x16x32_bf16 v[44:47], v[80:83], v[152:155], v[44:47]
    s_barrier
    s_mov_b64 s[68:69], exec
    s_mov_b32 exec_hi, 0xfffffff
    s_add_u32 m0, s65, 0
    s_add_u32 s70, s67, 409600
    buffer_load_dwordx4 v25, s[12:15], s70 offen lds
    s_add_u32 m0, s65, 3840
    s_add_u32 s70, s67, 440320
    buffer_load_dwordx4 v25, s[12:15], s70 offen lds
    s_add_u32 m0, s65, 7680
    s_add_u32 s70, s67, 471040
    buffer_load_dwordx4 v25, s[12:15], s70 offen lds
    s_add_u32 m0, s65, 11520
    s_add_u32 s70, s67, 501760
    buffer_load_dwordx4 v25, s[12:15], s70 offen lds
    s_add_u32 m0, s65, 15360
    s_add_u32 s70, s67, 532480
    buffer_load_dwordx4 v25, s[12:15], s70 offen lds
    s_add_u32 m0, s65, 19200
    s_add_u32 s70, s67, 563200
    buffer_load_dwordx4 v25, s[12:15], s70 offen lds
    s_add_u32 m0, s65, 23040
    s_add_u32 s70, s67, 593920
    buffer_load_dwordx4 v25, s[12:15], s70 offen lds
    s_mov_b64 exec, s[68:69]
    s_waitcnt vmcnt(7)
    s_barrier
    v_add_u32 v22, 26880, v23
    ds_read_b64_tr_b16 v[64:65], v22 offset:0
    ds_read_b64_tr_b16 v[66:67], v22 offset:640
    ds_read_b64_tr_b16 v[68:69], v22 offset:32
    ds_read_b64_tr_b16 v[70:71], v22 offset:672
    ds_read_b64_tr_b16 v[72:73], v22 offset:64
    ds_read_b64_tr_b16 v[74:75], v22 offset:704
    ds_read_b64_tr_b16 v[76:77], v22 offset:96
    ds_read_b64_tr_b16 v[78:79], v22 offset:736
    ds_read_b64_tr_b16 v[80:81], v22 offset:128
    ds_read_b64_tr_b16 v[82:83], v22 offset:768
    v_add_u32 v22, 32000, v23
    ds_read_b64_tr_b16 v[100:101], v22 offset:0
    ds_read_b64_tr_b16 v[102:103], v22 offset:640
    ds_read_b64_tr_b16 v[104:105], v22 offset:32
    ds_read_b64_tr_b16 v[106:107], v22 offset:672
    ds_read_b64_tr_b16 v[108:109], v22 offset:64
    ds_read_b64_tr_b16 v[110:111], v22 offset:704
    ds_read_b64_tr_b16 v[112:113], v22 offset:96
    ds_read_b64_tr_b16 v[114:115], v22 offset:736
    ds_read_b64_tr_b16 v[116:117], v22 offset:128
    ds_read_b64_tr_b16 v[118:119], v22 offset:768
    s_waitcnt lgkmcnt(10)
    v_mfma_f32_16x16x32_bf16 v[28:31], v[64:67], v[156:159], v[28:31]
    v_mfma_f32_16x16x32_bf16 v[32:35], v[68:71], v[156:159], v[32:35]
    v_mfma_f32_16x16x32_bf16 v[36:39], v[72:75], v[156:159], v[36:39]
    v_mfma_f32_16x16x32_bf16 v[40:43], v[76:79], v[156:159], v[40:43]
    v_mfma_f32_16x16x32_bf16 v[44:47], v[80:83], v[156:159], v[44:47]
    v_add_u32 v22, 37120, v23
    ds_read_b64_tr_b16 v[64:65], v22 offset:0
    ds_read_b64_tr_b16 v[66:67], v22 offset:640
    ds_read_b64_tr_b16 v[68:69], v22 offset:32
    ds_read_b64_tr_b16 v[70:71], v22 offset:672
    ds_read_b64_tr_b16 v[72:73], v22 offset:64
    ds_read_b64_tr_b16 v[74:75], v22 offset:704
    ds_read_b64_tr_b16 v[76:77], v22 offset:96
    ds_read_b64_tr_b16 v[78:79], v22 offset:736
    ds_read_b64_tr_b16 v[80:81], v22 offset:128
    ds_read_b64_tr_b16 v[82:83], v22 offset:768
    s_waitcnt lgkmcnt(10)
    v_mfma_f32_16x16x32_bf16 v[28:31], v[100:103], v[160:163], v[28:31]
    v_mfma_f32_16x16x32_bf16 v[32:35], v[104:107], v[160:163], v[32:35]
    v_mfma_f32_16x16x32_bf16 v[36:39], v[108:111], v[160:163], v[36:39]
    v_mfma_f32_16x16x32_bf16 v[40:43], v[112:115], v[160:163], v[40:43]
    v_mfma_f32_16x16x32_bf16 v[44:47], v[116:119], v[160:163], v[44:47]
    v_add_u32 v22, 42240, v23
    ds_read_b64_tr_b16 v[100:101], v22 offset:0
    ds_read_b64_tr_b16 v[102:103], v22 offset:640
    ds_read_b64_tr_b16 v[104:105], v22 offset:32
    ds_read_b64_tr_b16 v[106:107], v22 offset:672
    ds_read_b64_tr_b16 v[108:109], v22 offset:64
    ds_read_b64_tr_b16 v[110:111], v22 offset:704
    ds_read_b64_tr_b16 v[112:113], v22 offset:96
    ds_read_b64_tr_b16 v[114:115], v22 offset:736
    ds_read_b64_tr_b16 v[116:117], v22 offset:128
    ds_read_b64_tr_b16 v[118:119], v22 offset:768
    s_waitcnt lgkmcnt(10)
    v_mfma_f32_16x16x32_bf16 v[28:31], v[64:67], v[164:167], v[28:31]
    v_mfma_f32_16x16x32_bf16 v[32:35], v[68:71], v[164:167], v[32:35]
    v_mfma_f32_16x16x32_bf16 v[36:39], v[72:75], v[164:167], v[36:39]
    v_mfma_f32_16x16x32_bf16 v[40:43], v[76:79], v[164:167], v[40:43]
    v_mfma_f32_16x16x32_bf16 v[44:47], v[80:83], v[164:167], v[44:47]
    v_add_u32 v22, 47360, v23
    ds_read_b64_tr_b16 v[64:65], v22 offset:0
    ds_read_b64_tr_b16 v[66:67], v22 offset:640
    ds_read_b64_tr_b16 v[68:69], v22 offset:32
    ds_read_b64_tr_b16 v[70:71], v22 offset:672
    ds_read_b64_tr_b16 v[72:73], v22 offset:64
    ds_read_b64_tr_b16 v[74:75], v22 offset:704
    ds_read_b64_tr_b16 v[76:77], v22 offset:96
    ds_read_b64_tr_b16 v[78:79], v22 offset:736
    ds_read_b64_tr_b16 v[80:81], v22 offset:128
    ds_read_b64_tr_b16 v[82:83], v22 offset:768
    s_waitcnt lgkmcnt(10)
    v_mfma_f32_16x16x32_bf16 v[28:31], v[100:103], v[168:171], v[28:31]
    v_mfma_f32_16x16x32_bf16 v[32:35], v[104:107], v[168:171], v[32:35]
    v_mfma_f32_16x16x32_bf16 v[36:39], v[108:111], v[168:171], v[36:39]
    v_mfma_f32_16x16x32_bf16 v[40:43], v[112:115], v[168:171], v[40:43]
    v_mfma_f32_16x16x32_bf16 v[44:47], v[116:119], v[168:171], v[44:47]
    s_waitcnt lgkmcnt(0)
    v_mfma_f32_16x16x32_bf16 v[28:31], v[64:67], v[172:175], v[28:31]
    v_mfma_f32_16x16x32_bf16 v[32:35], v[68:71], v[172:175], v[32:35]
    v_mfma_f32_16x16x32_bf16 v[36:39], v[72:75], v[172:175], v[36:39]
    v_mfma_f32_16x16x32_bf16 v[40:43], v[76:79], v[172:175], v[40:43]
    v_mfma_f32_16x16x32_bf16 v[44:47], v[80:83], v[172:175], v[44:47]
    s_barrier
    s_mov_b64 s[68:69], exec
    s_mov_b32 exec_hi, 0xfffffff
    s_add_u32 m0, s65, 26880
    s_add_u32 s70, s67, 614400
    buffer_load_dwordx4 v25, s[12:15], s70 offen lds
    s_add_u32 m0, s65, 30720
    s_add_u32 s70, s67, 645120
    buffer_load_dwordx4 v25, s[12:15], s70 offen lds
    s_add_u32 m0, s65, 34560
    s_add_u32 s70, s67, 675840
    buffer_load_dwordx4 v25, s[12:15], s70 offen lds
    s_add_u32 m0, s65, 38400
    s_add_u32 s70, s67, 706560
    buffer_load_dwordx4 v25, s[12:15], s70 offen lds
    s_add_u32 m0, s65, 42240
    s_add_u32 s70, s67, 737280
    buffer_load_dwordx4 v25, s[12:15], s70 offen lds
    s_add_u32 m0, s65, 46080
    s_add_u32 s70, s67, 768000
    buffer_load_dwordx4 v25, s[12:15], s70 offen lds
    s_add_u32 m0, s65, 49920
    s_add_u32 s70, s67, 798720
    buffer_load_dwordx4 v25, s[12:15], s70 offen lds
    s_mov_b64 exec, s[68:69]
    s_waitcnt vmcnt(7)
    s_barrier
    v_add_u32 v22, 0, v23
    ds_read_b64_tr_b16 v[64:65], v22 offset:0
    ds_read_b64_tr_b16 v[66:67], v22 offset:640
    ds_read_b64_tr_b16 v[68:69], v22 offset:32
    ds_read_b64_tr_b16 v[70:71], v22 offset:672
    ds_read_b64_tr_b16 v[72:73], v22 offset:64
    ds_read_b64_tr_b16 v[74:75], v22 offset:704
    ds_read_b64_tr_b16 v[76:77], v22 offset:96
    ds_read_b64_tr_b16 v[78:79], v22 offset:736
    ds_read_b64_tr_b16 v[80:81], v22 offset:128
    ds_read_b64_tr_b16 v[82:83], v22 offset:768
    v_add_u32 v22, 5120, v23
    ds_read_b64_tr_b16 v[100:101], v22 offset:0
    ds_read_b64_tr_b16 v[102:103], v22 offset:640
    ds_read_b64_tr_b16 v[104:105], v22 offset:32
    ds_read_b64_tr_b16 v[106:107], v22 offset:672
    ds_read_b64_tr_b16 v[108:109], v22 offset:64
    ds_read_b64_tr_b16 v[110:111], v22 offset:704
    ds_read_b64_tr_b16 v[112:113], v22 offset:96
    ds_read_b64_tr_b16 v[114:115], v22 offset:736
    ds_read_b64_tr_b16 v[116:117], v22 offset:128
    ds_read_b64_tr_b16 v[118:119], v22 offset:768
    s_waitcnt lgkmcnt(10)
    v_mfma_f32_16x16x32_bf16 v[28:31], v[64:67], v[176:179], v[28:31]
    v_mfma_f32_16x16x32_bf16 v[32:35], v[68:71], v[176:179], v[32:35]
    v_mfma_f32_16x16x32_bf16 v[36:39], v[72:75], v[176:179], v[36:39]
    v_mfma_f32_16x16x32_bf16 v[40:43], v[76:79], v[176:179], v[40:43]
    v_mfma_f32_16x16x32_bf16 v[44:47], v[80:83], v[176:179], v[44:47]
    v_add_u32 v22, 10240, v23
    ds_read_b64_tr_b16 v[64:65], v22 offset:0
    ds_read_b64_tr_b16 v[66:67], v22 offset:640
    ds_read_b64_tr_b16 v[68:69], v22 offset:32
    ds_read_b64_tr_b16 v[70:71], v22 offset:672
    ds_read_b64_tr_b16 v[72:73], v22 offset:64
    ds_read_b64_tr_b16 v[74:75], v22 offset:704
    ds_read_b64_tr_b16 v[76:77], v22 offset:96
    ds_read_b64_tr_b16 v[78:79], v22 offset:736
    ds_read_b64_tr_b16 v[80:81], v22 offset:128
    ds_read_b64_tr_b16 v[82:83], v22 offset:768
    s_waitcnt lgkmcnt(10)
    v_mfma_f32_16x16x32_bf16 v[28:31], v[100:103], v[180:183], v[28:31]
    v_mfma_f32_16x16x32_bf16 v[32:35], v[104:107], v[180:183], v[32:35]
    v_mfma_f32_16x16x32_bf16 v[36:39], v[108:111], v[180:183], v[36:39]
    v_mfma_f32_16x16x32_bf16 v[40:43], v[112:115], v[180:183], v[40:43]
    v_mfma_f32_16x16x32_bf16 v[44:47], v[116:119], v[180:183], v[44:47]
    v_add_u32 v22, 15360, v23
    ds_read_b64_tr_b16 v[100:101], v22 offset:0
    ds_read_b64_tr_b16 v[102:103], v22 offset:640
    ds_read_b64_tr_b16 v[104:105], v22 offset:32
    ds_read_b64_tr_b16 v[106:107], v22 offset:672
    ds_read_b64_tr_b16 v[108:109], v22 offset:64
    ds_read_b64_tr_b16 v[110:111], v22 offset:704
    ds_read_b64_tr_b16 v[112:113], v22 offset:96
    ds_read_b64_tr_b16 v[114:115], v22 offset:736
    ds_read_b64_tr_b16 v[116:117], v22 offset:128
    ds_read_b64_tr_b16 v[118:119], v22 offset:768
    s_waitcnt lgkmcnt(10)
    v_mfma_f32_16x16x32_bf16 v[28:31], v[64:67], v[184:187], v[28:31]
    v_mfma_f32_16x16x32_bf16 v[32:35], v[68:71], v[184:187], v[32:35]
    v_mfma_f32_16x16x32_bf16 v[36:39], v[72:75], v[184:187], v[36:39]
    v_mfma_f32_16x16x32_bf16 v[40:43], v[76:79], v[184:187], v[40:43]
    v_mfma_f32_16x16x32_bf16 v[44:47], v[80:83], v[184:187], v[44:47]
    v_add_u32 v22, 20480, v23
    ds_read_b64_tr_b16 v[64:65], v22 offset:0
    ds_read_b64_tr_b16 v[66:67], v22 offset:640
    ds_read_b64_tr_b16 v[68:69], v22 offset:32
    ds_read_b64_tr_b16 v[70:71], v22 offset:672
    ds_read_b64_tr_b16 v[72:73], v22 offset:64
    ds_read_b64_tr_b16 v[74:75], v22 offset:704
    ds_read_b64_tr_b16 v[76:77], v22 offset:96
    ds_read_b64_tr_b16 v[78:79], v22 offset:736
    ds_read_b64_tr_b16 v[80:81], v22 offset:128
    ds_read_b64_tr_b16 v[82:83], v22 offset:768
    s_waitcnt lgkmcnt(10)
    v_mfma_f32_16x16x32_bf16 v[28:31], v[100:103], v[188:191], v[28:31]
    v_mfma_f32_16x16x32_bf16 v[32:35], v[104:107], v[188:191], v[32:35]
    v_mfma_f32_16x16x32_bf16 v[36:39], v[108:111], v[188:191], v[36:39]
    v_mfma_f32_16x16x32_bf16 v[40:43], v[112:115], v[188:191], v[40:43]
    v_mfma_f32_16x16x32_bf16 v[44:47], v[116:119], v[188:191], v[44:47]
    s_waitcnt lgkmcnt(0)
    v_mfma_f32_16x16x32_bf16 v[28:31], v[64:67], v[192:195], v[28:31]
    v_mfma_f32_16x16x32_bf16 v[32:35], v[68:71], v[192:195], v[32:35]
    v_mfma_f32_16x16x32_bf16 v[36:39], v[72:75], v[192:195], v[36:39]
    v_mfma_f32_16x16x32_bf16 v[40:43], v[76:79], v[192:195], v[40:43]
    v_mfma_f32_16x16x32_bf16 v[44:47], v[80:83], v[192:195], v[44:47]
    s_waitcnt vmcnt(0)
    s_barrier
    v_add_u32 v22, 26880, v23
    ds_read_b64_tr_b16 v[64:65], v22 offset:0
    ds_read_b64_tr_b16 v[66:67], v22 offset:640
    ds_read_b64_tr_b16 v[68:69], v22 offset:32
    ds_read_b64_tr_b16 v[70:71], v22 offset:672
    ds_read_b64_tr_b16 v[72:73], v22 offset:64
    ds_read_b64_tr_b16 v[74:75], v22 offset:704
    ds_read_b64_tr_b16 v[76:77], v22 offset:96
    ds_read_b64_tr_b16 v[78:79], v22 offset:736
    ds_read_b64_tr_b16 v[80:81], v22 offset:128
    ds_read_b64_tr_b16 v[82:83], v22 offset:768
    v_add_u32 v22, 32000, v23
    ds_read_b64_tr_b16 v[100:101], v22 offset:0
    ds_read_b64_tr_b16 v[102:103], v22 offset:640
    ds_read_b64_tr_b16 v[104:105], v22 offset:32
    ds_read_b64_tr_b16 v[106:107], v22 offset:672
    ds_read_b64_tr_b16 v[108:109], v22 offset:64
    ds_read_b64_tr_b16 v[110:111], v22 offset:704
    ds_read_b64_tr_b16 v[112:113], v22 offset:96
    ds_read_b64_tr_b16 v[114:115], v22 offset:736
    ds_read_b64_tr_b16 v[116:117], v22 offset:128
    ds_read_b64_tr_b16 v[118:119], v22 offset:768
    s_waitcnt lgkmcnt(10)
    v_mfma_f32_16x16x32_bf16 v[28:31], v[64:67], v[196:199], v[28:31]
    v_mfma_f32_16x16x32_bf16 v[32:35], v[68:71], v[196:199], v[32:35]
    v_mfma_f32_16x16x32_bf16 v[36:39], v[72:75], v[196:199], v[36:39]
    v_mfma_f32_16x16x32_bf16 v[40:43], v[76:79], v[196:199], v[40:43]
    v_mfma_f32_16x16x32_bf16 v[44:47], v[80:83], v[196:199], v[44:47]
    v_add_u32 v22, 37120, v23
    ds_read_b64_tr_b16 v[64:65], v22 offset:0
    ds_read_b64_tr_b16 v[66:67], v22 offset:640
    ds_read_b64_tr_b16 v[68:69], v22 offset:32
    ds_read_b64_tr_b16 v[70:71], v22 offset:672
    ds_read_b64_tr_b16 v[72:73], v22 offset:64
    ds_read_b64_tr_b16 v[74:75], v22 offset:704
    ds_read_b64_tr_b16 v[76:77], v22 offset:96
    ds_read_b64_tr_b16 v[78:79], v22 offset:736
    ds_read_b64_tr_b16 v[80:81], v22 offset:128
    ds_read_b64_tr_b16 v[82:83], v22 offset:768
    s_waitcnt lgkmcnt(10)
    v_mfma_f32_16x16x32_bf16 v[28:31], v[100:103], v[200:203], v[28:31]
    v_mfma_f32_16x16x32_bf16 v[32:35], v[104:107], v[200:203], v[32:35]
    v_mfma_f32_16x16x32_bf16 v[36:39], v[108:111], v[200:203], v[36:39]
    v_mfma_f32_16x16x32_bf16 v[40:43], v[112:115], v[200:203], v[40:43]
    v_mfma_f32_16x16x32_bf16 v[44:47], v[116:119], v[200:203], v[44:47]
    v_add_u32 v22, 42240, v23
    ds_read_b64_tr_b16 v[100:101], v22 offset:0
    ds_read_b64_tr_b16 v[102:103], v22 offset:640
    ds_read_b64_tr_b16 v[104:105], v22 offset:32
    ds_read_b64_tr_b16 v[106:107], v22 offset:672
    ds_read_b64_tr_b16 v[108:109], v22 offset:64
    ds_read_b64_tr_b16 v[110:111], v22 offset:704
    ds_read_b64_tr_b16 v[112:113], v22 offset:96
    ds_read_b64_tr_b16 v[114:115], v22 offset:736
    ds_read_b64_tr_b16 v[116:117], v22 offset:128
    ds_read_b64_tr_b16 v[118:119], v22 offset:768
    s_waitcnt lgkmcnt(10)
    v_mfma_f32_16x16x32_bf16 v[28:31], v[64:67], v[204:207], v[28:31]
    v_mfma_f32_16x16x32_bf16 v[32:35], v[68:71], v[204:207], v[32:35]
    v_mfma_f32_16x16x32_bf16 v[36:39], v[72:75], v[204:207], v[36:39]
    v_mfma_f32_16x16x32_bf16 v[40:43], v[76:79], v[204:207], v[40:43]
    v_mfma_f32_16x16x32_bf16 v[44:47], v[80:83], v[204:207], v[44:47]
    v_add_u32 v22, 47360, v23
    ds_read_b64_tr_b16 v[64:65], v22 offset:0
    ds_read_b64_tr_b16 v[66:67], v22 offset:640
    ds_read_b64_tr_b16 v[68:69], v22 offset:32
    ds_read_b64_tr_b16 v[70:71], v22 offset:672
    ds_read_b64_tr_b16 v[72:73], v22 offset:64
    ds_read_b64_tr_b16 v[74:75], v22 offset:704
    ds_read_b64_tr_b16 v[76:77], v22 offset:96
    ds_read_b64_tr_b16 v[78:79], v22 offset:736
    ds_read_b64_tr_b16 v[80:81], v22 offset:128
    ds_read_b64_tr_b16 v[82:83], v22 offset:768
    s_waitcnt lgkmcnt(10)
    v_mfma_f32_16x16x32_bf16 v[28:31], v[100:103], v[208:211], v[28:31]
    v_mfma_f32_16x16x32_bf16 v[32:35], v[104:107], v[208:211], v[32:35]
    v_mfma_f32_16x16x32_bf16 v[36:39], v[108:111], v[208:211], v[36:39]
    v_mfma_f32_16x16x32_bf16 v[40:43], v[112:115], v[208:211], v[40:43]
    v_mfma_f32_16x16x32_bf16 v[44:47], v[116:119], v[208:211], v[44:47]
    s_waitcnt lgkmcnt(0)
    v_mfma_f32_16x16x32_bf16 v[28:31], v[64:67], v[212:215], v[28:31]
    v_mfma_f32_16x16x32_bf16 v[32:35], v[68:71], v[212:215], v[32:35]
    v_mfma_f32_16x16x32_bf16 v[36:39], v[72:75], v[212:215], v[36:39]
    v_mfma_f32_16x16x32_bf16 v[40:43], v[76:79], v[212:215], v[40:43]
    v_mfma_f32_16x16x32_bf16 v[44:47], v[80:83], v[212:215], v[44:47]
    s_nop 15
    s_mov_b32 s6, 0x3ea52b5c
    v_mul_f32 v28, s6, v28
    v_mul_f32 v29, s6, v29
    v_mul_f32 v30, s6, v30
    v_mul_f32 v31, s6, v31
    v_cvt_pk_bf16_f32 v26, v28, v29
    v_cvt_pk_bf16_f32 v27, v30, v31
    buffer_store_dwordx2 v[26:27], v24, s[16:19], 0 offen offset:0
    s_nop 0
    v_mul_f32 v32, s6, v32
    v_mul_f32 v33, s6, v33
    v_mul_f32 v34, s6, v34
    v_mul_f32 v35, s6, v35
    v_cvt_pk_bf16_f32 v26, v32, v33
    v_cvt_pk_bf16_f32 v27, v34, v35
    buffer_store_dwordx2 v[26:27], v24, s[16:19], 0 offen offset:32
    s_nop 0
    v_mul_f32 v36, s6, v36
    v_mul_f32 v37, s6, v37
    v_mul_f32 v38, s6, v38
    v_mul_f32 v39, s6, v39
    v_cvt_pk_bf16_f32 v26, v36, v37
    v_cvt_pk_bf16_f32 v27, v38, v39
    buffer_store_dwordx2 v[26:27], v24, s[16:19], 0 offen offset:64
    s_nop 0
    v_mul_f32 v40, s6, v40
    v_mul_f32 v41, s6, v41
    v_mul_f32 v42, s6, v42
    v_mul_f32 v43, s6, v43
    v_cvt_pk_bf16_f32 v26, v40, v41
    v_cvt_pk_bf16_f32 v27, v42, v43
    buffer_store_dwordx2 v[26:27], v24, s[16:19], 0 offen offset:96
    s_nop 0
    v_mul_f32 v44, s6, v44
    v_mul_f32 v45, s6, v45
    v_mul_f32 v46, s6, v46
    v_mul_f32 v47, s6, v47
    v_cvt_pk_bf16_f32 v26, v44, v45
    v_cvt_pk_bf16_f32 v27, v46, v47
    buffer_store_dwordx2 v[26:27], v24, s[16:19], 0 offen offset:128
    s_nop 0
    s_waitcnt vmcnt(0)
    s_endpgm
L_k1_qkv_kernel_extra:
    s_mov_b32 s12, s40
    s_mov_b32 s13, s41
    s_mov_b32 s14, 0x6400
    s_mov_b32 s15, 0x00020000
    s_mov_b32 s24, s42
    s_mov_b32 s25, s43
    s_mov_b32 s26, 0x6400
    s_mov_b32 s27, 0x00020000
    s_mov_b32 s8, s36
    s_mov_b32 s9, s37
    s_mov_b32 s10, 0x280000
    s_mov_b32 s11, 0x00020000
    s_add_u32 s16, s60, 0x280000
    s_addc_u32 s17, s61, 0
    s_mov_b32 s18, 0x40000
    s_mov_b32 s19, 0x00020000
    v_and_b32 v1, 15, v0
    v_bfe_u32 v2, v0, 4, 2
    v_lshrrev_b32 v3, 6, v0
    v_lshlrev_b32 v3, 4, v3
    v_add_u32 v3, v3, v1
    s_mul_i32 s5, s3, 64
    v_add_u32 v3, s5, v3
    v_mov_b32 v10, v3
    v_and_b32 v4, 63, v0
    v_xor_b32 v17, 32, v4
    v_lshlrev_b32 v17, 2, v17
    s_mov_b32 s6, 1280
    v_lshlrev_b32 v5, 4, v2
    v_mov_b32 v4, v3
    v_mul_lo_u32 v4, v4, s6
    v_add_u32 v18, v4, v5
    v_mov_b32 v28, 0
    v_mov_b32 v29, 0
    v_mov_b32 v30, 0
    v_mov_b32 v31, 0
    v_mov_b32 v32, 0
    v_mov_b32 v33, 0
    v_mov_b32 v34, 0
    v_mov_b32 v35, 0
    v_mov_b32 v36, 0
    v_mov_b32 v37, 0
    v_mov_b32 v38, 0
    v_mov_b32 v39, 0
    v_mov_b32 v40, 0
    v_mov_b32 v41, 0
    v_mov_b32 v42, 0
    v_mov_b32 v43, 0
    v_lshrrev_b32 v4, 2, v1
    v_lshl_add_u32 v4, v2, 3, v4
    s_mov_b32 s7, 128
    v_mul_lo_u32 v4, v4, s7
    v_and_b32 v5, 3, v1
    v_lshl_add_u32 v23, v5, 3, v4
    s_mul_i32 s4, s4, 128
    buffer_load_dwordx4 v[136:139], v18, s[8:11], 0 offen offset:0
    buffer_load_dwordx4 v[140:143], v18, s[8:11], 0 offen offset:64
    buffer_load_dwordx4 v[144:147], v18, s[8:11], 0 offen offset:128
    buffer_load_dwordx4 v[148:151], v18, s[8:11], 0 offen offset:192
    buffer_load_dwordx4 v[152:155], v18, s[8:11], 0 offen offset:256
    buffer_load_dwordx4 v[156:159], v18, s[8:11], 0 offen offset:320
    buffer_load_dwordx4 v[160:163], v18, s[8:11], 0 offen offset:384
    buffer_load_dwordx4 v[164:167], v18, s[8:11], 0 offen offset:448
    buffer_load_dwordx4 v[168:171], v18, s[8:11], 0 offen offset:512
    buffer_load_dwordx4 v[172:175], v18, s[8:11], 0 offen offset:576
    buffer_load_dwordx4 v[176:179], v18, s[8:11], 0 offen offset:640
    buffer_load_dwordx4 v[180:183], v18, s[8:11], 0 offen offset:704
    buffer_load_dwordx4 v[184:187], v18, s[8:11], 0 offen offset:768
    buffer_load_dwordx4 v[188:191], v18, s[8:11], 0 offen offset:832
    buffer_load_dwordx4 v[192:195], v18, s[8:11], 0 offen offset:896
    buffer_load_dwordx4 v[196:199], v18, s[8:11], 0 offen offset:960
    buffer_load_dwordx4 v[200:203], v18, s[8:11], 0 offen offset:1024
    buffer_load_dwordx4 v[204:207], v18, s[8:11], 0 offen offset:1088
    buffer_load_dwordx4 v[208:211], v18, s[8:11], 0 offen offset:1152
    buffer_load_dwordx4 v[212:215], v18, s[8:11], 0 offen offset:1216
    v_mov_b32 v64, 0
    v_mov_b32 v65, 0
    v_mov_b32 v66, 0
    v_mov_b32 v67, 0
    v_lshlrev_b32 v4, 4, v0
    ds_write_b128 v4, v[64:67] offset:0
    ds_write_b128 v4, v[64:67] offset:4096
    ds_write_b128 v4, v[64:67] offset:8192
    ds_write_b128 v4, v[64:67] offset:12288
    ds_write_b128 v4, v[64:67] offset:16384
    ds_write_b128 v4, v[64:67] offset:20480
    ds_write_b128 v4, v[64:67] offset:24576
    ds_write_b128 v4, v[64:67] offset:28672
    ds_write_b128 v4, v[64:67] offset:32768
    ds_write_b128 v4, v[64:67] offset:36864
    ds_write_b128 v4, v[64:67] offset:40960
    ds_write_b128 v4, v[64:67] offset:45056
    ds_write_b128 v4, v[64:67] offset:49152
    ds_write_b128 v4, v[64:67] offset:53248
    ds_write_b128 v4, v[64:67] offset:57344
    ds_write_b128 v4, v[64:67] offset:61440
    v_add_u32 v4, 65536, v4
    ds_write_b128 v4, v[64:67] offset:0
    ds_write_b128 v4, v[64:67] offset:4096
    ds_write_b128 v4, v[64:67] offset:8192
    ds_write_b128 v4, v[64:67] offset:12288
    v_lshlrev_b32 v5, 2, v0
    s_movk_i32 s64, 0
    buffer_load_dword v64, v5, s[12:15], s64 offen
    buffer_load_dword v89, v5, s[24:27], s64 offen
    s_movk_i32 s64, 1024
    buffer_load_dword v65, v5, s[12:15], s64 offen
    buffer_load_dword v90, v5, s[24:27], s64 offen
    s_movk_i32 s64, 2048
    buffer_load_dword v66, v5, s[12:15], s64 offen
    buffer_load_dword v91, v5, s[24:27], s64 offen
    s_movk_i32 s64, 3072
    buffer_load_dword v67, v5, s[12:15], s64 offen
    buffer_load_dword v92, v5, s[24:27], s64 offen
    s_movk_i32 s64, 4096
    buffer_load_dword v68, v5, s[12:15], s64 offen
    buffer_load_dword v93, v5, s[24:27], s64 offen
    s_movk_i32 s64, 5120
    buffer_load_dword v69, v5, s[12:15], s64 offen
    buffer_load_dword v94, v5, s[24:27], s64 offen
    s_movk_i32 s64, 6144
    buffer_load_dword v70, v5, s[12:15], s64 offen
    buffer_load_dword v95, v5, s[24:27], s64 offen
    s_movk_i32 s64, 7168
    buffer_load_dword v71, v5, s[12:15], s64 offen
    buffer_load_dword v96, v5, s[24:27], s64 offen
    s_movk_i32 s64, 8192
    buffer_load_dword v72, v5, s[12:15], s64 offen
    buffer_load_dword v97, v5, s[24:27], s64 offen
    s_movk_i32 s64, 9216
    buffer_load_dword v73, v5, s[12:15], s64 offen
    buffer_load_dword v98, v5, s[24:27], s64 offen
    s_movk_i32 s64, 10240
    buffer_load_dword v74, v5, s[12:15], s64 offen
    buffer_load_dword v99, v5, s[24:27], s64 offen
    s_movk_i32 s64, 11264
    buffer_load_dword v75, v5, s[12:15], s64 offen
    buffer_load_dword v100, v5, s[24:27], s64 offen
    s_movk_i32 s64, 12288
    buffer_load_dword v76, v5, s[12:15], s64 offen
    buffer_load_dword v101, v5, s[24:27], s64 offen
    s_movk_i32 s64, 13312
    buffer_load_dword v77, v5, s[12:15], s64 offen
    buffer_load_dword v102, v5, s[24:27], s64 offen
    s_movk_i32 s64, 14336
    buffer_load_dword v78, v5, s[12:15], s64 offen
    buffer_load_dword v103, v5, s[24:27], s64 offen
    s_movk_i32 s64, 15360
    buffer_load_dword v79, v5, s[12:15], s64 offen
    buffer_load_dword v104, v5, s[24:27], s64 offen
    s_movk_i32 s64, 16384
    buffer_load_dword v80, v5, s[12:15], s64 offen
    buffer_load_dword v105, v5, s[24:27], s64 offen
    s_movk_i32 s64, 17408
    buffer_load_dword v81, v5, s[12:15], s64 offen
    buffer_load_dword v106, v5, s[24:27], s64 offen
    s_movk_i32 s64, 18432
    buffer_load_dword v82, v5, s[12:15], s64 offen
    buffer_load_dword v107, v5, s[24:27], s64 offen
    s_movk_i32 s64, 19456
    buffer_load_dword v83, v5, s[12:15], s64 offen
    buffer_load_dword v108, v5, s[24:27], s64 offen
    s_movk_i32 s64, 20480
    buffer_load_dword v84, v5, s[12:15], s64 offen
    buffer_load_dword v109, v5, s[24:27], s64 offen
    s_movk_i32 s64, 21504
    buffer_load_dword v85, v5, s[12:15], s64 offen
    buffer_load_dword v110, v5, s[24:27], s64 offen
    s_movk_i32 s64, 22528
    buffer_load_dword v86, v5, s[12:15], s64 offen
    buffer_load_dword v111, v5, s[24:27], s64 offen
    s_movk_i32 s64, 23552
    buffer_load_dword v87, v5, s[12:15], s64 offen
    buffer_load_dword v112, v5, s[24:27], s64 offen
    s_movk_i32 s64, 24576
    buffer_load_dword v88, v5, s[12:15], s64 offen
    buffer_load_dword v113, v5, s[24:27], s64 offen
    s_waitcnt vmcnt(50)
    v_mov_b32 v11, 0
    v_mov_b32 v12, 0
    v_mov_b32 v15, 0x3f803f80
    s_nop 0
    v_dot2c_f32_bf16 v11, v136, v15
    v_dot2c_f32_bf16 v12, v136, v136
    v_dot2c_f32_bf16 v11, v137, v15
    v_dot2c_f32_bf16 v12, v137, v137
    v_dot2c_f32_bf16 v11, v138, v15
    v_dot2c_f32_bf16 v12, v138, v138
    v_dot2c_f32_bf16 v11, v139, v15
    v_dot2c_f32_bf16 v12, v139, v139
    v_dot2c_f32_bf16 v11, v140, v15
    v_dot2c_f32_bf16 v12, v140, v140
    v_dot2c_f32_bf16 v11, v141, v15
    v_dot2c_f32_bf16 v12, v141, v141
    v_dot2c_f32_bf16 v11, v142, v15
    v_dot2c_f32_bf16 v12, v142, v142
    v_dot2c_f32_bf16 v11, v143, v15
    v_dot2c_f32_bf16 v12, v143, v143
    v_dot2c_f32_bf16 v11, v144, v15
    v_dot2c_f32_bf16 v12, v144, v144
    v_dot2c_f32_bf16 v11, v145, v15
    v_dot2c_f32_bf16 v12, v145, v145
    v_dot2c_f32_bf16 v11, v146, v15
    v_dot2c_f32_bf16 v12, v146, v146
    v_dot2c_f32_bf16 v11, v147, v15
    v_dot2c_f32_bf16 v12, v147, v147
    v_dot2c_f32_bf16 v11, v148, v15
    v_dot2c_f32_bf16 v12, v148, v148
    v_dot2c_f32_bf16 v11, v149, v15
    v_dot2c_f32_bf16 v12, v149, v149
    v_dot2c_f32_bf16 v11, v150, v15
    v_dot2c_f32_bf16 v12, v150, v150
    v_dot2c_f32_bf16 v11, v151, v15
    v_dot2c_f32_bf16 v12, v151, v151
    v_dot2c_f32_bf16 v11, v152, v15
    v_dot2c_f32_bf16 v12, v152, v152
    v_dot2c_f32_bf16 v11, v153, v15
    v_dot2c_f32_bf16 v12, v153, v153
    v_dot2c_f32_bf16 v11, v154, v15
    v_dot2c_f32_bf16 v12, v154, v154
    v_dot2c_f32_bf16 v11, v155, v15
    v_dot2c_f32_bf16 v12, v155, v155
    v_dot2c_f32_bf16 v11, v156, v15
    v_dot2c_f32_bf16 v12, v156, v156
    v_dot2c_f32_bf16 v11, v157, v15
    v_dot2c_f32_bf16 v12, v157, v157
    v_dot2c_f32_bf16 v11, v158, v15
    v_dot2c_f32_bf16 v12, v158, v158
    v_dot2c_f32_bf16 v11, v159, v15
    v_dot2c_f32_bf16 v12, v159, v159
    v_dot2c_f32_bf16 v11, v160, v15
    v_dot2c_f32_bf16 v12, v160, v160
    v_dot2c_f32_bf16 v11, v161, v15
    v_dot2c_f32_bf16 v12, v161, v161
    v_dot2c_f32_bf16 v11, v162, v15
    v_dot2c_f32_bf16 v12, v162, v162
    v_dot2c_f32_bf16 v11, v163, v15
    v_dot2c_f32_bf16 v12, v163, v163
    v_dot2c_f32_bf16 v11, v164, v15
    v_dot2c_f32_bf16 v12, v164, v164
    v_dot2c_f32_bf16 v11, v165, v15
    v_dot2c_f32_bf16 v12, v165, v165
    v_dot2c_f32_bf16 v11, v166, v15
    v_dot2c_f32_bf16 v12, v166, v166
    v_dot2c_f32_bf16 v11, v167, v15
    v_dot2c_f32_bf16 v12, v167, v167
    v_dot2c_f32_bf16 v11, v168, v15
    v_dot2c_f32_bf16 v12, v168, v168
    v_dot2c_f32_bf16 v11, v169, v15
    v_dot2c_f32_bf16 v12, v169, v169
    v_dot2c_f32_bf16 v11, v170, v15
    v_dot2c_f32_bf16 v12, v170, v170
    v_dot2c_f32_bf16 v11, v171, v15
    v_dot2c_f32_bf16 v12, v171, v171
    v_dot2c_f32_bf16 v11, v172, v15
    v_dot2c_f32_bf16 v12, v172, v172
    v_dot2c_f32_bf16 v11, v173, v15
    v_dot2c_f32_bf16 v12, v173, v173
    v_dot2c_f32_bf16 v11, v174, v15
    v_dot2c_f32_bf16 v12, v174, v174
    v_dot2c_f32_bf16 v11, v175, v15
    v_dot2c_f32_bf16 v12, v175, v175
    v_dot2c_f32_bf16 v11, v176, v15
    v_dot2c_f32_bf16 v12, v176, v176
    v_dot2c_f32_bf16 v11, v177, v15
    v_dot2c_f32_bf16 v12, v177, v177
    v_dot2c_f32_bf16 v11, v178, v15
    v_dot2c_f32_bf16 v12, v178, v178
    v_dot2c_f32_bf16 v11, v179, v15
    v_dot2c_f32_bf16 v12, v179, v179
    v_dot2c_f32_bf16 v11, v180, v15
    v_dot2c_f32_bf16 v12, v180, v180
    v_dot2c_f32_bf16 v11, v181, v15
    v_dot2c_f32_bf16 v12, v181, v181
    v_dot2c_f32_bf16 v11, v182, v15
    v_dot2c_f32_bf16 v12, v182, v182
    v_dot2c_f32_bf16 v11, v183, v15
    v_dot2c_f32_bf16 v12, v183, v183
    v_dot2c_f32_bf16 v11, v184, v15
    v_dot2c_f32_bf16 v12, v184, v184
    v_dot2c_f32_bf16 v11, v185, v15
    v_dot2c_f32_bf16 v12, v185, v185
    v_dot2c_f32_bf16 v11, v186, v15
    v_dot2c_f32_bf16 v12, v186, v186
    v_dot2c_f32_bf16 v11, v187, v15
    v_dot2c_f32_bf16 v12, v187, v187
    v_dot2c_f32_bf16 v11, v188, v15
    v_dot2c_f32_bf16 v12, v188, v188
    v_dot2c_f32_bf16 v11, v189, v15
    v_dot2c_f32_bf16 v12, v189, v189
    v_dot2c_f32_bf16 v11, v190, v15
    v_dot2c_f32_bf16 v12, v190, v190
    v_dot2c_f32_bf16 v11, v191, v15
    v_dot2c_f32_bf16 v12, v191, v191
    v_dot2c_f32_bf16 v11, v192, v15
    v_dot2c_f32_bf16 v12, v192, v192
    v_dot2c_f32_bf16 v11, v193, v15
    v_dot2c_f32_bf16 v12, v193, v193
    v_dot2c_f32_bf16 v11, v194, v15
    v_dot2c_f32_bf16 v12, v194, v194
    v_dot2c_f32_bf16 v11, v195, v15
    v_dot2c_f32_bf16 v12, v195, v195
    v_dot2c_f32_bf16 v11, v196, v15
    v_dot2c_f32_bf16 v12, v196, v196
    v_dot2c_f32_bf16 v11, v197, v15
    v_dot2c_f32_bf16 v12, v197, v197
    v_dot2c_f32_bf16 v11, v198, v15
    v_dot2c_f32_bf16 v12, v198, v198
    v_dot2c_f32_bf16 v11, v199, v15
    v_dot2c_f32_bf16 v12, v199, v199
    v_dot2c_f32_bf16 v11, v200, v15
    v_dot2c_f32_bf16 v12, v200, v200
    v_dot2c_f32_bf16 v11, v201, v15
    v_dot2c_f32_bf16 v12, v201, v201
    v_dot2c_f32_bf16 v11, v202, v15
    v_dot2c_f32_bf16 v12, v202, v202
    v_dot2c_f32_bf16 v11, v203, v15
    v_dot2c_f32_bf16 v12, v203, v203
    v_dot2c_f32_bf16 v11, v204, v15
    v_dot2c_f32_bf16 v12, v204, v204
    v_dot2c_f32_bf16 v11, v205, v15
    v_dot2c_f32_bf16 v12, v205, v205
    v_dot2c_f32_bf16 v11, v206, v15
    v_dot2c_f32_bf16 v12, v206, v206
    v_dot2c_f32_bf16 v11, v207, v15
    v_dot2c_f32_bf16 v12, v207, v207
    v_dot2c_f32_bf16 v11, v208, v15
    v_dot2c_f32_bf16 v12, v208, v208
    v_dot2c_f32_bf16 v11, v209, v15
    v_dot2c_f32_bf16 v12, v209, v209
    v_dot2c_f32_bf16 v11, v210, v15
    v_dot2c_f32_bf16 v12, v210, v210
    v_dot2c_f32_bf16 v11, v211, v15
    v_dot2c_f32_bf16 v12, v211, v211
    v_dot2c_f32_bf16 v11, v212, v15
    v_dot2c_f32_bf16 v12, v212, v212
    v_dot2c_f32_bf16 v11, v213, v15
    v_dot2c_f32_bf16 v12, v213, v213
    v_dot2c_f32_bf16 v11, v214, v15
    v_dot2c_f32_bf16 v12, v214, v214
    v_dot2c_f32_bf16 v11, v215, v15
    v_dot2c_f32_bf16 v12, v215, v215
    s_nop 3
    ds_swizzle_b32 v3, v11 offset:0x401F
    s_waitcnt lgkmcnt(0)
    v_add_f32 v11, v11, v3
    s_nop 0
    ds_bpermute_b32 v3, v17, v11
    s_waitcnt lgkmcnt(0)
    v_add_f32 v11, v11, v3
    ds_swizzle_b32 v3, v12 offset:0x401F
    s_waitcnt lgkmcnt(0)
    v_add_f32 v12, v12, v3
    s_nop 0
    ds_bpermute_b32 v3, v17, v12
    s_waitcnt lgkmcnt(0)
    v_add_f32 v12, v12, v3
    v_mul_f32 v11, 0x3acccccd, v11
    v_mul_f32 v12, 0x3acccccd, v12
    v_fma_f32 v12, -v11, v11, v12
    v_max_f32 v12, 0, v12
    v_add_f32 v12, 0x3727c5ac, v12
    v_rsq_f32 v13, v12
    s_nop 0
    v_mul_f32 v14, v11, v13
    v_sub_f32 v14, 0, v14
    v_lshlrev_b32 v3, 16, v136
    v_and_b32 v4, 0xffff0000, v136
    v_fma_f32 v3, v3, v13, v14
    v_fma_f32 v4, v4, v13, v14
    v_cvt_pk_bf16_f32 v136, v3, v4
    v_lshlrev_b32 v5, 16, v137
    v_and_b32 v6, 0xffff0000, v137
    v_fma_f32 v5, v5, v13, v14
    v_fma_f32 v6, v6, v13, v14
    v_cvt_pk_bf16_f32 v137, v5, v6
    v_lshlrev_b32 v3, 16, v138
    v_and_b32 v4, 0xffff0000, v138
    v_fma_f32 v3, v3, v13, v14
    v_fma_f32 v4, v4, v13, v14
    v_cvt_pk_bf16_f32 v138, v3, v4
    v_lshlrev_b32 v5, 16, v139
    v_and_b32 v6, 0xffff0000, v139
    v_fma_f32 v5, v5, v13, v14
    v_fma_f32 v6, v6, v13, v14
    v_cvt_pk_bf16_f32 v139, v5, v6
    v_lshlrev_b32 v3, 16, v140
    v_and_b32 v4, 0xffff0000, v140
    v_fma_f32 v3, v3, v13, v14
    v_fma_f32 v4, v4, v13, v14
    v_cvt_pk_bf16_f32 v140, v3, v4
    v_lshlrev_b32 v5, 16, v141
    v_and_b32 v6, 0xffff0000, v141
    v_fma_f32 v5, v5, v13, v14
    v_fma_f32 v6, v6, v13, v14
    v_cvt_pk_bf16_f32 v141, v5, v6
    v_lshlrev_b32 v3, 16, v142
    v_and_b32 v4, 0xffff0000, v142
    v_fma_f32 v3, v3, v13, v14
    v_fma_f32 v4, v4, v13, v14
    v_cvt_pk_bf16_f32 v142, v3, v4
    v_lshlrev_b32 v5, 16, v143
    v_and_b32 v6, 0xffff0000, v143
    v_fma_f32 v5, v5, v13, v14
    v_fma_f32 v6, v6, v13, v14
    v_cvt_pk_bf16_f32 v143, v5, v6
    v_lshlrev_b32 v3, 16, v144
    v_and_b32 v4, 0xffff0000, v144
    v_fma_f32 v3, v3, v13, v14
    v_fma_f32 v4, v4, v13, v14
    v_cvt_pk_bf16_f32 v144, v3, v4
    v_lshlrev_b32 v5, 16, v145
    v_and_b32 v6, 0xffff0000, v145
    v_fma_f32 v5, v5, v13, v14
    v_fma_f32 v6, v6, v13, v14
    v_cvt_pk_bf16_f32 v145, v5, v6
    v_lshlrev_b32 v3, 16, v146
    v_and_b32 v4, 0xffff0000, v146
    v_fma_f32 v3, v3, v13, v14
    v_fma_f32 v4, v4, v13, v14
    v_cvt_pk_bf16_f32 v146, v3, v4
    v_lshlrev_b32 v5, 16, v147
    v_and_b32 v6, 0xffff0000, v147
    v_fma_f32 v5, v5, v13, v14
    v_fma_f32 v6, v6, v13, v14
    v_cvt_pk_bf16_f32 v147, v5, v6
    v_lshlrev_b32 v3, 16, v148
    v_and_b32 v4, 0xffff0000, v148
    v_fma_f32 v3, v3, v13, v14
    v_fma_f32 v4, v4, v13, v14
    v_cvt_pk_bf16_f32 v148, v3, v4
    v_lshlrev_b32 v5, 16, v149
    v_and_b32 v6, 0xffff0000, v149
    v_fma_f32 v5, v5, v13, v14
    v_fma_f32 v6, v6, v13, v14
    v_cvt_pk_bf16_f32 v149, v5, v6
    v_lshlrev_b32 v3, 16, v150
    v_and_b32 v4, 0xffff0000, v150
    v_fma_f32 v3, v3, v13, v14
    v_fma_f32 v4, v4, v13, v14
    v_cvt_pk_bf16_f32 v150, v3, v4
    v_lshlrev_b32 v5, 16, v151
    v_and_b32 v6, 0xffff0000, v151
    v_fma_f32 v5, v5, v13, v14
    v_fma_f32 v6, v6, v13, v14
    v_cvt_pk_bf16_f32 v151, v5, v6
    v_lshlrev_b32 v3, 16, v152
    v_and_b32 v4, 0xffff0000, v152
    v_fma_f32 v3, v3, v13, v14
    v_fma_f32 v4, v4, v13, v14
    v_cvt_pk_bf16_f32 v152, v3, v4
    v_lshlrev_b32 v5, 16, v153
    v_and_b32 v6, 0xffff0000, v153
    v_fma_f32 v5, v5, v13, v14
    v_fma_f32 v6, v6, v13, v14
    v_cvt_pk_bf16_f32 v153, v5, v6
    v_lshlrev_b32 v3, 16, v154
    v_and_b32 v4, 0xffff0000, v154
    v_fma_f32 v3, v3, v13, v14
    v_fma_f32 v4, v4, v13, v14
    v_cvt_pk_bf16_f32 v154, v3, v4
    v_lshlrev_b32 v5, 16, v155
    v_and_b32 v6, 0xffff0000, v155
    v_fma_f32 v5, v5, v13, v14
    v_fma_f32 v6, v6, v13, v14
    v_cvt_pk_bf16_f32 v155, v5, v6
    v_lshlrev_b32 v3, 16, v156
    v_and_b32 v4, 0xffff0000, v156
    v_fma_f32 v3, v3, v13, v14
    v_fma_f32 v4, v4, v13, v14
    v_cvt_pk_bf16_f32 v156, v3, v4
    v_lshlrev_b32 v5, 16, v157
    v_and_b32 v6, 0xffff0000, v157
    v_fma_f32 v5, v5, v13, v14
    v_fma_f32 v6, v6, v13, v14
    v_cvt_pk_bf16_f32 v157, v5, v6
    v_lshlrev_b32 v3, 16, v158
    v_and_b32 v4, 0xffff0000, v158
    v_fma_f32 v3, v3, v13, v14
    v_fma_f32 v4, v4, v13, v14
    v_cvt_pk_bf16_f32 v158, v3, v4
    v_lshlrev_b32 v5, 16, v159
    v_and_b32 v6, 0xffff0000, v159
    v_fma_f32 v5, v5, v13, v14
    v_fma_f32 v6, v6, v13, v14
    v_cvt_pk_bf16_f32 v159, v5, v6
    v_lshlrev_b32 v3, 16, v160
    v_and_b32 v4, 0xffff0000, v160
    v_fma_f32 v3, v3, v13, v14
    v_fma_f32 v4, v4, v13, v14
    v_cvt_pk_bf16_f32 v160, v3, v4
    v_lshlrev_b32 v5, 16, v161
    v_and_b32 v6, 0xffff0000, v161
    v_fma_f32 v5, v5, v13, v14
    v_fma_f32 v6, v6, v13, v14
    v_cvt_pk_bf16_f32 v161, v5, v6
    v_lshlrev_b32 v3, 16, v162
    v_and_b32 v4, 0xffff0000, v162
    v_fma_f32 v3, v3, v13, v14
    v_fma_f32 v4, v4, v13, v14
    v_cvt_pk_bf16_f32 v162, v3, v4
    v_lshlrev_b32 v5, 16, v163
    v_and_b32 v6, 0xffff0000, v163
    v_fma_f32 v5, v5, v13, v14
    v_fma_f32 v6, v6, v13, v14
    v_cvt_pk_bf16_f32 v163, v5, v6
    v_lshlrev_b32 v3, 16, v164
    v_and_b32 v4, 0xffff0000, v164
    v_fma_f32 v3, v3, v13, v14
    v_fma_f32 v4, v4, v13, v14
    v_cvt_pk_bf16_f32 v164, v3, v4
    v_lshlrev_b32 v5, 16, v165
    v_and_b32 v6, 0xffff0000, v165
    v_fma_f32 v5, v5, v13, v14
    v_fma_f32 v6, v6, v13, v14
    v_cvt_pk_bf16_f32 v165, v5, v6
    v_lshlrev_b32 v3, 16, v166
    v_and_b32 v4, 0xffff0000, v166
    v_fma_f32 v3, v3, v13, v14
    v_fma_f32 v4, v4, v13, v14
    v_cvt_pk_bf16_f32 v166, v3, v4
    v_lshlrev_b32 v5, 16, v167
    v_and_b32 v6, 0xffff0000, v167
    v_fma_f32 v5, v5, v13, v14
    v_fma_f32 v6, v6, v13, v14
    v_cvt_pk_bf16_f32 v167, v5, v6
    v_lshlrev_b32 v3, 16, v168
    v_and_b32 v4, 0xffff0000, v168
    v_fma_f32 v3, v3, v13, v14
    v_fma_f32 v4, v4, v13, v14
    v_cvt_pk_bf16_f32 v168, v3, v4
    v_lshlrev_b32 v5, 16, v169
    v_and_b32 v6, 0xffff0000, v169
    v_fma_f32 v5, v5, v13, v14
    v_fma_f32 v6, v6, v13, v14
    v_cvt_pk_bf16_f32 v169, v5, v6
    v_lshlrev_b32 v3, 16, v170
    v_and_b32 v4, 0xffff0000, v170
    v_fma_f32 v3, v3, v13, v14
    v_fma_f32 v4, v4, v13, v14
    v_cvt_pk_bf16_f32 v170, v3, v4
    v_lshlrev_b32 v5, 16, v171
    v_and_b32 v6, 0xffff0000, v171
    v_fma_f32 v5, v5, v13, v14
    v_fma_f32 v6, v6, v13, v14
    v_cvt_pk_bf16_f32 v171, v5, v6
    v_lshlrev_b32 v3, 16, v172
    v_and_b32 v4, 0xffff0000, v172
    v_fma_f32 v3, v3, v13, v14
    v_fma_f32 v4, v4, v13, v14
    v_cvt_pk_bf16_f32 v172, v3, v4
    v_lshlrev_b32 v5, 16, v173
    v_and_b32 v6, 0xffff0000, v173
    v_fma_f32 v5, v5, v13, v14
    v_fma_f32 v6, v6, v13, v14
    v_cvt_pk_bf16_f32 v173, v5, v6
    v_lshlrev_b32 v3, 16, v174
    v_and_b32 v4, 0xffff0000, v174
    v_fma_f32 v3, v3, v13, v14
    v_fma_f32 v4, v4, v13, v14
    v_cvt_pk_bf16_f32 v174, v3, v4
    v_lshlrev_b32 v5, 16, v175
    v_and_b32 v6, 0xffff0000, v175
    v_fma_f32 v5, v5, v13, v14
    v_fma_f32 v6, v6, v13, v14
    v_cvt_pk_bf16_f32 v175, v5, v6
    v_lshlrev_b32 v3, 16, v176
    v_and_b32 v4, 0xffff0000, v176
    v_fma_f32 v3, v3, v13, v14
    v_fma_f32 v4, v4, v13, v14
    v_cvt_pk_bf16_f32 v176, v3, v4
    v_lshlrev_b32 v5, 16, v177
    v_and_b32 v6, 0xffff0000, v177
    v_fma_f32 v5, v5, v13, v14
    v_fma_f32 v6, v6, v13, v14
    v_cvt_pk_bf16_f32 v177, v5, v6
    v_lshlrev_b32 v3, 16, v178
    v_and_b32 v4, 0xffff0000, v178
    v_fma_f32 v3, v3, v13, v14
    v_fma_f32 v4, v4, v13, v14
    v_cvt_pk_bf16_f32 v178, v3, v4
    v_lshlrev_b32 v5, 16, v179
    v_and_b32 v6, 0xffff0000, v179
    v_fma_f32 v5, v5, v13, v14
    v_fma_f32 v6, v6, v13, v14
    v_cvt_pk_bf16_f32 v179, v5, v6
    v_lshlrev_b32 v3, 16, v180
    v_and_b32 v4, 0xffff0000, v180
    v_fma_f32 v3, v3, v13, v14
    v_fma_f32 v4, v4, v13, v14
    v_cvt_pk_bf16_f32 v180, v3, v4
    v_lshlrev_b32 v5, 16, v181
    v_and_b32 v6, 0xffff0000, v181
    v_fma_f32 v5, v5, v13, v14
    v_fma_f32 v6, v6, v13, v14
    v_cvt_pk_bf16_f32 v181, v5, v6
    v_lshlrev_b32 v3, 16, v182
    v_and_b32 v4, 0xffff0000, v182
    v_fma_f32 v3, v3, v13, v14
    v_fma_f32 v4, v4, v13, v14
    v_cvt_pk_bf16_f32 v182, v3, v4
    v_lshlrev_b32 v5, 16, v183
    v_and_b32 v6, 0xffff0000, v183
    v_fma_f32 v5, v5, v13, v14
    v_fma_f32 v6, v6, v13, v14
    v_cvt_pk_bf16_f32 v183, v5, v6
    v_lshlrev_b32 v3, 16, v184
    v_and_b32 v4, 0xffff0000, v184
    v_fma_f32 v3, v3, v13, v14
    v_fma_f32 v4, v4, v13, v14
    v_cvt_pk_bf16_f32 v184, v3, v4
    v_lshlrev_b32 v5, 16, v185
    v_and_b32 v6, 0xffff0000, v185
    v_fma_f32 v5, v5, v13, v14
    v_fma_f32 v6, v6, v13, v14
    v_cvt_pk_bf16_f32 v185, v5, v6
    v_lshlrev_b32 v3, 16, v186
    v_and_b32 v4, 0xffff0000, v186
    v_fma_f32 v3, v3, v13, v14
    v_fma_f32 v4, v4, v13, v14
    v_cvt_pk_bf16_f32 v186, v3, v4
    v_lshlrev_b32 v5, 16, v187
    v_and_b32 v6, 0xffff0000, v187
    v_fma_f32 v5, v5, v13, v14
    v_fma_f32 v6, v6, v13, v14
    v_cvt_pk_bf16_f32 v187, v5, v6
    v_lshlrev_b32 v3, 16, v188
    v_and_b32 v4, 0xffff0000, v188
    v_fma_f32 v3, v3, v13, v14
    v_fma_f32 v4, v4, v13, v14
    v_cvt_pk_bf16_f32 v188, v3, v4
    v_lshlrev_b32 v5, 16, v189
    v_and_b32 v6, 0xffff0000, v189
    v_fma_f32 v5, v5, v13, v14
    v_fma_f32 v6, v6, v13, v14
    v_cvt_pk_bf16_f32 v189, v5, v6
    v_lshlrev_b32 v3, 16, v190
    v_and_b32 v4, 0xffff0000, v190
    v_fma_f32 v3, v3, v13, v14
    v_fma_f32 v4, v4, v13, v14
    v_cvt_pk_bf16_f32 v190, v3, v4
    v_lshlrev_b32 v5, 16, v191
    v_and_b32 v6, 0xffff0000, v191
    v_fma_f32 v5, v5, v13, v14
    v_fma_f32 v6, v6, v13, v14
    v_cvt_pk_bf16_f32 v191, v5, v6
    v_lshlrev_b32 v3, 16, v192
    v_and_b32 v4, 0xffff0000, v192
    v_fma_f32 v3, v3, v13, v14
    v_fma_f32 v4, v4, v13, v14
    v_cvt_pk_bf16_f32 v192, v3, v4
    v_lshlrev_b32 v5, 16, v193
    v_and_b32 v6, 0xffff0000, v193
    v_fma_f32 v5, v5, v13, v14
    v_fma_f32 v6, v6, v13, v14
    v_cvt_pk_bf16_f32 v193, v5, v6
    v_lshlrev_b32 v3, 16, v194
    v_and_b32 v4, 0xffff0000, v194
    v_fma_f32 v3, v3, v13, v14
    v_fma_f32 v4, v4, v13, v14
    v_cvt_pk_bf16_f32 v194, v3, v4
    v_lshlrev_b32 v5, 16, v195
    v_and_b32 v6, 0xffff0000, v195
    v_fma_f32 v5, v5, v13, v14
    v_fma_f32 v6, v6, v13, v14
    v_cvt_pk_bf16_f32 v195, v5, v6
    v_lshlrev_b32 v3, 16, v196
    v_and_b32 v4, 0xffff0000, v196
    v_fma_f32 v3, v3, v13, v14
    v_fma_f32 v4, v4, v13, v14
    v_cvt_pk_bf16_f32 v196, v3, v4
    v_lshlrev_b32 v5, 16, v197
    v_and_b32 v6, 0xffff0000, v197
    v_fma_f32 v5, v5, v13, v14
    v_fma_f32 v6, v6, v13, v14
    v_cvt_pk_bf16_f32 v197, v5, v6
    v_lshlrev_b32 v3, 16, v198
    v_and_b32 v4, 0xffff0000, v198
    v_fma_f32 v3, v3, v13, v14
    v_fma_f32 v4, v4, v13, v14
    v_cvt_pk_bf16_f32 v198, v3, v4
    v_lshlrev_b32 v5, 16, v199
    v_and_b32 v6, 0xffff0000, v199
    v_fma_f32 v5, v5, v13, v14
    v_fma_f32 v6, v6, v13, v14
    v_cvt_pk_bf16_f32 v199, v5, v6
    v_lshlrev_b32 v3, 16, v200
    v_and_b32 v4, 0xffff0000, v200
    v_fma_f32 v3, v3, v13, v14
    v_fma_f32 v4, v4, v13, v14
    v_cvt_pk_bf16_f32 v200, v3, v4
    v_lshlrev_b32 v5, 16, v201
    v_and_b32 v6, 0xffff0000, v201
    v_fma_f32 v5, v5, v13, v14
    v_fma_f32 v6, v6, v13, v14
    v_cvt_pk_bf16_f32 v201, v5, v6
    v_lshlrev_b32 v3, 16, v202
    v_and_b32 v4, 0xffff0000, v202
    v_fma_f32 v3, v3, v13, v14
    v_fma_f32 v4, v4, v13, v14
    v_cvt_pk_bf16_f32 v202, v3, v4
    v_lshlrev_b32 v5, 16, v203
    v_and_b32 v6, 0xffff0000, v203
    v_fma_f32 v5, v5, v13, v14
    v_fma_f32 v6, v6, v13, v14
    v_cvt_pk_bf16_f32 v203, v5, v6
    v_lshlrev_b32 v3, 16, v204
    v_and_b32 v4, 0xffff0000, v204
    v_fma_f32 v3, v3, v13, v14
    v_fma_f32 v4, v4, v13, v14
    v_cvt_pk_bf16_f32 v204, v3, v4
    v_lshlrev_b32 v5, 16, v205
    v_and_b32 v6, 0xffff0000, v205
    v_fma_f32 v5, v5, v13, v14
    v_fma_f32 v6, v6, v13, v14
    v_cvt_pk_bf16_f32 v205, v5, v6
    v_lshlrev_b32 v3, 16, v206
    v_and_b32 v4, 0xffff0000, v206
    v_fma_f32 v3, v3, v13, v14
    v_fma_f32 v4, v4, v13, v14
    v_cvt_pk_bf16_f32 v206, v3, v4
    v_lshlrev_b32 v5, 16, v207
    v_and_b32 v6, 0xffff0000, v207
    v_fma_f32 v5, v5, v13, v14
    v_fma_f32 v6, v6, v13, v14
    v_cvt_pk_bf16_f32 v207, v5, v6
    v_lshlrev_b32 v3, 16, v208
    v_and_b32 v4, 0xffff0000, v208
    v_fma_f32 v3, v3, v13, v14
    v_fma_f32 v4, v4, v13, v14
    v_cvt_pk_bf16_f32 v208, v3, v4
    v_lshlrev_b32 v5, 16, v209
    v_and_b32 v6, 0xffff0000, v209
    v_fma_f32 v5, v5, v13, v14
    v_fma_f32 v6, v6, v13, v14
    v_cvt_pk_bf16_f32 v209, v5, v6
    v_lshlrev_b32 v3, 16, v210
    v_and_b32 v4, 0xffff0000, v210
    v_fma_f32 v3, v3, v13, v14
    v_fma_f32 v4, v4, v13, v14
    v_cvt_pk_bf16_f32 v210, v3, v4
    v_lshlrev_b32 v5, 16, v211
    v_and_b32 v6, 0xffff0000, v211
    v_fma_f32 v5, v5, v13, v14
    v_fma_f32 v6, v6, v13, v14
    v_cvt_pk_bf16_f32 v211, v5, v6
    v_lshlrev_b32 v3, 16, v212
    v_and_b32 v4, 0xffff0000, v212
    v_fma_f32 v3, v3, v13, v14
    v_fma_f32 v4, v4, v13, v14
    v_cvt_pk_bf16_f32 v212, v3, v4
    v_lshlrev_b32 v5, 16, v213
    v_and_b32 v6, 0xffff0000, v213
    v_fma_f32 v5, v5, v13, v14
    v_fma_f32 v6, v6, v13, v14
    v_cvt_pk_bf16_f32 v213, v5, v6
    v_lshlrev_b32 v3, 16, v214
    v_and_b32 v4, 0xffff0000, v214
    v_fma_f32 v3, v3, v13, v14
    v_fma_f32 v4, v4, v13, v14
    v_cvt_pk_bf16_f32 v214, v3, v4
    v_lshlrev_b32 v5, 16, v215
    v_and_b32 v6, 0xffff0000, v215
    v_fma_f32 v5, v5, v13, v14
    v_fma_f32 v6, v6, v13, v14
    v_cvt_pk_bf16_f32 v215, v5, v6
    s_waitcnt vmcnt(0) lgkmcnt(0)
    s_barrier
    v_add_u32 v4, 0, v0
    v_mul_u32_u24 v5, 6554, v4
    v_lshrrev_b32 v5, 16, v5
    v_mul_u32_u24 v6, 10, v5
    v_sub_u32 v6, v4, v6
    v_lshlrev_b32 v5, 7, v5
    v_lshl_add_u32 v5, v6, 2, v5
    ds_write_b32 v5, v64
    ds_write_b32 v5, v89 offset:64
    v_add_u32 v4, 256, v0
    v_mul_u32_u24 v5, 6554, v4
    v_lshrrev_b32 v5, 16, v5
    v_mul_u32_u24 v6, 10, v5
    v_sub_u32 v6, v4, v6
    v_lshlrev_b32 v5, 7, v5
    v_lshl_add_u32 v5, v6, 2, v5
    ds_write_b32 v5, v65
    ds_write_b32 v5, v90 offset:64
    v_add_u32 v4, 512, v0
    v_mul_u32_u24 v5, 6554, v4
    v_lshrrev_b32 v5, 16, v5
    v_mul_u32_u24 v6, 10, v5
    v_sub_u32 v6, v4, v6
    v_lshlrev_b32 v5, 7, v5
    v_lshl_add_u32 v5, v6, 2, v5
    ds_write_b32 v5, v66
    ds_write_b32 v5, v91 offset:64
    v_add_u32 v4, 768, v0
    v_mul_u32_u24 v5, 6554, v4
    v_lshrrev_b32 v5, 16, v5
    v_mul_u32_u24 v6, 10, v5
    v_sub_u32 v6, v4, v6
    v_lshlrev_b32 v5, 7, v5
    v_lshl_add_u32 v5, v6, 2, v5
    ds_write_b32 v5, v67
    ds_write_b32 v5, v92 offset:64
    v_add_u32 v4, 1024, v0
    v_mul_u32_u24 v5, 6554, v4
    v_lshrrev_b32 v5, 16, v5
    v_mul_u32_u24 v6, 10, v5
    v_sub_u32 v6, v4, v6
    v_lshlrev_b32 v5, 7, v5
    v_lshl_add_u32 v5, v6, 2, v5
    ds_write_b32 v5, v68
    ds_write_b32 v5, v93 offset:64
    v_add_u32 v4, 1280, v0
    v_mul_u32_u24 v5, 6554, v4
    v_lshrrev_b32 v5, 16, v5
    v_mul_u32_u24 v6, 10, v5
    v_sub_u32 v6, v4, v6
    v_lshlrev_b32 v5, 7, v5
    v_lshl_add_u32 v5, v6, 2, v5
    ds_write_b32 v5, v69
    ds_write_b32 v5, v94 offset:64
    v_add_u32 v4, 1536, v0
    v_mul_u32_u24 v5, 6554, v4
    v_lshrrev_b32 v5, 16, v5
    v_mul_u32_u24 v6, 10, v5
    v_sub_u32 v6, v4, v6
    v_lshlrev_b32 v5, 7, v5
    v_lshl_add_u32 v5, v6, 2, v5
    ds_write_b32 v5, v70
    ds_write_b32 v5, v95 offset:64
    v_add_u32 v4, 1792, v0
    v_mul_u32_u24 v5, 6554, v4
    v_lshrrev_b32 v5, 16, v5
    v_mul_u32_u24 v6, 10, v5
    v_sub_u32 v6, v4, v6
    v_lshlrev_b32 v5, 7, v5
    v_lshl_add_u32 v5, v6, 2, v5
    ds_write_b32 v5, v71
    ds_write_b32 v5, v96 offset:64
    v_add_u32 v4, 2048, v0
    v_mul_u32_u24 v5, 6554, v4
    v_lshrrev_b32 v5, 16, v5
    v_mul_u32_u24 v6, 10, v5
    v_sub_u32 v6, v4, v6
    v_lshlrev_b32 v5, 7, v5
    v_lshl_add_u32 v5, v6, 2, v5
    ds_write_b32 v5, v72
    ds_write_b32 v5, v97 offset:64
    v_add_u32 v4, 2304, v0
    v_mul_u32_u24 v5, 6554, v4
    v_lshrrev_b32 v5, 16, v5
    v_mul_u32_u24 v6, 10, v5
    v_sub_u32 v6, v4, v6
    v_lshlrev_b32 v5, 7, v5
    v_lshl_add_u32 v5, v6, 2, v5
    ds_write_b32 v5, v73
    ds_write_b32 v5, v98 offset:64
    v_add_u32 v4, 2560, v0
    v_mul_u32_u24 v5, 6554, v4
    v_lshrrev_b32 v5, 16, v5
    v_mul_u32_u24 v6, 10, v5
    v_sub_u32 v6, v4, v6
    v_lshlrev_b32 v5, 7, v5
    v_lshl_add_u32 v5, v6, 2, v5
    ds_write_b32 v5, v74
    ds_write_b32 v5, v99 offset:64
    v_add_u32 v4, 2816, v0
    v_mul_u32_u24 v5, 6554, v4
    v_lshrrev_b32 v5, 16, v5
    v_mul_u32_u24 v6, 10, v5
    v_sub_u32 v6, v4, v6
    v_lshlrev_b32 v5, 7, v5
    v_lshl_add_u32 v5, v6, 2, v5
    ds_write_b32 v5, v75
    ds_write_b32 v5, v100 offset:64
    v_add_u32 v4, 3072, v0
    v_mul_u32_u24 v5, 6554, v4
    v_lshrrev_b32 v5, 16, v5
    v_mul_u32_u24 v6, 10, v5
    v_sub_u32 v6, v4, v6
    v_lshlrev_b32 v5, 7, v5
    v_lshl_add_u32 v5, v6, 2, v5
    ds_write_b32 v5, v76
    ds_write_b32 v5, v101 offset:64
    v_add_u32 v4, 3328, v0
    v_mul_u32_u24 v5, 6554, v4
    v_lshrrev_b32 v5, 16, v5
    v_mul_u32_u24 v6, 10, v5
    v_sub_u32 v6, v4, v6
    v_lshlrev_b32 v5, 7, v5
    v_lshl_add_u32 v5, v6, 2, v5
    ds_write_b32 v5, v77
    ds_write_b32 v5, v102 offset:64
    v_add_u32 v4, 3584, v0
    v_mul_u32_u24 v5, 6554, v4
    v_lshrrev_b32 v5, 16, v5
    v_mul_u32_u24 v6, 10, v5
    v_sub_u32 v6, v4, v6
    v_lshlrev_b32 v5, 7, v5
    v_lshl_add_u32 v5, v6, 2, v5
    ds_write_b32 v5, v78
    ds_write_b32 v5, v103 offset:64
    v_add_u32 v4, 3840, v0
    v_mul_u32_u24 v5, 6554, v4
    v_lshrrev_b32 v5, 16, v5
    v_mul_u32_u24 v6, 10, v5
    v_sub_u32 v6, v4, v6
    v_lshlrev_b32 v5, 7, v5
    v_lshl_add_u32 v5, v6, 2, v5
    ds_write_b32 v5, v79
    ds_write_b32 v5, v104 offset:64
    v_add_u32 v4, 4096, v0
    v_mul_u32_u24 v5, 6554, v4
    v_lshrrev_b32 v5, 16, v5
    v_mul_u32_u24 v6, 10, v5
    v_sub_u32 v6, v4, v6
    v_lshlrev_b32 v5, 7, v5
    v_lshl_add_u32 v5, v6, 2, v5
    ds_write_b32 v5, v80
    ds_write_b32 v5, v105 offset:64
    v_add_u32 v4, 4352, v0
    v_mul_u32_u24 v5, 6554, v4
    v_lshrrev_b32 v5, 16, v5
    v_mul_u32_u24 v6, 10, v5
    v_sub_u32 v6, v4, v6
    v_lshlrev_b32 v5, 7, v5
    v_lshl_add_u32 v5, v6, 2, v5
    ds_write_b32 v5, v81
    ds_write_b32 v5, v106 offset:64
    v_add_u32 v4, 4608, v0
    v_mul_u32_u24 v5, 6554, v4
    v_lshrrev_b32 v5, 16, v5
    v_mul_u32_u24 v6, 10, v5
    v_sub_u32 v6, v4, v6
    v_lshlrev_b32 v5, 7, v5
    v_lshl_add_u32 v5, v6, 2, v5
    ds_write_b32 v5, v82
    ds_write_b32 v5, v107 offset:64
    v_add_u32 v4, 4864, v0
    v_mul_u32_u24 v5, 6554, v4
    v_lshrrev_b32 v5, 16, v5
    v_mul_u32_u24 v6, 10, v5
    v_sub_u32 v6, v4, v6
    v_lshlrev_b32 v5, 7, v5
    v_lshl_add_u32 v5, v6, 2, v5
    ds_write_b32 v5, v83
    ds_write_b32 v5, v108 offset:64
    v_add_u32 v4, 5120, v0
    v_mul_u32_u24 v5, 6554, v4
    v_lshrrev_b32 v5, 16, v5
    v_mul_u32_u24 v6, 10, v5
    v_sub_u32 v6, v4, v6
    v_lshlrev_b32 v5, 7, v5
    v_lshl_add_u32 v5, v6, 2, v5
    ds_write_b32 v5, v84
    ds_write_b32 v5, v109 offset:64
    v_add_u32 v4, 5376, v0
    v_mul_u32_u24 v5, 6554, v4
    v_lshrrev_b32 v5, 16, v5
    v_mul_u32_u24 v6, 10, v5
    v_sub_u32 v6, v4, v6
    v_lshlrev_b32 v5, 7, v5
    v_lshl_add_u32 v5, v6, 2, v5
    ds_write_b32 v5, v85
    ds_write_b32 v5, v110 offset:64
    v_add_u32 v4, 5632, v0
    v_mul_u32_u24 v5, 6554, v4
    v_lshrrev_b32 v5, 16, v5
    v_mul_u32_u24 v6, 10, v5
    v_sub_u32 v6, v4, v6
    v_lshlrev_b32 v5, 7, v5
    v_lshl_add_u32 v5, v6, 2, v5
    ds_write_b32 v5, v86
    ds_write_b32 v5, v111 offset:64
    v_add_u32 v4, 5888, v0
    v_mul_u32_u24 v5, 6554, v4
    v_lshrrev_b32 v5, 16, v5
    v_mul_u32_u24 v6, 10, v5
    v_sub_u32 v6, v4, v6
    v_lshlrev_b32 v5, 7, v5
    v_lshl_add_u32 v5, v6, 2, v5
    ds_write_b32 v5, v87
    ds_write_b32 v5, v112 offset:64
    v_add_u32 v4, 6144, v0
    v_mul_u32_u24 v5, 6554, v4
    v_lshrrev_b32 v5, 16, v5
    v_mul_u32_u24 v6, 10, v5
    v_sub_u32 v6, v4, v6
    v_lshlrev_b32 v5, 7, v5
    v_lshl_add_u32 v5, v6, 2, v5
    ds_write_b32 v5, v88
    ds_write_b32 v5, v113 offset:64
    s_waitcnt lgkmcnt(0)
    s_waitcnt vmcnt(0)
    s_barrier
    v_add_u32 v22, 0, v23
    ds_read_b64_tr_b16 v[64:65], v22 offset:0
    ds_read_b64_tr_b16 v[66:67], v22 offset:512
    ds_read_b64_tr_b16 v[68:69], v22 offset:32
    ds_read_b64_tr_b16 v[70:71], v22 offset:544
    ds_read_b64_tr_b16 v[72:73], v22 offset:64
    ds_read_b64_tr_b16 v[74:75], v22 offset:576
    ds_read_b64_tr_b16 v[76:77], v22 offset:96
    ds_read_b64_tr_b16 v[78:79], v22 offset:608
    v_add_u32 v22, 4096, v23
    ds_read_b64_tr_b16 v[100:101], v22 offset:0
    ds_read_b64_tr_b16 v[102:103], v22 offset:512
    ds_read_b64_tr_b16 v[104:105], v22 offset:32
    ds_read_b64_tr_b16 v[106:107], v22 offset:544
    ds_read_b64_tr_b16 v[108:109], v22 offset:64
    ds_read_b64_tr_b16 v[110:111], v22 offset:576
    ds_read_b64_tr_b16 v[112:113], v22 offset:96
    ds_read_b64_tr_b16 v[114:115], v22 offset:608
    s_waitcnt lgkmcnt(8)
    v_mfma_f32_16x16x32_bf16 v[28:31], v[64:67], v[136:139], v[28:31]
    v_mfma_f32_16x16x32_bf16 v[32:35], v[68:71], v[136:139], v[32:35]
    v_mfma_f32_16x16x32_bf16 v[36:39], v[72:75], v[136:139], v[36:39]
    v_mfma_f32_16x16x32_bf16 v[40:43], v[76:79], v[136:139], v[40:43]
    v_add_u32 v22, 8192, v23
    ds_read_b64_tr_b16 v[64:65], v22 offset:0
    ds_read_b64_tr_b16 v[66:67], v22 offset:512
    ds_read_b64_tr_b16 v[68:69], v22 offset:32
    ds_read_b64_tr_b16 v[70:71], v22 offset:544
    ds_read_b64_tr_b16 v[72:73], v22 offset:64
    ds_read_b64_tr_b16 v[74:75], v22 offset:576
    ds_read_b64_tr_b16 v[76:77], v22 offset:96
    ds_read_b64_tr_b16 v[78:79], v22 offset:608
    s_waitcnt lgkmcnt(8)
    v_mfma_f32_16x16x32_bf16 v[28:31], v[100:103], v[140:143], v[28:31]
    v_mfma_f32_16x16x32_bf16 v[32:35], v[104:107], v[140:143], v[32:35]
    v_mfma_f32_16x16x32_bf16 v[36:39], v[108:111], v[140:143], v[36:39]
    v_mfma_f32_16x16x32_bf16 v[40:43], v[112:115], v[140:143], v[40:43]
    v_add_u32 v22, 12288, v23
    ds_read_b64_tr_b16 v[100:101], v22 offset:0
    ds_read_b64_tr_b16 v[102:103], v22 offset:512
    ds_read_b64_tr_b16 v[104:105], v22 offset:32
    ds_read_b64_tr_b16 v[106:107], v22 offset:544
    ds_read_b64_tr_b16 v[108:109], v22 offset:64
    ds_read_b64_tr_b16 v[110:111], v22 offset:576
    ds_read_b64_tr_b16 v[112:113], v22 offset:96
    ds_read_b64_tr_b16 v[114:115], v22 offset:608
    s_waitcnt lgkmcnt(8)
    v_mfma_f32_16x16x32_bf16 v[28:31], v[64:67], v[144:147], v[28:31]
    v_mfma_f32_16x16x32_bf16 v[32:35], v[68:71], v[144:147], v[32:35]
    v_mfma_f32_16x16x32_bf16 v[36:39], v[72:75], v[144:147], v[36:39]
    v_mfma_f32_16x16x32_bf16 v[40:43], v[76:79], v[144:147], v[40:43]
    v_add_u32 v22, 16384, v23
    ds_read_b64_tr_b16 v[64:65], v22 offset:0
    ds_read_b64_tr_b16 v[66:67], v22 offset:512
    ds_read_b64_tr_b16 v[68:69], v22 offset:32
    ds_read_b64_tr_b16 v[70:71], v22 offset:544
    ds_read_b64_tr_b16 v[72:73], v22 offset:64
    ds_read_b64_tr_b16 v[74:75], v22 offset:576
    ds_read_b64_tr_b16 v[76:77], v22 offset:96
    ds_read_b64_tr_b16 v[78:79], v22 offset:608
    s_waitcnt lgkmcnt(8)
    v_mfma_f32_16x16x32_bf16 v[28:31], v[100:103], v[148:151], v[28:31]
    v_mfma_f32_16x16x32_bf16 v[32:35], v[104:107], v[148:151], v[32:35]
    v_mfma_f32_16x16x32_bf16 v[36:39], v[108:111], v[148:151], v[36:39]
    v_mfma_f32_16x16x32_bf16 v[40:43], v[112:115], v[148:151], v[40:43]
    v_add_u32 v22, 20480, v23
    ds_read_b64_tr_b16 v[100:101], v22 offset:0
    ds_read_b64_tr_b16 v[102:103], v22 offset:512
    ds_read_b64_tr_b16 v[104:105], v22 offset:32
    ds_read_b64_tr_b16 v[106:107], v22 offset:544
    ds_read_b64_tr_b16 v[108:109], v22 offset:64
    ds_read_b64_tr_b16 v[110:111], v22 offset:576
    ds_read_b64_tr_b16 v[112:113], v22 offset:96
    ds_read_b64_tr_b16 v[114:115], v22 offset:608
    s_waitcnt lgkmcnt(8)
    v_mfma_f32_16x16x32_bf16 v[28:31], v[64:67], v[152:155], v[28:31]
    v_mfma_f32_16x16x32_bf16 v[32:35], v[68:71], v[152:155], v[32:35]
    v_mfma_f32_16x16x32_bf16 v[36:39], v[72:75], v[152:155], v[36:39]
    v_mfma_f32_16x16x32_bf16 v[40:43], v[76:79], v[152:155], v[40:43]
    v_add_u32 v22, 24576, v23
    ds_read_b64_tr_b16 v[64:65], v22 offset:0
    ds_read_b64_tr_b16 v[66:67], v22 offset:512
    ds_read_b64_tr_b16 v[68:69], v22 offset:32
    ds_read_b64_tr_b16 v[70:71], v22 offset:544
    ds_read_b64_tr_b16 v[72:73], v22 offset:64
    ds_read_b64_tr_b16 v[74:75], v22 offset:576
    ds_read_b64_tr_b16 v[76:77], v22 offset:96
    ds_read_b64_tr_b16 v[78:79], v22 offset:608
    s_waitcnt lgkmcnt(8)
    v_mfma_f32_16x16x32_bf16 v[28:31], v[100:103], v[156:159], v[28:31]
    v_mfma_f32_16x16x32_bf16 v[32:35], v[104:107], v[156:159], v[32:35]
    v_mfma_f32_16x16x32_bf16 v[36:39], v[108:111], v[156:159], v[36:39]
    v_mfma_f32_16x16x32_bf16 v[40:43], v[112:115], v[156:159], v[40:43]
    v_add_u32 v22, 28672, v23
    ds_read_b64_tr_b16 v[100:101], v22 offset:0
    ds_read_b64_tr_b16 v[102:103], v22 offset:512
    ds_read_b64_tr_b16 v[104:105], v22 offset:32
    ds_read_b64_tr_b16 v[106:107], v22 offset:544
    ds_read_b64_tr_b16 v[108:109], v22 offset:64
    ds_read_b64_tr_b16 v[110:111], v22 offset:576
    ds_read_b64_tr_b16 v[112:113], v22 offset:96
    ds_read_b64_tr_b16 v[114:115], v22 offset:608
    s_waitcnt lgkmcnt(8)
    v_mfma_f32_16x16x32_bf16 v[28:31], v[64:67], v[160:163], v[28:31]
    v_mfma_f32_16x16x32_bf16 v[32:35], v[68:71], v[160:163], v[32:35]
    v_mfma_f32_16x16x32_bf16 v[36:39], v[72:75], v[160:163], v[36:39]
    v_mfma_f32_16x16x32_bf16 v[40:43], v[76:79], v[160:163], v[40:43]
    v_add_u32 v22, 32768, v23
    ds_read_b64_tr_b16 v[64:65], v22 offset:0
    ds_read_b64_tr_b16 v[66:67], v22 offset:512
    ds_read_b64_tr_b16 v[68:69], v22 offset:32
    ds_read_b64_tr_b16 v[70:71], v22 offset:544
    ds_read_b64_tr_b16 v[72:73], v22 offset:64
    ds_read_b64_tr_b16 v[74:75], v22 offset:576
    ds_read_b64_tr_b16 v[76:77], v22 offset:96
    ds_read_b64_tr_b16 v[78:79], v22 offset:608
    s_waitcnt lgkmcnt(8)
    v_mfma_f32_16x16x32_bf16 v[28:31], v[100:103], v[164:167], v[28:31]
    v_mfma_f32_16x16x32_bf16 v[32:35], v[104:107], v[164:167], v[32:35]
    v_mfma_f32_16x16x32_bf16 v[36:39], v[108:111], v[164:167], v[36:39]
    v_mfma_f32_16x16x32_bf16 v[40:43], v[112:115], v[164:167], v[40:43]
    v_add_u32 v22, 36864, v23
    ds_read_b64_tr_b16 v[100:101], v22 offset:0
    ds_read_b64_tr_b16 v[102:103], v22 offset:512
    ds_read_b64_tr_b16 v[104:105], v22 offset:32
    ds_read_b64_tr_b16 v[106:107], v22 offset:544
    ds_read_b64_tr_b16 v[108:109], v22 offset:64
    ds_read_b64_tr_b16 v[110:111], v22 offset:576
    ds_read_b64_tr_b16 v[112:113], v22 offset:96
    ds_read_b64_tr_b16 v[114:115], v22 offset:608
    s_waitcnt lgkmcnt(8)
    v_mfma_f32_16x16x32_bf16 v[28:31], v[64:67], v[168:171], v[28:31]
    v_mfma_f32_16x16x32_bf16 v[32:35], v[68:71], v[168:171], v[32:35]
    v_mfma_f32_16x16x32_bf16 v[36:39], v[72:75], v[168:171], v[36:39]
    v_mfma_f32_16x16x32_bf16 v[40:43], v[76:79], v[168:171], v[40:43]
    v_add_u32 v22, 40960, v23
    ds_read_b64_tr_b16 v[64:65], v22 offset:0
    ds_read_b64_tr_b16 v[66:67], v22 offset:512
    ds_read_b64_tr_b16 v[68:69], v22 offset:32
    ds_read_b64_tr_b16 v[70:71], v22 offset:544
    ds_read_b64_tr_b16 v[72:73], v22 offset:64
    ds_read_b64_tr_b16 v[74:75], v22 offset:576
    ds_read_b64_tr_b16 v[76:77], v22 offset:96
    ds_read_b64_tr_b16 v[78:79], v22 offset:608
    s_waitcnt lgkmcnt(8)
    v_mfma_f32_16x16x32_bf16 v[28:31], v[100:103], v[172:175], v[28:31]
    v_mfma_f32_16x16x32_bf16 v[32:35], v[104:107], v[172:175], v[32:35]
    v_mfma_f32_16x16x32_bf16 v[36:39], v[108:111], v[172:175], v[36:39]
    v_mfma_f32_16x16x32_bf16 v[40:43], v[112:115], v[172:175], v[40:43]
    v_add_u32 v22, 45056, v23
    ds_read_b64_tr_b16 v[100:101], v22 offset:0
    ds_read_b64_tr_b16 v[102:103], v22 offset:512
    ds_read_b64_tr_b16 v[104:105], v22 offset:32
    ds_read_b64_tr_b16 v[106:107], v22 offset:544
    ds_read_b64_tr_b16 v[108:109], v22 offset:64
    ds_read_b64_tr_b16 v[110:111], v22 offset:576
    ds_read_b64_tr_b16 v[112:113], v22 offset:96
    ds_read_b64_tr_b16 v[114:115], v22 offset:608
    s_waitcnt lgkmcnt(8)
    v_mfma_f32_16x16x32_bf16 v[28:31], v[64:67], v[176:179], v[28:31]
    v_mfma_f32_16x16x32_bf16 v[32:35], v[68:71], v[176:179], v[32:35]
    v_mfma_f32_16x16x32_bf16 v[36:39], v[72:75], v[176:179], v[36:39]
    v_mfma_f32_16x16x32_bf16 v[40:43], v[76:79], v[176:179], v[40:43]
    v_add_u32 v22, 49152, v23
    ds_read_b64_tr_b16 v[64:65], v22 offset:0
    ds_read_b64_tr_b16 v[66:67], v22 offset:512
    ds_read_b64_tr_b16 v[68:69], v22 offset:32
    ds_read_b64_tr_b16 v[70:71], v22 offset:544
    ds_read_b64_tr_b16 v[72:73], v22 offset:64
    ds_read_b64_tr_b16 v[74:75], v22 offset:576
    ds_read_b64_tr_b16 v[76:77], v22 offset:96
    ds_read_b64_tr_b16 v[78:79], v22 offset:608
    s_waitcnt lgkmcnt(8)
    v_mfma_f32_16x16x32_bf16 v[28:31], v[100:103], v[180:183], v[28:31]
    v_mfma_f32_16x16x32_bf16 v[32:35], v[104:107], v[180:183], v[32:35]
    v_mfma_f32_16x16x32_bf16 v[36:39], v[108:111], v[180:183], v[36:39]
    v_mfma_f32_16x16x32_bf16 v[40:43], v[112:115], v[180:183], v[40:43]
    v_add_u32 v22, 53248, v23
    ds_read_b64_tr_b16 v[100:101], v22 offset:0
    ds_read_b64_tr_b16 v[102:103], v22 offset:512
    ds_read_b64_tr_b16 v[104:105], v22 offset:32
    ds_read_b64_tr_b16 v[106:107], v22 offset:544
    ds_read_b64_tr_b16 v[108:109], v22 offset:64
    ds_read_b64_tr_b16 v[110:111], v22 offset:576
    ds_read_b64_tr_b16 v[112:113], v22 offset:96
    ds_read_b64_tr_b16 v[114:115], v22 offset:608
    s_waitcnt lgkmcnt(8)
    v_mfma_f32_16x16x32_bf16 v[28:31], v[64:67], v[184:187], v[28:31]
    v_mfma_f32_16x16x32_bf16 v[32:35], v[68:71], v[184:187], v[32:35]
    v_mfma_f32_16x16x32_bf16 v[36:39], v[72:75], v[184:187], v[36:39]
    v_mfma_f32_16x16x32_bf16 v[40:43], v[76:79], v[184:187], v[40:43]
    v_add_u32 v22, 57344, v23
    ds_read_b64_tr_b16 v[64:65], v22 offset:0
    ds_read_b64_tr_b16 v[66:67], v22 offset:512
    ds_read_b64_tr_b16 v[68:69], v22 offset:32
    ds_read_b64_tr_b16 v[70:71], v22 offset:544
    ds_read_b64_tr_b16 v[72:73], v22 offset:64
    ds_read_b64_tr_b16 v[74:75], v22 offset:576
    ds_read_b64_tr_b16 v[76:77], v22 offset:96
    ds_read_b64_tr_b16 v[78:79], v22 offset:608
    s_waitcnt lgkmcnt(8)
    v_mfma_f32_16x16x32_bf16 v[28:31], v[100:103], v[188:191], v[28:31]
    v_mfma_f32_16x16x32_bf16 v[32:35], v[104:107], v[188:191], v[32:35]
    v_mfma_f32_16x16x32_bf16 v[36:39], v[108:111], v[188:191], v[36:39]
    v_mfma_f32_16x16x32_bf16 v[40:43], v[112:115], v[188:191], v[40:43]
    v_add_u32 v22, 61440, v23
    ds_read_b64_tr_b16 v[100:101], v22 offset:0
    ds_read_b64_tr_b16 v[102:103], v22 offset:512
    ds_read_b64_tr_b16 v[104:105], v22 offset:32
    ds_read_b64_tr_b16 v[106:107], v22 offset:544
    ds_read_b64_tr_b16 v[108:109], v22 offset:64
    ds_read_b64_tr_b16 v[110:111], v22 offset:576
    ds_read_b64_tr_b16 v[112:113], v22 offset:96
    ds_read_b64_tr_b16 v[114:115], v22 offset:608
    s_waitcnt lgkmcnt(8)
    v_mfma_f32_16x16x32_bf16 v[28:31], v[64:67], v[192:195], v[28:31]
    v_mfma_f32_16x16x32_bf16 v[32:35], v[68:71], v[192:195], v[32:35]
    v_mfma_f32_16x16x32_bf16 v[36:39], v[72:75], v[192:195], v[36:39]
    v_mfma_f32_16x16x32_bf16 v[40:43], v[76:79], v[192:195], v[40:43]
    v_add_u32 v22, 65536, v23
    ds_read_b64_tr_b16 v[64:65], v22 offset:0
    ds_read_b64_tr_b16 v[66:67], v22 offset:512
    ds_read_b64_tr_b16 v[68:69], v22 offset:32
    ds_read_b64_tr_b16 v[70:71], v22 offset:544
    ds_read_b64_tr_b16 v[72:73], v22 offset:64
    ds_read_b64_tr_b16 v[74:75], v22 offset:576
    ds_read_b64_tr_b16 v[76:77], v22 offset:96
    ds_read_b64_tr_b16 v[78:79], v22 offset:608
    s_waitcnt lgkmcnt(8)
    v_mfma_f32_16x16x32_bf16 v[28:31], v[100:103], v[196:199], v[28:31]
    v_mfma_f32_16x16x32_bf16 v[32:35], v[104:107], v[196:199], v[32:35]
    v_mfma_f32_16x16x32_bf16 v[36:39], v[108:111], v[196:199], v[36:39]
    v_mfma_f32_16x16x32_bf16 v[40:43], v[112:115], v[196:199], v[40:43]
    v_add_u32 v22, 69632, v23
    ds_read_b64_tr_b16 v[100:101], v22 offset:0
    ds_read_b64_tr_b16 v[102:103], v22 offset:512
    ds_read_b64_tr_b16 v[104:105], v22 offset:32
    ds_read_b64_tr_b16 v[106:107], v22 offset:544
    ds_read_b64_tr_b16 v[108:109], v22 offset:64
    ds_read_b64_tr_b16 v[110:111], v22 offset:576
    ds_read_b64_tr_b16 v[112:113], v22 offset:96
    ds_read_b64_tr_b16 v[114:115], v22 offset:608
    s_waitcnt lgkmcnt(8)
    v_mfma_f32_16x16x32_bf16 v[28:31], v[64:67], v[200:203], v[28:31]
    v_mfma_f32_16x16x32_bf16 v[32:35], v[68:71], v[200:203], v[32:35]
    v_mfma_f32_16x16x32_bf16 v[36:39], v[72:75], v[200:203], v[36:39]
    v_mfma_f32_16x16x32_bf16 v[40:43], v[76:79], v[200:203], v[40:43]
    v_add_u32 v22, 73728, v23
    ds_read_b64_tr_b16 v[64:65], v22 offset:0
    ds_read_b64_tr_b16 v[66:67], v22 offset:512
    ds_read_b64_tr_b16 v[68:69], v22 offset:32
    ds_read_b64_tr_b16 v[70:71], v22 offset:544
    ds_read_b64_tr_b16 v[72:73], v22 offset:64
    ds_read_b64_tr_b16 v[74:75], v22 offset:576
    ds_read_b64_tr_b16 v[76:77], v22 offset:96
    ds_read_b64_tr_b16 v[78:79], v22 offset:608
    s_waitcnt lgkmcnt(8)
    v_mfma_f32_16x16x32_bf16 v[28:31], v[100:103], v[204:207], v[28:31]
    v_mfma_f32_16x16x32_bf16 v[32:35], v[104:107], v[204:207], v[32:35]
    v_mfma_f32_16x16x32_bf16 v[36:39], v[108:111], v[204:207], v[36:39]
    v_mfma_f32_16x16x32_bf16 v[40:43], v[112:115], v[204:207], v[40:43]
    v_add_u32 v22, 77824, v23
    ds_read_b64_tr_b16 v[100:101], v22 offset:0
    ds_read_b64_tr_b16 v[102:103], v22 offset:512
    ds_read_b64_tr_b16 v[104:105], v22 offset:32
    ds_read_b64_tr_b16 v[106:107], v22 offset:544
    ds_read_b64_tr_b16 v[108:109], v22 offset:64
    ds_read_b64_tr_b16 v[110:111], v22 offset:576
    ds_read_b64_tr_b16 v[112:113], v22 offset:96
    ds_read_b64_tr_b16 v[114:115], v22 offset:608
    s_waitcnt lgkmcnt(8)
    v_mfma_f32_16x16x32_bf16 v[28:31], v[64:67], v[208:211], v[28:31]
    v_mfma_f32_16x16x32_bf16 v[32:35], v[68:71], v[208:211], v[32:35]
    v_mfma_f32_16x16x32_bf16 v[36:39], v[72:75], v[208:211], v[36:39]
    v_mfma_f32_16x16x32_bf16 v[40:43], v[76:79], v[208:211], v[40:43]
    s_waitcnt lgkmcnt(0)
    v_mfma_f32_16x16x32_bf16 v[28:31], v[100:103], v[212:215], v[28:31]
    v_mfma_f32_16x16x32_bf16 v[32:35], v[104:107], v[212:215], v[32:35]
    v_mfma_f32_16x16x32_bf16 v[36:39], v[108:111], v[212:215], v[36:39]
    v_mfma_f32_16x16x32_bf16 v[40:43], v[112:115], v[212:215], v[40:43]
    s_nop 15
    v_lshrrev_b32 v3, 5, v10
    v_and_b32 v4, 31, v10
    v_lshlrev_b32 v5, 11, v3
    v_lshl_add_u32 v5, v4, 4, v5
    v_lshrrev_b32 v6, 1, v2
    v_lshl_add_u32 v5, v6, 9, v5
    v_and_b32 v6, 1, v2
    v_lshl_add_u32 v5, v6, 3, v5
    v_cvt_pk_bf16_f32 v26, v28, v29
    v_cvt_pk_bf16_f32 v27, v30, v31
    buffer_store_dwordx2 v[26:27], v5, s[16:19], 0 offen offset:0
    v_lshlrev_b32 v5, 11, v3
    v_lshl_add_u32 v5, v4, 4, v5
    v_lshrrev_b32 v6, 1, v2
    v_lshl_add_u32 v5, v6, 9, v5
    v_and_b32 v6, 1, v2
    v_lshl_add_u32 v5, v6, 3, v5
    v_cvt_pk_bf16_f32 v26, v32, v33
    v_cvt_pk_bf16_f32 v27, v34, v35
    buffer_store_dwordx2 v[26:27], v5, s[16:19], 0 offen offset:1024
    v_cmp_eq_u32 vcc, 1, v2
    s_nop 1
    v_cndmask_b32 v40, v40, 1.0, vcc
    v_lshlrev_b32 v5, 11, v3
    v_lshrrev_b32 v6, 4, v4
    v_lshl_add_u32 v5, v6, 10, v5
    v_bfe_u32 v6, v4, 2, 1
    v_lshl_add_u32 v5, v6, 9, v5
    v_bfe_u32 v6, v4, 3, 1
    v_lshl_add_u32 v5, v6, 3, v5
    v_and_b32 v6, 3, v4
    v_lshl_add_u32 v5, v6, 1, v5
    v_lshl_add_u32 v5, v2, 6, v5
    v_cvt_pk_bf16_f32 v26, v36, v37
    v_cvt_pk_bf16_f32 v27, v38, v39
    s_nop 0
    v_add_u32 v6, 131072, v5
    buffer_store_short v26, v6, s[16:19], 0 offen
    buffer_store_short_d16_hi v26, v6, s[16:19], 0 offen offset:16
    buffer_store_short v27, v6, s[16:19], 0 offen offset:32
    buffer_store_short_d16_hi v27, v6, s[16:19], 0 offen offset:48
    v_cvt_pk_bf16_f32 v26, v40, v41
    v_cvt_pk_bf16_f32 v27, v42, v43
    s_nop 0
    v_add_u32 v6, 131328, v5
    buffer_store_short v26, v6, s[16:19], 0 offen
    buffer_store_short_d16_hi v26, v6, s[16:19], 0 offen offset:16
    buffer_store_short v27, v6, s[16:19], 0 offen offset:32
    buffer_store_short_d16_hi v27, v6, s[16:19], 0 offen offset:48
    s_endpgm
L_END_k1_qkv_kernel:
    s_endpgm
.globl k2_attn_kernel
.p2align 8
.type k2_attn_kernel,@function
k2_attn_kernel:
    s_cmp_ge_u32 s2, 256
    s_cbranch_scc1 L_END_k2_attn_kernel
    s_load_dwordx2 s[4:5], s[0:1], 96
    s_waitcnt lgkmcnt(0)
    s_mov_b32 s8, s4
    s_mov_b32 s9, s5
    s_mov_b32 s10, 0x280000
    s_mov_b32 s11, 0x00020000
    s_add_u32 s12, s4, 0x280000
    s_addc_u32 s13, s5, 0
    s_mov_b32 s14, 0x40000
    s_mov_b32 s15, 0x00020000
    s_add_u32 s16, s4, 0x300000
    s_addc_u32 s17, s5, 0
    s_mov_b32 s18, 0x280000
    s_mov_b32 s19, 0x00020000
    v_and_b32 v1, 31, v0
    v_bfe_u32 v2, v0, 5, 1
    v_lshrrev_b32 v3, 6, v0
    s_lshl_b32 s3, s2, 3
    v_lshl_add_u32 v3, v3, 1, s3
    s_movk_i32 s6, 1280
    v_mul_lo_u32 v3, v3, s6
    v_mul_u32_u24 v4, 40, v1
    v_add_u32 v3, v3, v4
    v_lshl_add_u32 v5, v2, 4, v3
    v_lshl_add_u32 v6, v2, 3, v3
    buffer_load_dwordx4 v[8:11], v5, s[8:11], 0 offen offset:0
    buffer_load_dwordx4 v[12:15], v5, s[8:11], 0 offen offset:32
    buffer_load_dwordx4 v[16:19], v5, s[8:11], 0 offen offset:1280
    buffer_load_dwordx4 v[20:23], v5, s[8:11], 0 offen offset:1312
    v_and_b32 v7, 63, v0
    v_lshlrev_b32 v7, 4, v7
    s_mov_b32 s20, 0x20000
    buffer_load_dwordx4 v[24:27], v7, s[12:15], 0 offen offset:0
    buffer_load_dwordx4 v[28:31], v7, s[12:15], 0 offen offset:1024
    buffer_load_dwordx4 v[32:35], v7, s[12:15], s20 offen offset:0
    buffer_load_dwordx4 v[36:39], v7, s[12:15], s20 offen offset:1024
    v_mov_b32 v104, 0
    v_mov_b32 v72, 0
    v_mov_b32 v105, 0
    v_mov_b32 v73, 0
    v_mov_b32 v106, 0
    v_mov_b32 v74, 0
    v_mov_b32 v107, 0
    v_mov_b32 v75, 0
    v_mov_b32 v108, 0
    v_mov_b32 v76, 0
    v_mov_b32 v109, 0
    v_mov_b32 v77, 0
    v_mov_b32 v110, 0
    v_mov_b32 v78, 0
    v_mov_b32 v111, 0
    v_mov_b32 v79, 0
    v_mov_b32 v112, 0
    v_mov_b32 v80, 0
    v_mov_b32 v113, 0
    v_mov_b32 v81, 0
    v_mov_b32 v114, 0
    v_mov_b32 v82, 0
    v_mov_b32 v115, 0
    v_mov_b32 v83, 0
    v_mov_b32 v116, 0
    v_mov_b32 v84, 0
    v_mov_b32 v117, 0
    v_mov_b32 v85, 0
    v_mov_b32 v118, 0
    v_mov_b32 v86, 0
    v_mov_b32 v119, 0
    v_mov_b32 v87, 0
    v_mov_b32 v120, 0
    v_mov_b32 v88, 0
    v_mov_b32 v121, 0
    v_mov_b32 v89, 0
    v_mov_b32 v122, 0
    v_mov_b32 v90, 0
    v_mov_b32 v123, 0
    v_mov_b32 v91, 0
    v_mov_b32 v124, 0
    v_mov_b32 v92, 0
    v_mov_b32 v125, 0
    v_mov_b32 v93, 0
    v_mov_b32 v126, 0
    v_mov_b32 v94, 0
    v_mov_b32 v127, 0
    v_mov_b32 v95, 0
    v_mov_b32 v128, 0
    v_mov_b32 v96, 0
    v_mov_b32 v129, 0
    v_mov_b32 v97, 0
    v_mov_b32 v130, 0
    v_mov_b32 v98, 0
    v_mov_b32 v131, 0
    v_mov_b32 v99, 0
    v_mov_b32 v132, 0
    v_mov_b32 v100, 0
    v_mov_b32 v133, 0
    v_mov_b32 v101, 0
    v_mov_b32 v134, 0
    v_mov_b32 v102, 0
    v_mov_b32 v135, 0
    v_mov_b32 v103, 0
    s_waitcnt vmcnt(0)
    v_mfma_f32_32x32x16_bf16 v[40:55], v[24:27], v[8:11], v[72:87]
    v_mfma_f32_32x32x16_bf16 v[40:55], v[28:31], v[12:15], v[40:55]
    v_mfma_f32_32x32x16_bf16 v[56:71], v[24:27], v[16:19], v[88:103]
    v_mfma_f32_32x32x16_bf16 v[56:71], v[28:31], v[20:23], v[56:71]
    s_nop 15
    v_max3_f32 v152, v40, v41, v42
    v_max3_f32 v152, v152, v43, v44
    v_max3_f32 v152, v152, v45, v46
    v_max3_f32 v152, v152, v47, v48
    v_max3_f32 v152, v152, v49, v50
    v_max3_f32 v152, v152, v51, v52
    v_max3_f32 v152, v152, v53, v54
    v_max_f32 v152, v152, v55
    v_mov_b32 v4, v152
    s_nop 1
    v_permlane32_swap_b32 v4, v152
    s_nop 1
    v_max_f32 v152, v152, v4
    v_sub_f32 v152, 0, v152
    v_mov_b32 v72, v152
    v_mov_b32 v73, v152
    v_mov_b32 v74, v152
    v_mov_b32 v75, v152
    v_mov_b32 v76, v152
    v_mov_b32 v77, v152
    v_mov_b32 v78, v152
    v_mov_b32 v79, v152
    v_mov_b32 v80, v152
    v_mov_b32 v81, v152
    v_mov_b32 v82, v152
    v_mov_b32 v83, v152
    v_mov_b32 v84, v152
    v_mov_b32 v85, v152
    v_mov_b32 v86, v152
    v_mov_b32 v87, v152
    v_max3_f32 v153, v56, v57, v58
    v_max3_f32 v153, v153, v59, v60
    v_max3_f32 v153, v153, v61, v62
    v_max3_f32 v153, v153, v63, v64
    v_max3_f32 v153, v153, v65, v66
    v_max3_f32 v153, v153, v67, v68
    v_max3_f32 v153, v153, v69, v70
    v_max_f32 v153, v153, v71
    v_mov_b32 v4, v153
    s_nop 1
    v_permlane32_swap_b32 v4, v153
    s_nop 1
    v_max_f32 v153, v153, v4
    v_sub_f32 v153, 0, v153
    v_mov_b32 v88, v153
    v_mov_b32 v89, v153
    v_mov_b32 v90, v153
    v_mov_b32 v91, v153
    v_mov_b32 v92, v153
    v_mov_b32 v93, v153
    v_mov_b32 v94, v153
    v_mov_b32 v95, v153
    v_mov_b32 v96, v153
    v_mov_b32 v97, v153
    v_mov_b32 v98, v153
    v_mov_b32 v99, v153
    v_mov_b32 v100, v153
    v_mov_b32 v101, v153
    v_mov_b32 v102, v153
    v_mov_b32 v103, v153
    s_mov_b32 s25, 0x41000000
    v_mfma_f32_32x32x16_bf16 v[40:55], v[24:27], v[8:11], v[72:87]
    v_mfma_f32_32x32x16_bf16 v[40:55], v[28:31], v[12:15], v[40:55]
    v_mfma_f32_32x32x16_bf16 v[56:71], v[24:27], v[16:19], v[88:103]
    v_mfma_f32_32x32x16_bf16 v[56:71], v[28:31], v[20:23], v[56:71]
    s_movk_i32 s22, 2048
    s_add_u32 s23, s22, s20
    buffer_load_dwordx4 v[156:159], v7, s[12:15], s22 offen offset:0
    buffer_load_dwordx4 v[160:163], v7, s[12:15], s22 offen offset:1024
    buffer_load_dwordx4 v[164:167], v7, s[12:15], s23 offen offset:0
    buffer_load_dwordx4 v[168:171], v7, s[12:15], s23 offen offset:1024
    s_movk_i32 s22, 4096
    s_add_u32 s23, s22, s20
    buffer_load_dwordx4 v[172:175], v7, s[12:15], s22 offen offset:0
    buffer_load_dwordx4 v[176:179], v7, s[12:15], s22 offen offset:1024
    buffer_load_dwordx4 v[180:183], v7, s[12:15], s23 offen offset:0
    buffer_load_dwordx4 v[184:187], v7, s[12:15], s23 offen offset:1024
    s_movk_i32 s22, 6144
    s_add_u32 s23, s22, s20
    buffer_load_dwordx4 v[188:191], v7, s[12:15], s22 offen offset:0
    buffer_load_dwordx4 v[192:195], v7, s[12:15], s22 offen offset:1024
    buffer_load_dwordx4 v[196:199], v7, s[12:15], s23 offen offset:0
    buffer_load_dwordx4 v[200:203], v7, s[12:15], s23 offen offset:1024
    s_nop 15
    v_max3_f32 v152, v40, v41, v42
    v_max3_f32 v4, v43, v44, v45
    v_max3_f32 v152, v152, v46, v47
    v_max3_f32 v4, v4, v48, v49
    v_max3_f32 v152, v152, v50, v51
    v_max3_f32 v4, v4, v52, v53
    v_max3_f32 v152, v152, v54, v55
    v_max_f32 v152, v152, v4
    v_cmp_lt_f32 vcc, s25, v152
    s_cbranch_vccnz L_rare_pa
L_back_pa:
    v_exp_f32 v40, v40
    v_exp_f32 v41, v41
    v_exp_f32 v42, v42
    v_exp_f32 v43, v43
    v_cvt_pk_bf16_f32 v136, v40, v41
    v_exp_f32 v44, v44
    v_exp_f32 v45, v45
    v_cvt_pk_bf16_f32 v137, v42, v43
    v_exp_f32 v46, v46
    v_exp_f32 v47, v47
    v_cvt_pk_bf16_f32 v138, v44, v45
    v_exp_f32 v48, v48
    v_exp_f32 v49, v49
    v_cvt_pk_bf16_f32 v139, v46, v47
    v_exp_f32 v50, v50
    v_exp_f32 v51, v51
    v_cvt_pk_bf16_f32 v140, v48, v49
    v_exp_f32 v52, v52
    v_exp_f32 v53, v53
    v_cvt_pk_bf16_f32 v141, v50, v51
    v_exp_f32 v54, v54
    v_exp_f32 v55, v55
    v_cvt_pk_bf16_f32 v142, v52, v53
    v_cvt_pk_bf16_f32 v143, v54, v55
    s_nop 1
    s_movk_i32 s21, 2048
L_attn_loop:
    s_waitcnt vmcnt(8)
    v_mfma_f32_32x32x16_bf16 v[40:55], v[156:159], v[8:11], v[72:87]
    v_max3_f32 v153, v56, v57, v58
    v_max3_f32 v4, v59, v60, v61
    v_max3_f32 v153, v153, v62, v63
    v_max3_f32 v4, v4, v64, v65
    v_max3_f32 v153, v153, v66, v67
    v_max3_f32 v4, v4, v68, v69
    v_max3_f32 v153, v153, v70, v71
    v_max_f32 v153, v153, v4
    v_cmp_lt_f32 vcc, s25, v153
    s_cbranch_vccnz L_rare_b1
L_back_b1:
    v_exp_f32 v56, v56
    v_exp_f32 v57, v57
    v_mfma_f32_32x32x16_bf16 v[40:55], v[160:163], v[12:15], v[40:55]
    v_exp_f32 v58, v58
    v_exp_f32 v59, v59
    v_cvt_pk_bf16_f32 v144, v56, v57
    v_exp_f32 v60, v60
    v_exp_f32 v61, v61
    v_cvt_pk_bf16_f32 v145, v58, v59
    v_exp_f32 v62, v62
    v_mfma_f32_32x32x16_bf16 v[104:119], v[32:35], v[136:139], v[104:119]
    v_exp_f32 v63, v63
    v_cvt_pk_bf16_f32 v146, v60, v61
    v_exp_f32 v64, v64
    v_exp_f32 v65, v65
    v_cvt_pk_bf16_f32 v147, v62, v63
    v_exp_f32 v66, v66
    v_exp_f32 v67, v67
    v_mfma_f32_32x32x16_bf16 v[104:119], v[36:39], v[140:143], v[104:119]
    v_cvt_pk_bf16_f32 v148, v64, v65
    v_exp_f32 v68, v68
    v_exp_f32 v69, v69
    v_cvt_pk_bf16_f32 v149, v66, v67
    v_exp_f32 v70, v70
    v_exp_f32 v71, v71
    v_cvt_pk_bf16_f32 v150, v68, v69
    v_cvt_pk_bf16_f32 v151, v70, v71
    s_nop 1
    s_add_u32 s22, s21, 6144
    s_and_b32 s22, s22, 0x1ffff
    s_add_u32 s23, s22, s20
    v_mfma_f32_32x32x16_bf16 v[120:135], v[32:35], v[144:147], v[120:135]
    v_max3_f32 v152, v40, v41, v42
    v_max3_f32 v4, v43, v44, v45
    v_max3_f32 v152, v152, v46, v47
    v_max3_f32 v4, v4, v48, v49
    v_max3_f32 v152, v152, v50, v51
    v_max3_f32 v4, v4, v52, v53
    v_max3_f32 v152, v152, v54, v55
    v_max_f32 v152, v152, v4
    v_cmp_lt_f32 vcc, s25, v152
    s_cbranch_vccnz L_rare_a1
L_back_a1:
    v_exp_f32 v40, v40
    v_exp_f32 v41, v41
    v_mfma_f32_32x32x16_bf16 v[120:135], v[36:39], v[148:151], v[120:135]
    v_exp_f32 v42, v42
    v_exp_f32 v43, v43
    v_cvt_pk_bf16_f32 v136, v40, v41
    v_exp_f32 v44, v44
    v_exp_f32 v45, v45
    v_cvt_pk_bf16_f32 v137, v42, v43
    v_exp_f32 v46, v46
    v_mfma_f32_32x32x16_bf16 v[56:71], v[156:159], v[16:19], v[88:103]
    v_exp_f32 v47, v47
    v_cvt_pk_bf16_f32 v138, v44, v45
    v_exp_f32 v48, v48
    v_exp_f32 v49, v49
    v_cvt_pk_bf16_f32 v139, v46, v47
    v_exp_f32 v50, v50
    v_exp_f32 v51, v51
    v_mfma_f32_32x32x16_bf16 v[56:71], v[160:163], v[20:23], v[56:71]
    v_cvt_pk_bf16_f32 v140, v48, v49
    v_exp_f32 v52, v52
    v_exp_f32 v53, v53
    v_cvt_pk_bf16_f32 v141, v50, v51
    v_exp_f32 v54, v54
    v_exp_f32 v55, v55
    v_cvt_pk_bf16_f32 v142, v52, v53
    v_cvt_pk_bf16_f32 v143, v54, v55
    s_nop 1
    buffer_load_dwordx4 v[24:27], v7, s[12:15], s22 offen offset:0
    buffer_load_dwordx4 v[28:31], v7, s[12:15], s22 offen offset:1024
    buffer_load_dwordx4 v[32:35], v7, s[12:15], s23 offen offset:0
    buffer_load_dwordx4 v[36:39], v7, s[12:15], s23 offen offset:1024
    s_add_u32 s21, s21, 2048
    s_waitcnt vmcnt(8)
    v_mfma_f32_32x32x16_bf16 v[40:55], v[172:175], v[8:11], v[72:87]
    v_max3_f32 v153, v56, v57, v58
    v_max3_f32 v4, v59, v60, v61
    v_max3_f32 v153, v153, v62, v63
    v_max3_f32 v4, v4, v64, v65
    v_max3_f32 v153, v153, v66, v67
    v_max3_f32 v4, v4, v68, v69
    v_max3_f32 v153, v153, v70, v71
    v_max_f32 v153, v153, v4
    v_cmp_lt_f32 vcc, s25, v153
    s_cbranch_vccnz L_rare_b2
L_back_b2:
    v_exp_f32 v56, v56
    v_exp_f32 v57, v57
    v_mfma_f32_32x32x16_bf16 v[40:55], v[176:179], v[12:15], v[40:55]
    v_exp_f32 v58, v58
    v_exp_f32 v59, v59
    v_cvt_pk_bf16_f32 v144, v56, v57
    v_exp_f32 v60, v60
    v_exp_f32 v61, v61
    v_cvt_pk_bf16_f32 v145, v58, v59
    v_exp_f32 v62, v62
    v_mfma_f32_32x32x16_bf16 v[104:119], v[164:167], v[136:139], v[104:119]
    v_exp_f32 v63, v63
    v_cvt_pk_bf16_f32 v146, v60, v61
    v_exp_f32 v64, v64
    v_exp_f32 v65, v65
    v_cvt_pk_bf16_f32 v147, v62, v63
    v_exp_f32 v66, v66
    v_exp_f32 v67, v67
    v_mfma_f32_32x32x16_bf16 v[104:119], v[168:171], v[140:143], v[104:119]
    v_cvt_pk_bf16_f32 v148, v64, v65
    v_exp_f32 v68, v68
    v_exp_f32 v69, v69
    v_cvt_pk_bf16_f32 v149, v66, v67
    v_exp_f32 v70, v70
    v_exp_f32 v71, v71
    v_cvt_pk_bf16_f32 v150, v68, v69
    v_cvt_pk_bf16_f32 v151, v70, v71
    s_nop 1
    s_add_u32 s22, s21, 6144
    s_and_b32 s22, s22, 0x1ffff
    s_add_u32 s23, s22, s20
    v_mfma_f32_32x32x16_bf16 v[120:135], v[164:167], v[144:147], v[120:135]
    v_max3_f32 v152, v40, v41, v42
    v_max3_f32 v4, v43, v44, v45
    v_max3_f32 v152, v152, v46, v47
    v_max3_f32 v4, v4, v48, v49
    v_max3_f32 v152, v152, v50, v51
    v_max3_f32 v4, v4, v52, v53
    v_max3_f32 v152, v152, v54, v55
    v_max_f32 v152, v152, v4
    v_cmp_lt_f32 vcc, s25, v152
    s_cbranch_vccnz L_rare_a2
L_back_a2:
    v_exp_f32 v40, v40
    v_exp_f32 v41, v41
    v_mfma_f32_32x32x16_bf16 v[120:135], v[168:171], v[148:151], v[120:135]
    v_exp_f32 v42, v42
    v_exp_f32 v43, v43
    v_cvt_pk_bf16_f32 v136, v40, v41
    v_exp_f32 v44, v44
    v_exp_f32 v45, v45
    v_cvt_pk_bf16_f32 v137, v42, v43
    v_exp_f32 v46, v46
    v_mfma_f32_32x32x16_bf16 v[56:71], v[172:175], v[16:19], v[88:103]
    v_exp_f32 v47, v47
    v_cvt_pk_bf16_f32 v138, v44, v45
    v_exp_f32 v48, v48
    v_exp_f32 v49, v49
    v_cvt_pk_bf16_f32 v139, v46, v47
    v_exp_f32 v50, v50
    v_exp_f32 v51, v51
    v_mfma_f32_32x32x16_bf16 v[56:71], v[176:179], v[20:23], v[56:71]
    v_cvt_pk_bf16_f32 v140, v48, v49
    v_exp_f32 v52, v52
    v_exp_f32 v53, v53
    v_cvt_pk_bf16_f32 v141, v50, v51
    v_exp_f32 v54, v54
    v_exp_f32 v55, v55
    v_cvt_pk_bf16_f32 v142, v52, v53
    v_cvt_pk_bf16_f32 v143, v54, v55
    s_nop 1
    buffer_load_dwordx4 v[156:159], v7, s[12:15], s22 offen offset:0
    buffer_load_dwordx4 v[160:163], v7, s[12:15], s22 offen offset:1024
    buffer_load_dwordx4 v[164:167], v7, s[12:15], s23 offen offset:0
    buffer_load_dwordx4 v[168:171], v7, s[12:15], s23 offen offset:1024
    s_add_u32 s21, s21, 2048
    s_waitcnt vmcnt(8)
    v_mfma_f32_32x32x16_bf16 v[40:55], v[188:191], v[8:11], v[72:87]
    v_max3_f32 v153, v56, v57, v58
    v_max3_f32 v4, v59, v60, v61
    v_max3_f32 v153, v153, v62, v63
    v_max3_f32 v4, v4, v64, v65
    v_max3_f32 v153, v153, v66, v67
    v_max3_f32 v4, v4, v68, v69
    v_max3_f32 v153, v153, v70, v71
    v_max_f32 v153, v153, v4
    v_cmp_lt_f32 vcc, s25, v153
    s_cbranch_vccnz L_rare_b3
L_back_b3:
    v_exp_f32 v56, v56
    v_exp_f32 v57, v57
    v_mfma_f32_32x32x16_bf16 v[40:55], v[192:195], v[12:15], v[40:55]
    v_exp_f32 v58, v58
    v_exp_f32 v59, v59
    v_cvt_pk_bf16_f32 v144, v56, v57
    v_exp_f32 v60, v60
    v_exp_f32 v61, v61
    v_cvt_pk_bf16_f32 v145, v58, v59
    v_exp_f32 v62, v62
    v_mfma_f32_32x32x16_bf16 v[104:119], v[180:183], v[136:139], v[104:119]
    v_exp_f32 v63, v63
    v_cvt_pk_bf16_f32 v146, v60, v61
    v_exp_f32 v64, v64
    v_exp_f32 v65, v65
    v_cvt_pk_bf16_f32 v147, v62, v63
    v_exp_f32 v66, v66
    v_exp_f32 v67, v67
    v_mfma_f32_32x32x16_bf16 v[104:119], v[184:187], v[140:143], v[104:119]
    v_cvt_pk_bf16_f32 v148, v64, v65
    v_exp_f32 v68, v68
    v_exp_f32 v69, v69
    v_cvt_pk_bf16_f32 v149, v66, v67
    v_exp_f32 v70, v70
    v_exp_f32 v71, v71
    v_cvt_pk_bf16_f32 v150, v68, v69
    v_cvt_pk_bf16_f32 v151, v70, v71
    s_nop 1
    s_add_u32 s22, s21, 6144
    s_and_b32 s22, s22, 0x1ffff
    s_add_u32 s23, s22, s20
    v_mfma_f32_32x32x16_bf16 v[120:135], v[180:183], v[144:147], v[120:135]
    v_max3_f32 v152, v40, v41, v42
    v_max3_f32 v4, v43, v44, v45
    v_max3_f32 v152, v152, v46, v47
    v_max3_f32 v4, v4, v48, v49
    v_max3_f32 v152, v152, v50, v51
    v_max3_f32 v4, v4, v52, v53
    v_max3_f32 v152, v152, v54, v55
    v_max_f32 v152, v152, v4
    v_cmp_lt_f32 vcc, s25, v152
    s_cbranch_vccnz L_rare_a3
L_back_a3:
    v_exp_f32 v40, v40
    v_exp_f32 v41, v41
    v_mfma_f32_32x32x16_bf16 v[120:135], v[184:187], v[148:151], v[120:135]
    v_exp_f32 v42, v42
    v_exp_f32 v43, v43
    v_cvt_pk_bf16_f32 v136, v40, v41
    v_exp_f32 v44, v44
    v_exp_f32 v45, v45
    v_cvt_pk_bf16_f32 v137, v42, v43
    v_exp_f32 v46, v46
    v_mfma_f32_32x32x16_bf16 v[56:71], v[188:191], v[16:19], v[88:103]
    v_exp_f32 v47, v47
    v_cvt_pk_bf16_f32 v138, v44, v45
    v_exp_f32 v48, v48
    v_exp_f32 v49, v49
    v_cvt_pk_bf16_f32 v139, v46, v47
    v_exp_f32 v50, v50
    v_exp_f32 v51, v51
    v_mfma_f32_32x32x16_bf16 v[56:71], v[192:195], v[20:23], v[56:71]
    v_cvt_pk_bf16_f32 v140, v48, v49
    v_exp_f32 v52, v52
    v_exp_f32 v53, v53
    v_cvt_pk_bf16_f32 v141, v50, v51
    v_exp_f32 v54, v54
    v_exp_f32 v55, v55
    v_cvt_pk_bf16_f32 v142, v52, v53
    v_cvt_pk_bf16_f32 v143, v54, v55
    s_nop 1
    buffer_load_dwordx4 v[172:175], v7, s[12:15], s22 offen offset:0
    buffer_load_dwordx4 v[176:179], v7, s[12:15], s22 offen offset:1024
    buffer_load_dwordx4 v[180:183], v7, s[12:15], s23 offen offset:0
    buffer_load_dwordx4 v[184:187], v7, s[12:15], s23 offen offset:1024
    s_add_u32 s21, s21, 2048
    s_cmp_ge_u32 s21, 0x20000
    s_cbranch_scc1 L_attn_tail
    s_waitcnt vmcnt(8)
    v_mfma_f32_32x32x16_bf16 v[40:55], v[24:27], v[8:11], v[72:87]
    v_max3_f32 v153, v56, v57, v58
    v_max3_f32 v4, v59, v60, v61
    v_max3_f32 v153, v153, v62, v63
    v_max3_f32 v4, v4, v64, v65
    v_max3_f32 v153, v153, v66, v67
    v_max3_f32 v4, v4, v68, v69
    v_max3_f32 v153, v153, v70, v71
    v_max_f32 v153, v153, v4
    v_cmp_lt_f32 vcc, s25, v153
    s_cbranch_vccnz L_rare_b0
L_back_b0:
    v_exp_f32 v56, v56
    v_exp_f32 v57, v57
    v_mfma_f32_32x32x16_bf16 v[40:55], v[28:31], v[12:15], v[40:55]
    v_exp_f32 v58, v58
    v_exp_f32 v59, v59
    v_cvt_pk_bf16_f32 v144, v56, v57
    v_exp_f32 v60, v60
    v_exp_f32 v61, v61
    v_cvt_pk_bf16_f32 v145, v58, v59
    v_exp_f32 v62, v62
    v_mfma_f32_32x32x16_bf16 v[104:119], v[196:199], v[136:139], v[104:119]
    v_exp_f32 v63, v63
    v_cvt_pk_bf16_f32 v146, v60, v61
    v_exp_f32 v64, v64
    v_exp_f32 v65, v65
    v_cvt_pk_bf16_f32 v147, v62, v63
    v_exp_f32 v66, v66
    v_exp_f32 v67, v67
    v_mfma_f32_32x32x16_bf16 v[104:119], v[200:203], v[140:143], v[104:119]
    v_cvt_pk_bf16_f32 v148, v64, v65
    v_exp_f32 v68, v68
    v_exp_f32 v69, v69
    v_cvt_pk_bf16_f32 v149, v66, v67
    v_exp_f32 v70, v70
    v_exp_f32 v71, v71
    v_cvt_pk_bf16_f32 v150, v68, v69
    v_cvt_pk_bf16_f32 v151, v70, v71
    s_nop 1
    s_add_u32 s22, s21, 6144
    s_and_b32 s22, s22, 0x1ffff
    s_add_u32 s23, s22, s20
    v_mfma_f32_32x32x16_bf16 v[120:135], v[196:199], v[144:147], v[120:135]
    v_max3_f32 v152, v40, v41, v42
    v_max3_f32 v4, v43, v44, v45
    v_max3_f32 v152, v152, v46, v47
    v_max3_f32 v4, v4, v48, v49
    v_max3_f32 v152, v152, v50, v51
    v_max3_f32 v4, v4, v52, v53
    v_max3_f32 v152, v152, v54, v55
    v_max_f32 v152, v152, v4
    v_cmp_lt_f32 vcc, s25, v152
    s_cbranch_vccnz L_rare_a0
L_back_a0:
    v_exp_f32 v40, v40
    v_exp_f32 v41, v41
    v_mfma_f32_32x32x16_bf16 v[120:135], v[200:203], v[148:151], v[120:135]
    v_exp_f32 v42, v42
    v_exp_f32 v43, v43
    v_cvt_pk_bf16_f32 v136, v40, v41
    v_exp_f32 v44, v44
    v_exp_f32 v45, v45
    v_cvt_pk_bf16_f32 v137, v42, v43
    v_exp_f32 v46, v46
    v_mfma_f32_32x32x16_bf16 v[56:71], v[24:27], v[16:19], v[88:103]
    v_exp_f32 v47, v47
    v_cvt_pk_bf16_f32 v138, v44, v45
    v_exp_f32 v48, v48
    v_exp_f32 v49, v49
    v_cvt_pk_bf16_f32 v139, v46, v47
    v_exp_f32 v50, v50
    v_exp_f32 v51, v51
    v_mfma_f32_32x32x16_bf16 v[56:71], v[28:31], v[20:23], v[56:71]
    v_cvt_pk_bf16_f32 v140, v48, v49
    v_exp_f32 v52, v52
    v_exp_f32 v53, v53
    v_cvt_pk_bf16_f32 v141, v50, v51
    v_exp_f32 v54, v54
    v_exp_f32 v55, v55
    v_cvt_pk_bf16_f32 v142, v52, v53
    v_cvt_pk_bf16_f32 v143, v54, v55
    s_nop 1
    buffer_load_dwordx4 v[188:191], v7, s[12:15], s22 offen offset:0
    buffer_load_dwordx4 v[192:195], v7, s[12:15], s22 offen offset:1024
    buffer_load_dwordx4 v[196:199], v7, s[12:15], s23 offen offset:0
    buffer_load_dwordx4 v[200:203], v7, s[12:15], s23 offen offset:1024
    s_add_u32 s21, s21, 2048
    s_branch L_attn_loop
L_attn_tail:
    v_mfma_f32_32x32x16_bf16 v[104:119], v[196:199], v[136:139], v[104:119]
    v_max3_f32 v153, v56, v57, v58
    v_max3_f32 v4, v59, v60, v61
    v_max3_f32 v153, v153, v62, v63
    v_max3_f32 v4, v4, v64, v65
    v_max3_f32 v153, v153, v66, v67
    v_max3_f32 v4, v4, v68, v69
    v_max3_f32 v153, v153, v70, v71
    v_max_f32 v153, v153, v4
    v_cmp_lt_f32 vcc, s25, v153
    s_cbranch_vccnz L_rare_tb
L_back_tb:
    v_exp_f32 v56, v56
    v_exp_f32 v57, v57
    v_mfma_f32_32x32x16_bf16 v[104:119], v[200:203], v[140:143], v[104:119]
    v_exp_f32 v58, v58
    v_exp_f32 v59, v59
    v_cvt_pk_bf16_f32 v144, v56, v57
    v_exp_f32 v60, v60
    v_exp_f32 v61, v61
    v_cvt_pk_bf16_f32 v145, v58, v59
    v_exp_f32 v62, v62
    v_exp_f32 v63, v63
    v_cvt_pk_bf16_f32 v146, v60, v61
    v_exp_f32 v64, v64
    v_exp_f32 v65, v65
    v_cvt_pk_bf16_f32 v147, v62, v63
    v_exp_f32 v66, v66
    v_exp_f32 v67, v67
    v_cvt_pk_bf16_f32 v148, v64, v65
    v_exp_f32 v68, v68
    v_exp_f32 v69, v69
    v_cvt_pk_bf16_f32 v149, v66, v67
    v_exp_f32 v70, v70
    v_exp_f32 v71, v71
    v_cvt_pk_bf16_f32 v150, v68, v69
    v_cvt_pk_bf16_f32 v151, v70, v71
    s_nop 1
    v_mfma_f32_32x32x16_bf16 v[120:135], v[196:199], v[144:147], v[120:135]
    v_mfma_f32_32x32x16_bf16 v[120:135], v[200:203], v[148:151], v[120:135]
    s_branch L_attn_epi
L_rare_pa:
    v_mov_b32 v4, v152
    s_nop 1
    v_permlane32_swap_b32 v4, v152
    s_nop 1
    v_max_f32 v152, v152, v4
    v_max_f32 v152, 0, v152
    v_exp_f32 v4, -v152
    v_sub_f32 v72, v72, v152
    v_sub_f32 v40, v40, v152
    v_sub_f32 v73, v73, v152
    v_sub_f32 v41, v41, v152
    v_sub_f32 v74, v74, v152
    v_sub_f32 v42, v42, v152
    v_sub_f32 v75, v75, v152
    v_sub_f32 v43, v43, v152
    v_sub_f32 v76, v76, v152
    v_sub_f32 v44, v44, v152
    v_sub_f32 v77, v77, v152
    v_sub_f32 v45, v45, v152
    v_sub_f32 v78, v78, v152
    v_sub_f32 v46, v46, v152
    v_sub_f32 v79, v79, v152
    v_sub_f32 v47, v47, v152
    v_sub_f32 v80, v80, v152
    v_sub_f32 v48, v48, v152
    v_sub_f32 v81, v81, v152
    v_sub_f32 v49, v49, v152
    v_sub_f32 v82, v82, v152
    v_sub_f32 v50, v50, v152
    v_sub_f32 v83, v83, v152
    v_sub_f32 v51, v51, v152
    v_sub_f32 v84, v84, v152
    v_sub_f32 v52, v52, v152
    v_sub_f32 v85, v85, v152
    v_sub_f32 v53, v53, v152
    v_sub_f32 v86, v86, v152
    v_sub_f32 v54, v54, v152
    v_sub_f32 v87, v87, v152
    v_sub_f32 v55, v55, v152
    v_mul_f32 v104, v104, v4
    v_mul_f32 v105, v105, v4
    v_mul_f32 v106, v106, v4
    v_mul_f32 v107, v107, v4
    v_mul_f32 v108, v108, v4
    v_mul_f32 v109, v109, v4
    v_mul_f32 v110, v110, v4
    v_mul_f32 v111, v111, v4
    v_mul_f32 v112, v112, v4
    v_mul_f32 v113, v113, v4
    v_mul_f32 v114, v114, v4
    v_mul_f32 v115, v115, v4
    v_mul_f32 v116, v116, v4
    v_mul_f32 v117, v117, v4
    v_mul_f32 v118, v118, v4
    v_mul_f32 v119, v119, v4
    s_branch L_back_pa
L_rare_b1:
    v_mov_b32 v4, v153
    s_nop 1
    v_permlane32_swap_b32 v4, v153
    s_nop 1
    v_max_f32 v153, v153, v4
    v_max_f32 v153, 0, v153
    v_exp_f32 v4, -v153
    v_sub_f32 v88, v88, v153
    v_sub_f32 v56, v56, v153
    v_sub_f32 v89, v89, v153
    v_sub_f32 v57, v57, v153
    v_sub_f32 v90, v90, v153
    v_sub_f32 v58, v58, v153
    v_sub_f32 v91, v91, v153
    v_sub_f32 v59, v59, v153
    v_sub_f32 v92, v92, v153
    v_sub_f32 v60, v60, v153
    v_sub_f32 v93, v93, v153
    v_sub_f32 v61, v61, v153
    v_sub_f32 v94, v94, v153
    v_sub_f32 v62, v62, v153
    v_sub_f32 v95, v95, v153
    v_sub_f32 v63, v63, v153
    v_sub_f32 v96, v96, v153
    v_sub_f32 v64, v64, v153
    v_sub_f32 v97, v97, v153
    v_sub_f32 v65, v65, v153
    v_sub_f32 v98, v98, v153
    v_sub_f32 v66, v66, v153
    v_sub_f32 v99, v99, v153
    v_sub_f32 v67, v67, v153
    v_sub_f32 v100, v100, v153
    v_sub_f32 v68, v68, v153
    v_sub_f32 v101, v101, v153
    v_sub_f32 v69, v69, v153
    v_sub_f32 v102, v102, v153
    v_sub_f32 v70, v70, v153
    v_sub_f32 v103, v103, v153
    v_sub_f32 v71, v71, v153
    v_mul_f32 v120, v120, v4
    v_mul_f32 v121, v121, v4
    v_mul_f32 v122, v122, v4
    v_mul_f32 v123, v123, v4
    v_mul_f32 v124, v124, v4
    v_mul_f32 v125, v125, v4
    v_mul_f32 v126, v126, v4
    v_mul_f32 v127, v127, v4
    v_mul_f32 v128, v128, v4
    v_mul_f32 v129, v129, v4
    v_mul_f32 v130, v130, v4
    v_mul_f32 v131, v131, v4
    v_mul_f32 v132, v132, v4
    v_mul_f32 v133, v133, v4
    v_mul_f32 v134, v134, v4
    v_mul_f32 v135, v135, v4
    s_branch L_back_b1
L_rare_a1:
    v_mov_b32 v4, v152
    s_nop 1
    v_permlane32_swap_b32 v4, v152
    s_nop 1
    v_max_f32 v152, v152, v4
    v_max_f32 v152, 0, v152
    v_exp_f32 v4, -v152
    v_sub_f32 v72, v72, v152
    v_sub_f32 v40, v40, v152
    v_sub_f32 v73, v73, v152
    v_sub_f32 v41, v41, v152
    v_sub_f32 v74, v74, v152
    v_sub_f32 v42, v42, v152
    v_sub_f32 v75, v75, v152
    v_sub_f32 v43, v43, v152
    v_sub_f32 v76, v76, v152
    v_sub_f32 v44, v44, v152
    v_sub_f32 v77, v77, v152
    v_sub_f32 v45, v45, v152
    v_sub_f32 v78, v78, v152
    v_sub_f32 v46, v46, v152
    v_sub_f32 v79, v79, v152
    v_sub_f32 v47, v47, v152
    v_sub_f32 v80, v80, v152
    v_sub_f32 v48, v48, v152
    v_sub_f32 v81, v81, v152
    v_sub_f32 v49, v49, v152
    v_sub_f32 v82, v82, v152
    v_sub_f32 v50, v50, v152
    v_sub_f32 v83, v83, v152
    v_sub_f32 v51, v51, v152
    v_sub_f32 v84, v84, v152
    v_sub_f32 v52, v52, v152
    v_sub_f32 v85, v85, v152
    v_sub_f32 v53, v53, v152
    v_sub_f32 v86, v86, v152
    v_sub_f32 v54, v54, v152
    v_sub_f32 v87, v87, v152
    v_sub_f32 v55, v55, v152
    v_mul_f32 v104, v104, v4
    v_mul_f32 v105, v105, v4
    v_mul_f32 v106, v106, v4
    v_mul_f32 v107, v107, v4
    v_mul_f32 v108, v108, v4
    v_mul_f32 v109, v109, v4
    v_mul_f32 v110, v110, v4
    v_mul_f32 v111, v111, v4
    v_mul_f32 v112, v112, v4
    v_mul_f32 v113, v113, v4
    v_mul_f32 v114, v114, v4
    v_mul_f32 v115, v115, v4
    v_mul_f32 v116, v116, v4
    v_mul_f32 v117, v117, v4
    v_mul_f32 v118, v118, v4
    v_mul_f32 v119, v119, v4
    s_branch L_back_a1
L_rare_b2:
    v_mov_b32 v4, v153
    s_nop 1
    v_permlane32_swap_b32 v4, v153
    s_nop 1
    v_max_f32 v153, v153, v4
    v_max_f32 v153, 0, v153
    v_exp_f32 v4, -v153
    v_sub_f32 v88, v88, v153
    v_sub_f32 v56, v56, v153
    v_sub_f32 v89, v89, v153
    v_sub_f32 v57, v57, v153
    v_sub_f32 v90, v90, v153
    v_sub_f32 v58, v58, v153
    v_sub_f32 v91, v91, v153
    v_sub_f32 v59, v59, v153
    v_sub_f32 v92, v92, v153
    v_sub_f32 v60, v60, v153
    v_sub_f32 v93, v93, v153
    v_sub_f32 v61, v61, v153
    v_sub_f32 v94, v94, v153
    v_sub_f32 v62, v62, v153
    v_sub_f32 v95, v95, v153
    v_sub_f32 v63, v63, v153
    v_sub_f32 v96, v96, v153
    v_sub_f32 v64, v64, v153
    v_sub_f32 v97, v97, v153
    v_sub_f32 v65, v65, v153
    v_sub_f32 v98, v98, v153
    v_sub_f32 v66, v66, v153
    v_sub_f32 v99, v99, v153
    v_sub_f32 v67, v67, v153
    v_sub_f32 v100, v100, v153
    v_sub_f32 v68, v68, v153
    v_sub_f32 v101, v101, v153
    v_sub_f32 v69, v69, v153
    v_sub_f32 v102, v102, v153
    v_sub_f32 v70, v70, v153
    v_sub_f32 v103, v103, v153
    v_sub_f32 v71, v71, v153
    v_mul_f32 v120, v120, v4
    v_mul_f32 v121, v121, v4
    v_mul_f32 v122, v122, v4
    v_mul_f32 v123, v123, v4
    v_mul_f32 v124, v124, v4
    v_mul_f32 v125, v125, v4
    v_mul_f32 v126, v126, v4
    v_mul_f32 v127, v127, v4
    v_mul_f32 v128, v128, v4
    v_mul_f32 v129, v129, v4
    v_mul_f32 v130, v130, v4
    v_mul_f32 v131, v131, v4
    v_mul_f32 v132, v132, v4
    v_mul_f32 v133, v133, v4
    v_mul_f32 v134, v134, v4
    v_mul_f32 v135, v135, v4
    s_branch L_back_b2
L_rare_a2:
    v_mov_b32 v4, v152
    s_nop 1
    v_permlane32_swap_b32 v4, v152
    s_nop 1
    v_max_f32 v152, v152, v4
    v_max_f32 v152, 0, v152
    v_exp_f32 v4, -v152
    v_sub_f32 v72, v72, v152
    v_sub_f32 v40, v40, v152
    v_sub_f32 v73, v73, v152
    v_sub_f32 v41, v41, v152
    v_sub_f32 v74, v74, v152
    v_sub_f32 v42, v42, v152
    v_sub_f32 v75, v75, v152
    v_sub_f32 v43, v43, v152
    v_sub_f32 v76, v76, v152
    v_sub_f32 v44, v44, v152
    v_sub_f32 v77, v77, v152
    v_sub_f32 v45, v45, v152
    v_sub_f32 v78, v78, v152
    v_sub_f32 v46, v46, v152
    v_sub_f32 v79, v79, v152
    v_sub_f32 v47, v47, v152
    v_sub_f32 v80, v80, v152
    v_sub_f32 v48, v48, v152
    v_sub_f32 v81, v81, v152
    v_sub_f32 v49, v49, v152
    v_sub_f32 v82, v82, v152
    v_sub_f32 v50, v50, v152
    v_sub_f32 v83, v83, v152
    v_sub_f32 v51, v51, v152
    v_sub_f32 v84, v84, v152
    v_sub_f32 v52, v52, v152
    v_sub_f32 v85, v85, v152
    v_sub_f32 v53, v53, v152
    v_sub_f32 v86, v86, v152
    v_sub_f32 v54, v54, v152
    v_sub_f32 v87, v87, v152
    v_sub_f32 v55, v55, v152
    v_mul_f32 v104, v104, v4
    v_mul_f32 v105, v105, v4
    v_mul_f32 v106, v106, v4
    v_mul_f32 v107, v107, v4
    v_mul_f32 v108, v108, v4
    v_mul_f32 v109, v109, v4
    v_mul_f32 v110, v110, v4
    v_mul_f32 v111, v111, v4
    v_mul_f32 v112, v112, v4
    v_mul_f32 v113, v113, v4
    v_mul_f32 v114, v114, v4
    v_mul_f32 v115, v115, v4
    v_mul_f32 v116, v116, v4
    v_mul_f32 v117, v117, v4
    v_mul_f32 v118, v118, v4
    v_mul_f32 v119, v119, v4
    s_branch L_back_a2
L_rare_b3:
    v_mov_b32 v4, v153
    s_nop 1
    v_permlane32_swap_b32 v4, v153
    s_nop 1
    v_max_f32 v153, v153, v4
    v_max_f32 v153, 0, v153
    v_exp_f32 v4, -v153
    v_sub_f32 v88, v88, v153
    v_sub_f32 v56, v56, v153
    v_sub_f32 v89, v89, v153
    v_sub_f32 v57, v57, v153
    v_sub_f32 v90, v90, v153
    v_sub_f32 v58, v58, v153
    v_sub_f32 v91, v91, v153
    v_sub_f32 v59, v59, v153
    v_sub_f32 v92, v92, v153
    v_sub_f32 v60, v60, v153
    v_sub_f32 v93, v93, v153
    v_sub_f32 v61, v61, v153
    v_sub_f32 v94, v94, v153
    v_sub_f32 v62, v62, v153
    v_sub_f32 v95, v95, v153
    v_sub_f32 v63, v63, v153
    v_sub_f32 v96, v96, v153
    v_sub_f32 v64, v64, v153
    v_sub_f32 v97, v97, v153
    v_sub_f32 v65, v65, v153
    v_sub_f32 v98, v98, v153
    v_sub_f32 v66, v66, v153
    v_sub_f32 v99, v99, v153
    v_sub_f32 v67, v67, v153
    v_sub_f32 v100, v100, v153
    v_sub_f32 v68, v68, v153
    v_sub_f32 v101, v101, v153
    v_sub_f32 v69, v69, v153
    v_sub_f32 v102, v102, v153
    v_sub_f32 v70, v70, v153
    v_sub_f32 v103, v103, v153
    v_sub_f32 v71, v71, v153
    v_mul_f32 v120, v120, v4
    v_mul_f32 v121, v121, v4
    v_mul_f32 v122, v122, v4
    v_mul_f32 v123, v123, v4
    v_mul_f32 v124, v124, v4
    v_mul_f32 v125, v125, v4
    v_mul_f32 v126, v126, v4
    v_mul_f32 v127, v127, v4
    v_mul_f32 v128, v128, v4
    v_mul_f32 v129, v129, v4
    v_mul_f32 v130, v130, v4
    v_mul_f32 v131, v131, v4
    v_mul_f32 v132, v132, v4
    v_mul_f32 v133, v133, v4
    v_mul_f32 v134, v134, v4
    v_mul_f32 v135, v135, v4
    s_branch L_back_b3
L_rare_a3:
    v_mov_b32 v4, v152
    s_nop 1
    v_permlane32_swap_b32 v4, v152
    s_nop 1
    v_max_f32 v152, v152, v4
    v_max_f32 v152, 0, v152
    v_exp_f32 v4, -v152
    v_sub_f32 v72, v72, v152
    v_sub_f32 v40, v40, v152
    v_sub_f32 v73, v73, v152
    v_sub_f32 v41, v41, v152
    v_sub_f32 v74, v74, v152
    v_sub_f32 v42, v42, v152
    v_sub_f32 v75, v75, v152
    v_sub_f32 v43, v43, v152
    v_sub_f32 v76, v76, v152
    v_sub_f32 v44, v44, v152
    v_sub_f32 v77, v77, v152
    v_sub_f32 v45, v45, v152
    v_sub_f32 v78, v78, v152
    v_sub_f32 v46, v46, v152
    v_sub_f32 v79, v79, v152
    v_sub_f32 v47, v47, v152
    v_sub_f32 v80, v80, v152
    v_sub_f32 v48, v48, v152
    v_sub_f32 v81, v81, v152
    v_sub_f32 v49, v49, v152
    v_sub_f32 v82, v82, v152
    v_sub_f32 v50, v50, v152
    v_sub_f32 v83, v83, v152
    v_sub_f32 v51, v51, v152
    v_sub_f32 v84, v84, v152
    v_sub_f32 v52, v52, v152
    v_sub_f32 v85, v85, v152
    v_sub_f32 v53, v53, v152
    v_sub_f32 v86, v86, v152
    v_sub_f32 v54, v54, v152
    v_sub_f32 v87, v87, v152
    v_sub_f32 v55, v55, v152
    v_mul_f32 v104, v104, v4
    v_mul_f32 v105, v105, v4
    v_mul_f32 v106, v106, v4
    v_mul_f32 v107, v107, v4
    v_mul_f32 v108, v108, v4
    v_mul_f32 v109, v109, v4
    v_mul_f32 v110, v110, v4
    v_mul_f32 v111, v111, v4
    v_mul_f32 v112, v112, v4
    v_mul_f32 v113, v113, v4
    v_mul_f32 v114, v114, v4
    v_mul_f32 v115, v115, v4
    v_mul_f32 v116, v116, v4
    v_mul_f32 v117, v117, v4
    v_mul_f32 v118, v118, v4
    v_mul_f32 v119, v119, v4
    s_branch L_back_a3
L_rare_b0:
    v_mov_b32 v4, v153
    s_nop 1
    v_permlane32_swap_b32 v4, v153
    s_nop 1
    v_max_f32 v153, v153, v4
    v_max_f32 v153, 0, v153
    v_exp_f32 v4, -v153
    v_sub_f32 v88, v88, v153
    v_sub_f32 v56, v56, v153
    v_sub_f32 v89, v89, v153
    v_sub_f32 v57, v57, v153
    v_sub_f32 v90, v90, v153
    v_sub_f32 v58, v58, v153
    v_sub_f32 v91, v91, v153
    v_sub_f32 v59, v59, v153
    v_sub_f32 v92, v92, v153
    v_sub_f32 v60, v60, v153
    v_sub_f32 v93, v93, v153
    v_sub_f32 v61, v61, v153
    v_sub_f32 v94, v94, v153
    v_sub_f32 v62, v62, v153
    v_sub_f32 v95, v95, v153
    v_sub_f32 v63, v63, v153
    v_sub_f32 v96, v96, v153
    v_sub_f32 v64, v64, v153
    v_sub_f32 v97, v97, v153
    v_sub_f32 v65, v65, v153
    v_sub_f32 v98, v98, v153
    v_sub_f32 v66, v66, v153
    v_sub_f32 v99, v99, v153
    v_sub_f32 v67, v67, v153
    v_sub_f32 v100, v100, v153
    v_sub_f32 v68, v68, v153
    v_sub_f32 v101, v101, v153
    v_sub_f32 v69, v69, v153
    v_sub_f32 v102, v102, v153
    v_sub_f32 v70, v70, v153
    v_sub_f32 v103, v103, v153
    v_sub_f32 v71, v71, v153
    v_mul_f32 v120, v120, v4
    v_mul_f32 v121, v121, v4
    v_mul_f32 v122, v122, v4
    v_mul_f32 v123, v123, v4
    v_mul_f32 v124, v124, v4
    v_mul_f32 v125, v125, v4
    v_mul_f32 v126, v126, v4
    v_mul_f32 v127, v127, v4
    v_mul_f32 v128, v128, v4
    v_mul_f32 v129, v129, v4
    v_mul_f32 v130, v130, v4
    v_mul_f32 v131, v131, v4
    v_mul_f32 v132, v132, v4
    v_mul_f32 v133, v133, v4
    v_mul_f32 v134, v134, v4
    v_mul_f32 v135, v135, v4
    s_branch L_back_b0
L_rare_a0:
    v_mov_b32 v4, v152
    s_nop 1
    v_permlane32_swap_b32 v4, v152
    s_nop 1
    v_max_f32 v152, v152, v4
    v_max_f32 v152, 0, v152
    v_exp_f32 v4, -v152
    v_sub_f32 v72, v72, v152
    v_sub_f32 v40, v40, v152
    v_sub_f32 v73, v73, v152
    v_sub_f32 v41, v41, v152
    v_sub_f32 v74, v74, v152
    v_sub_f32 v42, v42, v152
    v_sub_f32 v75, v75, v152
    v_sub_f32 v43, v43, v152
    v_sub_f32 v76, v76, v152
    v_sub_f32 v44, v44, v152
    v_sub_f32 v77, v77, v152
    v_sub_f32 v45, v45, v152
    v_sub_f32 v78, v78, v152
    v_sub_f32 v46, v46, v152
    v_sub_f32 v79, v79, v152
    v_sub_f32 v47, v47, v152
    v_sub_f32 v80, v80, v152
    v_sub_f32 v48, v48, v152
    v_sub_f32 v81, v81, v152
    v_sub_f32 v49, v49, v152
    v_sub_f32 v82, v82, v152
    v_sub_f32 v50, v50, v152
    v_sub_f32 v83, v83, v152
    v_sub_f32 v51, v51, v152
    v_sub_f32 v84, v84, v152
    v_sub_f32 v52, v52, v152
    v_sub_f32 v85, v85, v152
    v_sub_f32 v53, v53, v152
    v_sub_f32 v86, v86, v152
    v_sub_f32 v54, v54, v152
    v_sub_f32 v87, v87, v152
    v_sub_f32 v55, v55, v152
    v_mul_f32 v104, v104, v4
    v_mul_f32 v105, v105, v4
    v_mul_f32 v106, v106, v4
    v_mul_f32 v107, v107, v4
    v_mul_f32 v108, v108, v4
    v_mul_f32 v109, v109, v4
    v_mul_f32 v110, v110, v4
    v_mul_f32 v111, v111, v4
    v_mul_f32 v112, v112, v4
    v_mul_f32 v113, v113, v4
    v_mul_f32 v114, v114, v4
    v_mul_f32 v115, v115, v4
    v_mul_f32 v116, v116, v4
    v_mul_f32 v117, v117, v4
    v_mul_f32 v118, v118, v4
    v_mul_f32 v119, v119, v4
    s_branch L_back_a0
L_rare_tb:
    v_mov_b32 v4, v153
    s_nop 1
    v_permlane32_swap_b32 v4, v153
    s_nop 1
    v_max_f32 v153, v153, v4
    v_max_f32 v153, 0, v153
    v_exp_f32 v4, -v153
    v_sub_f32 v88, v88, v153
    v_sub_f32 v56, v56, v153
    v_sub_f32 v89, v89, v153
    v_sub_f32 v57, v57, v153
    v_sub_f32 v90, v90, v153
    v_sub_f32 v58, v58, v153
    v_sub_f32 v91, v91, v153
    v_sub_f32 v59, v59, v153
    v_sub_f32 v92, v92, v153
    v_sub_f32 v60, v60, v153
    v_sub_f32 v93, v93, v153
    v_sub_f32 v61, v61, v153
    v_sub_f32 v94, v94, v153
    v_sub_f32 v62, v62, v153
    v_sub_f32 v95, v95, v153
    v_sub_f32 v63, v63, v153
    v_sub_f32 v96, v96, v153
    v_sub_f32 v64, v64, v153
    v_sub_f32 v97, v97, v153
    v_sub_f32 v65, v65, v153
    v_sub_f32 v98, v98, v153
    v_sub_f32 v66, v66, v153
    v_sub_f32 v99, v99, v153
    v_sub_f32 v67, v67, v153
    v_sub_f32 v100, v100, v153
    v_sub_f32 v68, v68, v153
    v_sub_f32 v101, v101, v153
    v_sub_f32 v69, v69, v153
    v_sub_f32 v102, v102, v153
    v_sub_f32 v70, v70, v153
    v_sub_f32 v103, v103, v153
    v_sub_f32 v71, v71, v153
    v_mul_f32 v120, v120, v4
    v_mul_f32 v121, v121, v4
    v_mul_f32 v122, v122, v4
    v_mul_f32 v123, v123, v4
    v_mul_f32 v124, v124, v4
    v_mul_f32 v125, v125, v4
    v_mul_f32 v126, v126, v4
    v_mul_f32 v127, v127, v4
    v_mul_f32 v128, v128, v4
    v_mul_f32 v129, v129, v4
    v_mul_f32 v130, v130, v4
    v_mul_f32 v131, v131, v4
    v_mul_f32 v132, v132, v4
    v_mul_f32 v133, v133, v4
    v_mul_f32 v134, v134, v4
    v_mul_f32 v135, v135, v4
    s_branch L_back_tb
L_attn_epi:
    s_nop 15
    v_and_b32 v1, 31, v0
    v_or_b32 v1, 32, v1
    v_lshlrev_b32 v1, 2, v1
    v_bfe_u32 v2, v0, 5, 1
    v_lshlrev_b32 v2, 22, v2
    v_add_u32 v2, v6, v2
    ds_bpermute_b32 v3, v1, v112
    s_waitcnt lgkmcnt(0)
    v_rcp_f32 v3, v3
    s_nop 0
    v_mul_f32 v104, v104, v3
    v_mul_f32 v105, v105, v3
    v_mul_f32 v106, v106, v3
    v_mul_f32 v107, v107, v3
    v_mul_f32 v108, v108, v3
    v_mul_f32 v109, v109, v3
    v_mul_f32 v110, v110, v3
    v_mul_f32 v111, v111, v3
    v_mul_f32 v112, v112, v3
    v_mul_f32 v113, v113, v3
    v_mul_f32 v114, v114, v3
    v_mul_f32 v115, v115, v3
    v_cvt_pk_bf16_f32 v136, v104, v105
    v_cvt_pk_bf16_f32 v137, v106, v107
    v_cvt_pk_bf16_f32 v138, v108, v109
    v_cvt_pk_bf16_f32 v139, v110, v111
    v_cvt_pk_bf16_f32 v140, v112, v113
    v_cvt_pk_bf16_f32 v141, v114, v115
    buffer_store_dwordx2 v[136:137], v6, s[16:19], 0 offen offset:0
    buffer_store_dwordx2 v[138:139], v6, s[16:19], 0 offen offset:16
    buffer_store_dwordx2 v[140:141], v2, s[16:19], 0 offen offset:32
    s_nop 1
    ds_bpermute_b32 v3, v1, v128
    s_waitcnt lgkmcnt(0)
    v_rcp_f32 v3, v3
    s_nop 0
    v_mul_f32 v120, v120, v3
    v_mul_f32 v121, v121, v3
    v_mul_f32 v122, v122, v3
    v_mul_f32 v123, v123, v3
    v_mul_f32 v124, v124, v3
    v_mul_f32 v125, v125, v3
    v_mul_f32 v126, v126, v3
    v_mul_f32 v127, v127, v3
    v_mul_f32 v128, v128, v3
    v_mul_f32 v129, v129, v3
    v_mul_f32 v130, v130, v3
    v_mul_f32 v131, v131, v3
    v_cvt_pk_bf16_f32 v136, v120, v121
    v_cvt_pk_bf16_f32 v137, v122, v123
    v_cvt_pk_bf16_f32 v138, v124, v125
    v_cvt_pk_bf16_f32 v139, v126, v127
    v_cvt_pk_bf16_f32 v140, v128, v129
    v_cvt_pk_bf16_f32 v141, v130, v131
    buffer_store_dwordx2 v[136:137], v6, s[16:19], 0 offen offset:1280
    buffer_store_dwordx2 v[138:139], v6, s[16:19], 0 offen offset:1296
    buffer_store_dwordx2 v[140:141], v2, s[16:19], 0 offen offset:1312
    s_nop 1
L_END_k2_attn_kernel:
    s_endpgm
.globl k3_wo_kernel
.p2align 8
.type k3_wo_kernel,@function
k3_wo_kernel:
    s_cmp_ge_u32 s2, 256
    s_cbranch_scc1 L_END_k3_wo_kernel
    s_load_dwordx16 s[36:51], s[0:1], 0
    s_load_dwordx8 s[52:59], s[0:1], 64
    s_load_dwordx2 s[60:61], s[0:1], 96
    s_and_b32 s3, s2, 31
    s_lshr_b32 s4, s2, 5
    s_waitcnt lgkmcnt(0)
    s_add_u32 s8, s60, 0x300000
    s_addc_u32 s9, s61, 0
    s_mov_b32 s10, 0x280000
    s_mov_b32 s11, 0x00020000
    s_mov_b32 s12, s44
    s_mov_b32 s13, s45
    s_mov_b32 s14, 0xc8000
    s_mov_b32 s15, 0x00020000
    s_add_u32 s16, s60, 0x580000
    s_addc_u32 s17, s61, 0
    s_mov_b32 s18, 0x280000
    s_mov_b32 s19, 0x00020000
    s_mov_b32 s20, s36
    s_mov_b32 s21, s37
    s_mov_b32 s22, 0x280000
    s_mov_b32 s23, 0x00020000
    v_and_b32 v1, 15, v0
    v_bfe_u32 v2, v0, 4, 2
    v_lshrrev_b32 v3, 6, v0
    v_lshlrev_b32 v3, 4, v3
    v_add_u32 v3, v3, v1
    s_mul_i32 s5, s3, 64
    v_add_u32 v3, s5, v3
    v_mov_b32 v10, v3
    v_and_b32 v4, 63, v0
    v_xor_b32 v17, 32, v4
    v_lshlrev_b32 v17, 2, v17
    s_mov_b32 s6, 1280
    v_lshlrev_b32 v5, 4, v2
    v_mov_b32 v4, v3
    v_mul_lo_u32 v4, v4, s6
    v_add_u32 v18, v4, v5
    v_mov_b32 v28, 0
    v_mov_b32 v29, 0
    v_mov_b32 v30, 0
    v_mov_b32 v31, 0
    v_mov_b32 v32, 0
    v_mov_b32 v33, 0
    v_mov_b32 v34, 0
    v_mov_b32 v35, 0
    v_mov_b32 v36, 0
    v_mov_b32 v37, 0
    v_mov_b32 v38, 0
    v_mov_b32 v39, 0
    v_mov_b32 v40, 0
    v_mov_b32 v41, 0
    v_mov_b32 v42, 0
    v_mov_b32 v43, 0
    v_mov_b32 v44, 0
    v_mov_b32 v45, 0
    v_mov_b32 v46, 0
    v_mov_b32 v47, 0
    v_lshrrev_b32 v4, 2, v1
    v_lshl_add_u32 v4, v2, 3, v4
    s_mov_b32 s7, 160
    v_mul_lo_u32 v4, v4, s7
    v_and_b32 v5, 3, v1
    v_lshl_add_u32 v23, v5, 3, v4
    s_mul_i32 s4, s4, 160
    v_and_b32 v4, 63, v0
    v_mul_u32_u24 v5, 6554, v4
    v_lshrrev_b32 v5, 16, v5
    v_mul_u32_u24 v6, 10, v5
    v_sub_u32 v6, v4, v6
    s_mov_b32 s66, 1280
    v_mul_lo_u32 v5, v5, s66
    v_lshl_add_u32 v25, v6, 4, v5
    v_lshrrev_b32 v4, 6, v0
    s_nop 1
    v_readfirstlane_b32 s64, v4
    s_nop 3
    s_mul_i32 s65, s64, 960
    s_mul_i32 s67, s64, 7680
    s_add_u32 s67, s67, s4
    buffer_load_dwordx4 v[136:139], v18, s[8:11], 0 offen offset:0
    buffer_load_dwordx4 v[140:143], v18, s[8:11], 0 offen offset:64
    buffer_load_dwordx4 v[144:147], v18, s[8:11], 0 offen offset:128
    buffer_load_dwordx4 v[148:151], v18, s[8:11], 0 offen offset:192
    buffer_load_dwordx4 v[152:155], v18, s[8:11], 0 offen offset:256
    s_mov_b32 s6, 1280
    v_mul_lo_u32 v24, v10, s6
    v_lshl_add_u32 v24, v2, 3, v24
    v_add_u32 v24, s4, v24
    buffer_load_dwordx2 v[216:217], v24, s[20:23], 0 offen offset:0
    buffer_load_dwordx2 v[220:221], v24, s[20:23], 0 offen offset:32
    buffer_load_dwordx2 v[224:225], v24, s[20:23], 0 offen offset:64
    buffer_load_dwordx2 v[228:229], v24, s[20:23], 0 offen offset:96
    buffer_load_dwordx2 v[232:233], v24, s[20:23], 0 offen offset:128
    s_mov_b64 s[68:69], exec
    s_mov_b32 exec_hi, 0xfffffff
    s_add_u32 m0, s65, 0
    s_add_u32 s70, s67, 0
    buffer_load_dwordx4 v25, s[12:15], s70 offen lds
    s_add_u32 m0, s65, 3840
    s_add_u32 s70, s67, 30720
    buffer_load_dwordx4 v25, s[12:15], s70 offen lds
    s_add_u32 m0, s65, 7680
    s_add_u32 s70, s67, 61440
    buffer_load_dwordx4 v25, s[12:15], s70 offen lds
    s_add_u32 m0, s65, 11520
    s_add_u32 s70, s67, 92160
    buffer_load_dwordx4 v25, s[12:15], s70 offen lds
    s_add_u32 m0, s65, 15360
    s_add_u32 s70, s67, 122880
    buffer_load_dwordx4 v25, s[12:15], s70 offen lds
    s_add_u32 m0, s65, 19200
    s_add_u32 s70, s67, 153600
    buffer_load_dwordx4 v25, s[12:15], s70 offen lds
    s_add_u32 m0, s65, 23040
    s_add_u32 s70, s67, 184320
    buffer_load_dwordx4 v25, s[12:15], s70 offen lds
    s_mov_b64 exec, s[68:69]
    buffer_load_dwordx4 v[156:159], v18, s[8:11], 0 offen offset:320
    buffer_load_dwordx4 v[160:163], v18, s[8:11], 0 offen offset:384
    buffer_load_dwordx4 v[164:167], v18, s[8:11], 0 offen offset:448
    buffer_load_dwordx4 v[168:171], v18, s[8:11], 0 offen offset:512
    buffer_load_dwordx4 v[172:175], v18, s[8:11], 0 offen offset:576
    s_mov_b64 s[68:69], exec
    s_mov_b32 exec_hi, 0xfffffff
    s_add_u32 m0, s65, 26880
    s_add_u32 s70, s67, 204800
    buffer_load_dwordx4 v25, s[12:15], s70 offen lds
    s_add_u32 m0, s65, 30720
    s_add_u32 s70, s67, 235520
    buffer_load_dwordx4 v25, s[12:15], s70 offen lds
    s_add_u32 m0, s65, 34560
    s_add_u32 s70, s67, 266240
    buffer_load_dwordx4 v25, s[12:15], s70 offen lds
    s_add_u32 m0, s65, 38400
    s_add_u32 s70, s67, 296960
    buffer_load_dwordx4 v25, s[12:15], s70 offen lds
    s_add_u32 m0, s65, 42240
    s_add_u32 s70, s67, 327680
    buffer_load_dwordx4 v25, s[12:15], s70 offen lds
    s_add_u32 m0, s65, 46080
    s_add_u32 s70, s67, 358400
    buffer_load_dwordx4 v25, s[12:15], s70 offen lds
    s_add_u32 m0, s65, 49920
    s_add_u32 s70, s67, 389120
    buffer_load_dwordx4 v25, s[12:15], s70 offen lds
    s_mov_b64 exec, s[68:69]
    s_waitcnt vmcnt(12)
    s_barrier
    v_add_u32 v22, 0, v23
    ds_read_b64_tr_b16 v[64:65], v22 offset:0
    ds_read_b64_tr_b16 v[66:67], v22 offset:640
    ds_read_b64_tr_b16 v[68:69], v22 offset:32
    ds_read_b64_tr_b16 v[70:71], v22 offset:672
    ds_read_b64_tr_b16 v[72:73], v22 offset:64
    ds_read_b64_tr_b16 v[74:75], v22 offset:704
    ds_read_b64_tr_b16 v[76:77], v22 offset:96
    ds_read_b64_tr_b16 v[78:79], v22 offset:736
    ds_read_b64_tr_b16 v[80:81], v22 offset:128
    ds_read_b64_tr_b16 v[82:83], v22 offset:768
    v_add_u32 v22, 5120, v23
    ds_read_b64_tr_b16 v[100:101], v22 offset:0
    ds_read_b64_tr_b16 v[102:103], v22 offset:640
    ds_read_b64_tr_b16 v[104:105], v22 offset:32
    ds_read_b64_tr_b16 v[106:107], v22 offset:672
    ds_read_b64_tr_b16 v[108:109], v22 offset:64
    ds_read_b64_tr_b16 v[110:111], v22 offset:704
    ds_read_b64_tr_b16 v[112:113], v22 offset:96
    ds_read_b64_tr_b16 v[114:115], v22 offset:736
    ds_read_b64_tr_b16 v[116:117], v22 offset:128
    ds_read_b64_tr_b16 v[118:119], v22 offset:768
    s_waitcnt lgkmcnt(10)
    v_mfma_f32_16x16x32_bf16 v[28:31], v[64:67], v[136:139], v[28:31]
    v_mfma_f32_16x16x32_bf16 v[32:35], v[68:71], v[136:139], v[32:35]
    v_mfma_f32_16x16x32_bf16 v[36:39], v[72:75], v[136:139], v[36:39]
    v_mfma_f32_16x16x32_bf16 v[40:43], v[76:79], v[136:139], v[40:43]
    v_mfma_f32_16x16x32_bf16 v[44:47], v[80:83], v[136:139], v[44:47]
    v_add_u32 v22, 10240, v23
    ds_read_b64_tr_b16 v[64:65], v22 offset:0
    ds_read_b64_tr_b16 v[66:67], v22 offset:640
    ds_read_b64_tr_b16 v[68:69], v22 offset:32
    ds_read_b64_tr_b16 v[70:71], v22 offset:672
    ds_read_b64_tr_b16 v[72:73], v22 offset:64
    ds_read_b64_tr_b16 v[74:75], v22 offset:704
    ds_read_b64_tr_b16 v[76:77], v22 offset:96
    ds_read_b64_tr_b16 v[78:79], v22 offset:736
    ds_read_b64_tr_b16 v[80:81], v22 offset:128
    ds_read_b64_tr_b16 v[82:83], v22 offset:768
    s_waitcnt lgkmcnt(10)
    v_mfma_f32_16x16x32_bf16 v[28:31], v[100:103], v[140:143], v[28:31]
    v_mfma_f32_16x16x32_bf16 v[32:35], v[104:107], v[140:143], v[32:35]
    v_mfma_f32_16x16x32_bf16 v[36:39], v[108:111], v[140:143], v[36:39]
    v_mfma_f32_16x16x32_bf16 v[40:43], v[112:115], v[140:143], v[40:43]
    v_mfma_f32_16x16x32_bf16 v[44:47], v[116:119], v[140:143], v[44:47]
    v_add_u32 v22, 15360, v23
    ds_read_b64_tr_b16 v[100:101], v22 offset:0
    ds_read_b64_tr_b16 v[102:103], v22 offset:640
    ds_read_b64_tr_b16 v[104:105], v22 offset:32
    ds_read_b64_tr_b16 v[106:107], v22 offset:672
    ds_read_b64_tr_b16 v[108:109], v22 offset:64
    ds_read_b64_tr_b16 v[110:111], v22 offset:704
    ds_read_b64_tr_b16 v[112:113], v22 offset:96
    ds_read_b64_tr_b16 v[114:115], v22 offset:736
    ds_read_b64_tr_b16 v[116:117], v22 offset:128
    ds_read_b64_tr_b16 v[118:119], v22 offset:768
    s_waitcnt lgkmcnt(10)
    v_mfma_f32_16x16x32_bf16 v[28:31], v[64:67], v[144:147], v[28:31]
    v_mfma_f32_16x16x32_bf16 v[32:35], v[68:71], v[144:147], v[32:35]
    v_mfma_f32_16x16x32_bf16 v[36:39], v[72:75], v[144:147], v[36:39]
    v_mfma_f32_16x16x32_bf16 v[40:43], v[76:79], v[144:147], v[40:43]
    v_mfma_f32_16x16x32_bf16 v[44:47], v[80:83], v[144:147], v[44:47]
    v_add_u32 v22, 20480, v23
    ds_read_b64_tr_b16 v[64:65], v22 offset:0
    ds_read_b64_tr_b16 v[66:67], v22 offset:640
    ds_read_b64_tr_b16 v[68:69], v22 offset:32
    ds_read_b64_tr_b16 v[70:71], v22 offset:672
    ds_read_b64_tr_b16 v[72:73], v22 offset:64
    ds_read_b64_tr_b16 v[74:75], v22 offset:704
    ds_read_b64_tr_b16 v[76:77], v22 offset:96
    ds_read_b64_tr_b16 v[78:79], v22 offset:736
    ds_read_b64_tr_b16 v[80:81], v22 offset:128
    ds_read_b64_tr_b16 v[82:83], v22 offset:768
    s_waitcnt lgkmcnt(10)
    v_mfma_f32_16x16x32_bf16 v[28:31], v[100:103], v[148:151], v[28:31]
    v_mfma_f32_16x16x32_bf16 v[32:35], v[104:107], v[148:151], v[32:35]
    v_mfma_f32_16x16x32_bf16 v[36:39], v[108:111], v[148:151], v[36:39]
    v_mfma_f32_16x16x32_bf16 v[40:43], v[112:115], v[148:151], v[40:43]
    v_mfma_f32_16x16x32_bf16 v[44:47], v[116:119], v[148:151], v[44:47]
    s_waitcnt lgkmcnt(0)
    v_mfma_f32_16x16x32_bf16 v[28:31], v[64:67], v[152:155], v[28:31]
    v_mfma_f32_16x16x32_bf16 v[32:35], v[68:71], v[152:155], v[32:35]
    v_mfma_f32_16x16x32_bf16 v[36:39], v[72:75], v[152:155], v[36:39]
    v_mfma_f32_16x16x32_bf16 v[40:43], v[76:79], v[152:155], v[40:43]
    v_mfma_f32_16x16x32_bf16 v[44:47], v[80:83], v[152:155], v[44:47]
    s_barrier
    buffer_load_dwordx4 v[136:139], v18, s[8:11], 0 offen offset:640
    buffer_load_dwordx4 v[140:143], v18, s[8:11], 0 offen offset:704
    buffer_load_dwordx4 v[144:147], v18, s[8:11], 0 offen offset:768
    buffer_load_dwordx4 v[148:151], v18, s[8:11], 0 offen offset:832
    buffer_load_dwordx4 v[152:155], v18, s[8:11], 0 offen offset:896
    s_mov_b64 s[68:69], exec
    s_mov_b32 exec_hi, 0xfffffff
    s_add_u32 m0, s65, 0
    s_add_u32 s70, s67, 409600
    buffer_load_dwordx4 v25, s[12:15], s70 offen lds
    s_add_u32 m0, s65, 3840
    s_add_u32 s70, s67, 440320
    buffer_load_dwordx4 v25, s[12:15], s70 offen lds
    s_add_u32 m0, s65, 7680
    s_add_u32 s70, s67, 471040
    buffer_load_dwordx4 v25, s[12:15], s70 offen lds
    s_add_u32 m0, s65, 11520
    s_add_u32 s70, s67, 501760
    buffer_load_dwordx4 v25, s[12:15], s70 offen lds
    s_add_u32 m0, s65, 15360
    s_add_u32 s70, s67, 532480
    buffer_load_dwordx4 v25, s[12:15], s70 offen lds
    s_add_u32 m0, s65, 19200
    s_add_u32 s70, s67, 563200
    buffer_load_dwordx4 v25, s[12:15], s70 offen lds
    s_add_u32 m0, s65, 23040
    s_add_u32 s70, s67, 593920
    buffer_load_dwordx4 v25, s[12:15], s70 offen lds
    s_mov_b64 exec, s[68:69]
    s_waitcnt vmcnt(12)
    s_barrier
    v_add_u32 v22, 26880, v23
    ds_read_b64_tr_b16 v[64:65], v22 offset:0
    ds_read_b64_tr_b16 v[66:67], v22 offset:640
    ds_read_b64_tr_b16 v[68:69], v22 offset:32
    ds_read_b64_tr_b16 v[70:71], v22 offset:672
    ds_read_b64_tr_b16 v[72:73], v22 offset:64
    ds_read_b64_tr_b16 v[74:75], v22 offset:704
    ds_read_b64_tr_b16 v[76:77], v22 offset:96
    ds_read_b64_tr_b16 v[78:79], v22 offset:736
    ds_read_b64_tr_b16 v[80:81], v22 offset:128
    ds_read_b64_tr_b16 v[82:83], v22 offset:768
    v_add_u32 v22, 32000, v23
    ds_read_b64_tr_b16 v[100:101], v22 offset:0
    ds_read_b64_tr_b16 v[102:103], v22 offset:640
    ds_read_b64_tr_b16 v[104:105], v22 offset:32
    ds_read_b64_tr_b16 v[106:107], v22 offset:672
    ds_read_b64_tr_b16 v[108:109], v22 offset:64
    ds_read_b64_tr_b16 v[110:111], v22 offset:704
    ds_read_b64_tr_b16 v[112:113], v22 offset:96
    ds_read_b64_tr_b16 v[114:115], v22 offset:736
    ds_read_b64_tr_b16 v[116:117], v22 offset:128
    ds_read_b64_tr_b16 v[118:119], v22 offset:768
    s_waitcnt lgkmcnt(10)
    v_mfma_f32_16x16x32_bf16 v[28:31], v[64:67], v[156:159], v[28:31]
    v_mfma_f32_16x16x32_bf16 v[32:35], v[68:71], v[156:159], v[32:35]
    v_mfma_f32_16x16x32_bf16 v[36:39], v[72:75], v[156:159], v[36:39]
    v_mfma_f32_16x16x32_bf16 v[40:43], v[76:79], v[156:159], v[40:43]
    v_mfma_f32_16x16x32_bf16 v[44:47], v[80:83], v[156:159], v[44:47]
    v_add_u32 v22, 37120, v23
    ds_read_b64_tr_b16 v[64:65], v22 offset:0
    ds_read_b64_tr_b16 v[66:67], v22 offset:640
    ds_read_b64_tr_b16 v[68:69], v22 offset:32
    ds_read_b64_tr_b16 v[70:71], v22 offset:672
    ds_read_b64_tr_b16 v[72:73], v22 offset:64
    ds_read_b64_tr_b16 v[74:75], v22 offset:704
    ds_read_b64_tr_b16 v[76:77], v22 offset:96
    ds_read_b64_tr_b16 v[78:79], v22 offset:736
    ds_read_b64_tr_b16 v[80:81], v22 offset:128
    ds_read_b64_tr_b16 v[82:83], v22 offset:768
    s_waitcnt lgkmcnt(10)
    v_mfma_f32_16x16x32_bf16 v[28:31], v[100:103], v[160:163], v[28:31]
    v_mfma_f32_16x16x32_bf16 v[32:35], v[104:107], v[160:163], v[32:35]
    v_mfma_f32_16x16x32_bf16 v[36:39], v[108:111], v[160:163], v[36:39]
    v_mfma_f32_16x16x32_bf16 v[40:43], v[112:115], v[160:163], v[40:43]
    v_mfma_f32_16x16x32_bf16 v[44:47], v[116:119], v[160:163], v[44:47]
    v_add_u32 v22, 42240, v23
    ds_read_b64_tr_b16 v[100:101], v22 offset:0
    ds_read_b64_tr_b16 v[102:103], v22 offset:640
    ds_read_b64_tr_b16 v[104:105], v22 offset:32
    ds_read_b64_tr_b16 v[106:107], v22 offset:672
    ds_read_b64_tr_b16 v[108:109], v22 offset:64
    ds_read_b64_tr_b16 v[110:111], v22 offset:704
    ds_read_b64_tr_b16 v[112:113], v22 offset:96
    ds_read_b64_tr_b16 v[114:115], v22 offset:736
    ds_read_b64_tr_b16 v[116:117], v22 offset:128
    ds_read_b64_tr_b16 v[118:119], v22 offset:768
    s_waitcnt lgkmcnt(10)
    v_mfma_f32_16x16x32_bf16 v[28:31], v[64:67], v[164:167], v[28:31]
    v_mfma_f32_16x16x32_bf16 v[32:35], v[68:71], v[164:167], v[32:35]
    v_mfma_f32_16x16x32_bf16 v[36:39], v[72:75], v[164:167], v[36:39]
    v_mfma_f32_16x16x32_bf16 v[40:43], v[76:79], v[164:167], v[40:43]
    v_mfma_f32_16x16x32_bf16 v[44:47], v[80:83], v[164:167], v[44:47]
    v_add_u32 v22, 47360, v23
    ds_read_b64_tr_b16 v[64:65], v22 offset:0
    ds_read_b64_tr_b16 v[66:67], v22 offset:640
    ds_read_b64_tr_b16 v[68:69], v22 offset:32
    ds_read_b64_tr_b16 v[70:71], v22 offset:672
    ds_read_b64_tr_b16 v[72:73], v22 offset:64
    ds_read_b64_tr_b16 v[74:75], v22 offset:704
    ds_read_b64_tr_b16 v[76:77], v22 offset:96
    ds_read_b64_tr_b16 v[78:79], v22 offset:736
    ds_read_b64_tr_b16 v[80:81], v22 offset:128
    ds_read_b64_tr_b16 v[82:83], v22 offset:768
    s_waitcnt lgkmcnt(10)
    v_mfma_f32_16x16x32_bf16 v[28:31], v[100:103], v[168:171], v[28:31]
    v_mfma_f32_16x16x32_bf16 v[32:35], v[104:107], v[168:171], v[32:35]
    v_mfma_f32_16x16x32_bf16 v[36:39], v[108:111], v[168:171], v[36:39]
    v_mfma_f32_16x16x32_bf16 v[40:43], v[112:115], v[168:171], v[40:43]
    v_mfma_f32_16x16x32_bf16 v[44:47], v[116:119], v[168:171], v[44:47]
    s_waitcnt lgkmcnt(0)
    v_mfma_f32_16x16x32_bf16 v[28:31], v[64:67], v[172:175], v[28:31]
    v_mfma_f32_16x16x32_bf16 v[32:35], v[68:71], v[172:175], v[32:35]
    v_mfma_f32_16x16x32_bf16 v[36:39], v[72:75], v[172:175], v[36:39]
    v_mfma_f32_16x16x32_bf16 v[40:43], v[76:79], v[172:175], v[40:43]
    v_mfma_f32_16x16x32_bf16 v[44:47], v[80:83], v[172:175], v[44:47]
    s_barrier
    buffer_load_dwordx4 v[156:159], v18, s[8:11], 0 offen offset:960
    buffer_load_dwordx4 v[160:163], v18, s[8:11], 0 offen offset:1024
    buffer_load_dwordx4 v[164:167], v18, s[8:11], 0 offen offset:1088
    buffer_load_dwordx4 v[168:171], v18, s[8:11], 0 offen offset:1152
    buffer_load_dwordx4 v[172:175], v18, s[8:11], 0 offen offset:1216
    s_mov_b64 s[68:69], exec
    s_mov_b32 exec_hi, 0xfffffff
    s_add_u32 m0, s65, 26880
    s_add_u32 s70, s67, 614400
    buffer_load_dwordx4 v25, s[12:15], s70 offen lds
    s_add_u32 m0, s65, 30720
    s_add_u32 s70, s67, 645120
    buffer_load_dwordx4 v25, s[12:15], s70 offen lds
    s_add_u32 m0, s65, 34560
    s_add_u32 s70, s67, 675840
    buffer_load_dwordx4 v25, s[12:15], s70 offen lds
    s_add_u32 m0, s65, 38400
    s_add_u32 s70, s67, 706560
    buffer_load_dwordx4 v25, s[12:15], s70 offen lds
    s_add_u32 m0, s65, 42240
    s_add_u32 s70, s67, 737280
    buffer_load_dwordx4 v25, s[12:15], s70 offen lds
    s_add_u32 m0, s65, 46080
    s_add_u32 s70, s67, 768000
    buffer_load_dwordx4 v25, s[12:15], s70 offen lds
    s_add_u32 m0, s65, 49920
    s_add_u32 s70, s67, 798720
    buffer_load_dwordx4 v25, s[12:15], s70 offen lds
    s_mov_b64 exec, s[68:69]
    s_waitcnt vmcnt(12)
    s_barrier
    v_add_u32 v22, 0, v23
    ds_read_b64_tr_b16 v[64:65], v22 offset:0
    ds_read_b64_tr_b16 v[66:67], v22 offset:640
    ds_read_b64_tr_b16 v[68:69], v22 offset:32
    ds_read_b64_tr_b16 v[70:71], v22 offset:672
    ds_read_b64_tr_b16 v[72:73], v22 offset:64
    ds_read_b64_tr_b16 v[74:75], v22 offset:704
    ds_read_b64_tr_b16 v[76:77], v22 offset:96
    ds_read_b64_tr_b16 v[78:79], v22 offset:736
    ds_read_b64_tr_b16 v[80:81], v22 offset:128
    ds_read_b64_tr_b16 v[82:83], v22 offset:768
    v_add_u32 v22, 5120, v23
    ds_read_b64_tr_b16 v[100:101], v22 offset:0
    ds_read_b64_tr_b16 v[102:103], v22 offset:640
    ds_read_b64_tr_b16 v[104:105], v22 offset:32
    ds_read_b64_tr_b16 v[106:107], v22 offset:672
    ds_read_b64_tr_b16 v[108:109], v22 offset:64
    ds_read_b64_tr_b16 v[110:111], v22 offset:704
    ds_read_b64_tr_b16 v[112:113], v22 offset:96
    ds_read_b64_tr_b16 v[114:115], v22 offset:736
    ds_read_b64_tr_b16 v[116:117], v22 offset:128
    ds_read_b64_tr_b16 v[118:119], v22 offset:768
    s_waitcnt lgkmcnt(10)
    v_mfma_f32_16x16x32_bf16 v[28:31], v[64:67], v[136:139], v[28:31]
    v_mfma_f32_16x16x32_bf16 v[32:35], v[68:71], v[136:139], v[32:35]
    v_mfma_f32_16x16x32_bf16 v[36:39], v[72:75], v[136:139], v[36:39]
    v_mfma_f32_16x16x32_bf16 v[40:43], v[76:79], v[136:139], v[40:43]
    v_mfma_f32_16x16x32_bf16 v[44:47], v[80:83], v[136:139], v[44:47]
    v_add_u32 v22, 10240, v23
    ds_read_b64_tr_b16 v[64:65], v22 offset:0
    ds_read_b64_tr_b16 v[66:67], v22 offset:640
    ds_read_b64_tr_b16 v[68:69], v22 offset:32
    ds_read_b64_tr_b16 v[70:71], v22 offset:672
    ds_read_b64_tr_b16 v[72:73], v22 offset:64
    ds_read_b64_tr_b16 v[74:75], v22 offset:704
    ds_read_b64_tr_b16 v[76:77], v22 offset:96
    ds_read_b64_tr_b16 v[78:79], v22 offset:736
    ds_read_b64_tr_b16 v[80:81], v22 offset:128
    ds_read_b64_tr_b16 v[82:83], v22 offset:768
    s_waitcnt lgkmcnt(10)
    v_mfma_f32_16x16x32_bf16 v[28:31], v[100:103], v[140:143], v[28:31]
    v_mfma_f32_16x16x32_bf16 v[32:35], v[104:107], v[140:143], v[32:35]
    v_mfma_f32_16x16x32_bf16 v[36:39], v[108:111], v[140:143], v[36:39]
    v_mfma_f32_16x16x32_bf16 v[40:43], v[112:115], v[140:143], v[40:43]
    v_mfma_f32_16x16x32_bf16 v[44:47], v[116:119], v[140:143], v[44:47]
    v_add_u32 v22, 15360, v23
    ds_read_b64_tr_b16 v[100:101], v22 offset:0
    ds_read_b64_tr_b16 v[102:103], v22 offset:640
    ds_read_b64_tr_b16 v[104:105], v22 offset:32
    ds_read_b64_tr_b16 v[106:107], v22 offset:672
    ds_read_b64_tr_b16 v[108:109], v22 offset:64
    ds_read_b64_tr_b16 v[110:111], v22 offset:704
    ds_read_b64_tr_b16 v[112:113], v22 offset:96
    ds_read_b64_tr_b16 v[114:115], v22 offset:736
    ds_read_b64_tr_b16 v[116:117], v22 offset:128
    ds_read_b64_tr_b16 v[118:119], v22 offset:768
    s_waitcnt lgkmcnt(10)
    v_mfma_f32_16x16x32_bf16 v[28:31], v[64:67], v[144:147], v[28:31]
    v_mfma_f32_16x16x32_bf16 v[32:35], v[68:71], v[144:147], v[32:35]
    v_mfma_f32_16x16x32_bf16 v[36:39], v[72:75], v[144:147], v[36:39]
    v_mfma_f32_16x16x32_bf16 v[40:43], v[76:79], v[144:147], v[40:43]
    v_mfma_f32_16x16x32_bf16 v[44:47], v[80:83], v[144:147], v[44:47]
    v_add_u32 v22, 20480, v23
    ds_read_b64_tr_b16 v[64:65], v22 offset:0
    ds_read_b64_tr_b16 v[66:67], v22 offset:640
    ds_read_b64_tr_b16 v[68:69], v22 offset:32
    ds_read_b64_tr_b16 v[70:71], v22 offset:672
    ds_read_b64_tr_b16 v[72:73], v22 offset:64
    ds_read_b64_tr_b16 v[74:75], v22 offset:704
    ds_read_b64_tr_b16 v[76:77], v22 offset:96
    ds_read_b64_tr_b16 v[78:79], v22 offset:736
    ds_read_b64_tr_b16 v[80:81], v22 offset:128
    ds_read_b64_tr_b16 v[82:83], v22 offset:768
    s_waitcnt lgkmcnt(10)
    v_mfma_f32_16x16x32_bf16 v[28:31], v[100:103], v[148:151], v[28:31]
    v_mfma_f32_16x16x32_bf16 v[32:35], v[104:107], v[148:151], v[32:35]
    v_mfma_f32_16x16x32_bf16 v[36:39], v[108:111], v[148:151], v[36:39]
    v_mfma_f32_16x16x32_bf16 v[40:43], v[112:115], v[148:151], v[40:43]
    v_mfma_f32_16x16x32_bf16 v[44:47], v[116:119], v[148:151], v[44:47]
    s_waitcnt lgkmcnt(0)
    v_mfma_f32_16x16x32_bf16 v[28:31], v[64:67], v[152:155], v[28:31]
    v_mfma_f32_16x16x32_bf16 v[32:35], v[68:71], v[152:155], v[32:35]
    v_mfma_f32_16x16x32_bf16 v[36:39], v[72:75], v[152:155], v[36:39]
    v_mfma_f32_16x16x32_bf16 v[40:43], v[76:79], v[152:155], v[40:43]
    v_mfma_f32_16x16x32_bf16 v[44:47], v[80:83], v[152:155], v[44:47]
    s_waitcnt vmcnt(0)
    s_barrier
    v_add_u32 v22, 26880, v23
    ds_read_b64_tr_b16 v[64:65], v22 offset:0
    ds_read_b64_tr_b16 v[66:67], v22 offset:640
    ds_read_b64_tr_b16 v[68:69], v22 offset:32
    ds_read_b64_tr_b16 v[70:71], v22 offset:672
    ds_read_b64_tr_b16 v[72:73], v22 offset:64
    ds_read_b64_tr_b16 v[74:75], v22 offset:704
    ds_read_b64_tr_b16 v[76:77], v22 offset:96
    ds_read_b64_tr_b16 v[78:79], v22 offset:736
    ds_read_b64_tr_b16 v[80:81], v22 offset:128
    ds_read_b64_tr_b16 v[82:83], v22 offset:768
    v_add_u32 v22, 32000, v23
    ds_read_b64_tr_b16 v[100:101], v22 offset:0
    ds_read_b64_tr_b16 v[102:103], v22 offset:640
    ds_read_b64_tr_b16 v[104:105], v22 offset:32
    ds_read_b64_tr_b16 v[106:107], v22 offset:672
    ds_read_b64_tr_b16 v[108:109], v22 offset:64
    ds_read_b64_tr_b16 v[110:111], v22 offset:704
    ds_read_b64_tr_b16 v[112:113], v22 offset:96
    ds_read_b64_tr_b16 v[114:115], v22 offset:736
    ds_read_b64_tr_b16 v[116:117], v22 offset:128
    ds_read_b64_tr_b16 v[118:119], v22 offset:768
    s_waitcnt lgkmcnt(10)
    v_mfma_f32_16x16x32_bf16 v[28:31], v[64:67], v[156:159], v[28:31]
    v_mfma_f32_16x16x32_bf16 v[32:35], v[68:71], v[156:159], v[32:35]
    v_mfma_f32_16x16x32_bf16 v[36:39], v[72:75], v[156:159], v[36:39]
    v_mfma_f32_16x16x32_bf16 v[40:43], v[76:79], v[156:159], v[40:43]
    v_mfma_f32_16x16x32_bf16 v[44:47], v[80:83], v[156:159], v[44:47]
    v_add_u32 v22, 37120, v23
    ds_read_b64_tr_b16 v[64:65], v22 offset:0
    ds_read_b64_tr_b16 v[66:67], v22 offset:640
    ds_read_b64_tr_b16 v[68:69], v22 offset:32
    ds_read_b64_tr_b16 v[70:71], v22 offset:672
    ds_read_b64_tr_b16 v[72:73], v22 offset:64
    ds_read_b64_tr_b16 v[74:75], v22 offset:704
    ds_read_b64_tr_b16 v[76:77], v22 offset:96
    ds_read_b64_tr_b16 v[78:79], v22 offset:736
    ds_read_b64_tr_b16 v[80:81], v22 offset:128
    ds_read_b64_tr_b16 v[82:83], v22 offset:768
    s_waitcnt lgkmcnt(10)
    v_mfma_f32_16x16x32_bf16 v[28:31], v[100:103], v[160:163], v[28:31]
    v_mfma_f32_16x16x32_bf16 v[32:35], v[104:107], v[160:163], v[32:35]
    v_mfma_f32_16x16x32_bf16 v[36:39], v[108:111], v[160:163], v[36:39]
    v_mfma_f32_16x16x32_bf16 v[40:43], v[112:115], v[160:163], v[40:43]
    v_mfma_f32_16x16x32_bf16 v[44:47], v[116:119], v[160:163], v[44:47]
    v_add_u32 v22, 42240, v23
    ds_read_b64_tr_b16 v[100:101], v22 offset:0
    ds_read_b64_tr_b16 v[102:103], v22 offset:640
    ds_read_b64_tr_b16 v[104:105], v22 offset:32
    ds_read_b64_tr_b16 v[106:107], v22 offset:672
    ds_read_b64_tr_b16 v[108:109], v22 offset:64
    ds_read_b64_tr_b16 v[110:111], v22 offset:704
    ds_read_b64_tr_b16 v[112:113], v22 offset:96
    ds_read_b64_tr_b16 v[114:115], v22 offset:736
    ds_read_b64_tr_b16 v[116:117], v22 offset:128
    ds_read_b64_tr_b16 v[118:119], v22 offset:768
    s_waitcnt lgkmcnt(10)
    v_mfma_f32_16x16x32_bf16 v[28:31], v[64:67], v[164:167], v[28:31]
    v_mfma_f32_16x16x32_bf16 v[32:35], v[68:71], v[164:167], v[32:35]
    v_mfma_f32_16x16x32_bf16 v[36:39], v[72:75], v[164:167], v[36:39]
    v_mfma_f32_16x16x32_bf16 v[40:43], v[76:79], v[164:167], v[40:43]
    v_mfma_f32_16x16x32_bf16 v[44:47], v[80:83], v[164:167], v[44:47]
    v_add_u32 v22, 47360, v23
    ds_read_b64_tr_b16 v[64:65], v22 offset:0
    ds_read_b64_tr_b16 v[66:67], v22 offset:640
    ds_read_b64_tr_b16 v[68:69], v22 offset:32
    ds_read_b64_tr_b16 v[70:71], v22 offset:672
    ds_read_b64_tr_b16 v[72:73], v22 offset:64
    ds_read_b64_tr_b16 v[74:75], v22 offset:704
    ds_read_b64_tr_b16 v[76:77], v22 offset:96
    ds_read_b64_tr_b16 v[78:79], v22 offset:736
    ds_read_b64_tr_b16 v[80:81], v22 offset:128
    ds_read_b64_tr_b16 v[82:83], v22 offset:768
    s_waitcnt lgkmcnt(10)
    v_mfma_f32_16x16x32_bf16 v[28:31], v[100:103], v[168:171], v[28:31]
    v_mfma_f32_16x16x32_bf16 v[32:35], v[104:107], v[168:171], v[32:35]
    v_mfma_f32_16x16x32_bf16 v[36:39], v[108:111], v[168:171], v[36:39]
    v_mfma_f32_16x16x32_bf16 v[40:43], v[112:115], v[168:171], v[40:43]
    v_mfma_f32_16x16x32_bf16 v[44:47], v[116:119], v[168:171], v[44:47]
    s_waitcnt lgkmcnt(0)
    v_mfma_f32_16x16x32_bf16 v[28:31], v[64:67], v[172:175], v[28:31]
    v_mfma_f32_16x16x32_bf16 v[32:35], v[68:71], v[172:175], v[32:35]
    v_mfma_f32_16x16x32_bf16 v[36:39], v[72:75], v[172:175], v[36:39]
    v_mfma_f32_16x16x32_bf16 v[40:43], v[76:79], v[172:175], v[40:43]
    v_mfma_f32_16x16x32_bf16 v[44:47], v[80:83], v[172:175], v[44:47]
    s_nop 15
    v_lshlrev_b32 v3, 16, v216
    v_add_f32 v28, v28, v3
    v_and_b32 v3, 0xffff0000, v216
    v_add_f32 v29, v29, v3
    v_lshlrev_b32 v3, 16, v217
    v_add_f32 v30, v30, v3
    v_and_b32 v3, 0xffff0000, v217
    v_add_f32 v31, v31, v3
    v_cvt_pk_bf16_f32 v26, v28, v29
    v_cvt_pk_bf16_f32 v27, v30, v31
    buffer_store_dwordx2 v[26:27], v24, s[16:19], 0 offen offset:0
    s_nop 0
    v_lshlrev_b32 v3, 16, v220
    v_add_f32 v32, v32, v3
    v_and_b32 v3, 0xffff0000, v220
    v_add_f32 v33, v33, v3
    v_lshlrev_b32 v3, 16, v221
    v_add_f32 v34, v34, v3
    v_and_b32 v3, 0xffff0000, v221
    v_add_f32 v35, v35, v3
    v_cvt_pk_bf16_f32 v26, v32, v33
    v_cvt_pk_bf16_f32 v27, v34, v35
    buffer_store_dwordx2 v[26:27], v24, s[16:19], 0 offen offset:32
    s_nop 0
    v_lshlrev_b32 v3, 16, v224
    v_add_f32 v36, v36, v3
    v_and_b32 v3, 0xffff0000, v224
    v_add_f32 v37, v37, v3
    v_lshlrev_b32 v3, 16, v225
    v_add_f32 v38, v38, v3
    v_and_b32 v3, 0xffff0000, v225
    v_add_f32 v39, v39, v3
    v_cvt_pk_bf16_f32 v26, v36, v37
    v_cvt_pk_bf16_f32 v27, v38, v39
    buffer_store_dwordx2 v[26:27], v24, s[16:19], 0 offen offset:64
    s_nop 0
    v_lshlrev_b32 v3, 16, v228
    v_add_f32 v40, v40, v3
    v_and_b32 v3, 0xffff0000, v228
    v_add_f32 v41, v41, v3
    v_lshlrev_b32 v3, 16, v229
    v_add_f32 v42, v42, v3
    v_and_b32 v3, 0xffff0000, v229
    v_add_f32 v43, v43, v3
    v_cvt_pk_bf16_f32 v26, v40, v41
    v_cvt_pk_bf16_f32 v27, v42, v43
    buffer_store_dwordx2 v[26:27], v24, s[16:19], 0 offen offset:96
    s_nop 0
    v_lshlrev_b32 v3, 16, v232
    v_add_f32 v44, v44, v3
    v_and_b32 v3, 0xffff0000, v232
    v_add_f32 v45, v45, v3
    v_lshlrev_b32 v3, 16, v233
    v_add_f32 v46, v46, v3
    v_and_b32 v3, 0xffff0000, v233
    v_add_f32 v47, v47, v3
    v_cvt_pk_bf16_f32 v26, v44, v45
    v_cvt_pk_bf16_f32 v27, v46, v47
    buffer_store_dwordx2 v[26:27], v24, s[16:19], 0 offen offset:128
    s_nop 0
    s_waitcnt vmcnt(0)
    s_endpgm
L_END_k3_wo_kernel:
    s_endpgm
.globl k4_w1_kernel
.p2align 8
.type k4_w1_kernel,@function
k4_w1_kernel:
    s_cmp_ge_u32 s2, 256
    s_cbranch_scc1 L_END_k4_w1_kernel
    s_load_dwordx16 s[36:51], s[0:1], 0
    s_load_dwordx8 s[52:59], s[0:1], 64
    s_load_dwordx2 s[60:61], s[0:1], 96
    s_and_b32 s3, s2, 31
    s_lshr_b32 s4, s2, 5
    s_waitcnt lgkmcnt(0)
    s_add_u32 s8, s60, 0x580000
    s_addc_u32 s9, s61, 0
    s_mov_b32 s10, 0x280000
    s_mov_b32 s11, 0x00020000
    s_mov_b32 s12, s48
    s_mov_b32 s13, s49
    s_mov_b32 s14, 0xc8000
    s_mov_b32 s15, 0x00020000
    s_add_u32 s16, s60, 0xa80000
    s_addc_u32 s17, s61, 0
    s_mov_b32 s18, 0x280000
    s_mov_b32 s19, 0x00020000
    s_add_u32 s28, s60, 0x800000
    s_addc_u32 s29, s61, 0
    s_mov_b32 s30, 0x280000
    s_mov_b32 s31, 0x00020000
    v_and_b32 v1, 15, v0
    v_bfe_u32 v2, v0, 4, 2
    v_lshrrev_b32 v3, 6, v0
    v_lshlrev_b32 v3, 4, v3
    v_add_u32 v3, v3, v1
    s_mul_i32 s5, s3, 64
    v_add_u32 v3, s5, v3
    v_mov_b32 v10, v3
    v_and_b32 v4, 63, v0
    v_xor_b32 v17, 32, v4
    v_lshlrev_b32 v17, 2, v17
    s_mov_b32 s6, 1280
    v_lshlrev_b32 v5, 4, v2
    v_mov_b32 v4, v3
    v_mul_lo_u32 v4, v4, s6
    v_add_u32 v18, v4, v5
    v_mov_b32 v28, 0
    v_mov_b32 v29, 0
    v_mov_b32 v30, 0
    v_mov_b32 v31, 0
    v_mov_b32 v32, 0
    v_mov_b32 v33, 0
    v_mov_b32 v34, 0
    v_mov_b32 v35, 0
    v_mov_b32 v36, 0
    v_mov_b32 v37, 0
    v_mov_b32 v38, 0
    v_mov_b32 v39, 0
    v_mov_b32 v40, 0
    v_mov_b32 v41, 0
    v_mov_b32 v42, 0
    v_mov_b32 v43, 0
    v_mov_b32 v44, 0
    v_mov_b32 v45, 0
    v_mov_b32 v46, 0
    v_mov_b32 v47, 0
    v_lshrrev_b32 v4, 2, v1
    v_lshl_add_u32 v4, v2, 3, v4
    s_mov_b32 s7, 160
    v_mul_lo_u32 v4, v4, s7
    v_and_b32 v5, 3, v1
    v_lshl_add_u32 v23, v5, 3, v4
    s_mul_i32 s4, s4, 160
    v_and_b32 v4, 63, v0
    v_mul_u32_u24 v5, 6554, v4
    v_lshrrev_b32 v5, 16, v5
    v_mul_u32_u24 v6, 10, v5
    v_sub_u32 v6, v4, v6
    s_mov_b32 s66, 1280
    v_mul_lo_u32 v5, v5, s66
    v_lshl_add_u32 v25, v6, 4, v5
    v_lshrrev_b32 v4, 6, v0
    s_nop 1
    v_readfirstlane_b32 s64, v4
    s_nop 3
    s_mul_i32 s65, s64, 960
    s_mul_i32 s67, s64, 7680
    s_add_u32 s67, s67, s4
    buffer_load_dwordx4 v[136:139], v18, s[8:11], 0 offen offset:0
    buffer_load_dwordx4 v[140:143], v18, s[8:11], 0 offen offset:64
    buffer_load_dwordx4 v[144:147], v18, s[8:11], 0 offen offset:128
    buffer_load_dwordx4 v[148:151], v18, s[8:11], 0 offen offset:192
    buffer_load_dwordx4 v[152:155], v18, s[8:11], 0 offen offset:256
    buffer_load_dwordx4 v[156:159], v18, s[8:11], 0 offen offset:320
    buffer_load_dwordx4 v[160:163], v18, s[8:11], 0 offen offset:384
    buffer_load_dwordx4 v[164:167], v18, s[8:11], 0 offen offset:448
    buffer_load_dwordx4 v[168:171], v18, s[8:11], 0 offen offset:512
    buffer_load_dwordx4 v[172:175], v18, s[8:11], 0 offen offset:576
    buffer_load_dwordx4 v[176:179], v18, s[8:11], 0 offen offset:640
    buffer_load_dwordx4 v[180:183], v18, s[8:11], 0 offen offset:704
    buffer_load_dwordx4 v[184:187], v18, s[8:11], 0 offen offset:768
    buffer_load_dwordx4 v[188:191], v18, s[8:11], 0 offen offset:832
    buffer_load_dwordx4 v[192:195], v18, s[8:11], 0 offen offset:896
    buffer_load_dwordx4 v[196:199], v18, s[8:11], 0 offen offset:960
    buffer_load_dwordx4 v[200:203], v18, s[8:11], 0 offen offset:1024
    buffer_load_dwordx4 v[204:207], v18, s[8:11], 0 offen offset:1088
    buffer_load_dwordx4 v[208:211], v18, s[8:11], 0 offen offset:1152
    buffer_load_dwordx4 v[212:215], v18, s[8:11], 0 offen offset:1216
    s_mov_b32 s6, 1280
    v_mul_lo_u32 v24, v10, s6
    v_lshl_add_u32 v24, v2, 3, v24
    v_add_u32 v24, s4, v24
    s_mov_b64 s[68:69], exec
    s_mov_b32 exec_hi, 0xfffffff
    s_add_u32 m0, s65, 0
    s_add_u32 s70, s67, 0
    buffer_load_dwordx4 v25, s[12:15], s70 offen lds
    s_add_u32 m0, s65, 3840
    s_add_u32 s70, s67, 30720
    buffer_load_dwordx4 v25, s[12:15], s70 offen lds
    s_add_u32 m0, s65, 7680
    s_add_u32 s70, s67, 61440
    buffer_load_dwordx4 v25, s[12:15], s70 offen lds
    s_add_u32 m0, s65, 11520
    s_add_u32 s70, s67, 92160
    buffer_load_dwordx4 v25, s[12:15], s70 offen lds
    s_add_u32 m0, s65, 15360
    s_add_u32 s70, s67, 122880
    buffer_load_dwordx4 v25, s[12:15], s70 offen lds
    s_add_u32 m0, s65, 19200
    s_add_u32 s70, s67, 153600
    buffer_load_dwordx4 v25, s[12:15], s70 offen lds
    s_add_u32 m0, s65, 23040
    s_add_u32 s70, s67, 184320
    buffer_load_dwordx4 v25, s[12:15], s70 offen lds
    s_mov_b64 exec, s[68:69]
    s_waitcnt vmcnt(7)
    v_mov_b32 v11, 0
    v_mov_b32 v12, 0
    v_mov_b32 v15, 0x3f803f80
    s_nop 0
    v_dot2c_f32_bf16 v11, v136, v15
    v_dot2c_f32_bf16 v12, v136, v136
    v_dot2c_f32_bf16 v11, v137, v15
    v_dot2c_f32_bf16 v12, v137, v137
    v_dot2c_f32_bf16 v11, v138, v15
    v_dot2c_f32_bf16 v12, v138, v138
    v_dot2c_f32_bf16 v11, v139, v15
    v_dot2c_f32_bf16 v12, v139, v139
    v_dot2c_f32_bf16 v11, v140, v15
    v_dot2c_f32_bf16 v12, v140, v140
    v_dot2c_f32_bf16 v11, v141, v15
    v_dot2c_f32_bf16 v12, v141, v141
    v_dot2c_f32_bf16 v11, v142, v15
    v_dot2c_f32_bf16 v12, v142, v142
    v_dot2c_f32_bf16 v11, v143, v15
    v_dot2c_f32_bf16 v12, v143, v143
    v_dot2c_f32_bf16 v11, v144, v15
    v_dot2c_f32_bf16 v12, v144, v144
    v_dot2c_f32_bf16 v11, v145, v15
    v_dot2c_f32_bf16 v12, v145, v145
    v_dot2c_f32_bf16 v11, v146, v15
    v_dot2c_f32_bf16 v12, v146, v146
    v_dot2c_f32_bf16 v11, v147, v15
    v_dot2c_f32_bf16 v12, v147, v147
    v_dot2c_f32_bf16 v11, v148, v15
    v_dot2c_f32_bf16 v12, v148, v148
    v_dot2c_f32_bf16 v11, v149, v15
    v_dot2c_f32_bf16 v12, v149, v149
    v_dot2c_f32_bf16 v11, v150, v15
    v_dot2c_f32_bf16 v12, v150, v150
    v_dot2c_f32_bf16 v11, v151, v15
    v_dot2c_f32_bf16 v12, v151, v151
    v_dot2c_f32_bf16 v11, v152, v15
    v_dot2c_f32_bf16 v12, v152, v152
    v_dot2c_f32_bf16 v11, v153, v15
    v_dot2c_f32_bf16 v12, v153, v153
    v_dot2c_f32_bf16 v11, v154, v15
    v_dot2c_f32_bf16 v12, v154, v154
    v_dot2c_f32_bf16 v11, v155, v15
    v_dot2c_f32_bf16 v12, v155, v155
    v_dot2c_f32_bf16 v11, v156, v15
    v_dot2c_f32_bf16 v12, v156, v156
    v_dot2c_f32_bf16 v11, v157, v15
    v_dot2c_f32_bf16 v12, v157, v157
    v_dot2c_f32_bf16 v11, v158, v15
    v_dot2c_f32_bf16 v12, v158, v158
    v_dot2c_f32_bf16 v11, v159, v15
    v_dot2c_f32_bf16 v12, v159, v159
    v_dot2c_f32_bf16 v11, v160, v15
    v_dot2c_f32_bf16 v12, v160, v160
    v_dot2c_f32_bf16 v11, v161, v15
    v_dot2c_f32_bf16 v12, v161, v161
    v_dot2c_f32_bf16 v11, v162, v15
    v_dot2c_f32_bf16 v12, v162, v162
    v_dot2c_f32_bf16 v11, v163, v15
    v_dot2c_f32_bf16 v12, v163, v163
    v_dot2c_f32_bf16 v11, v164, v15
    v_dot2c_f32_bf16 v12, v164, v164
    v_dot2c_f32_bf16 v11, v165, v15
    v_dot2c_f32_bf16 v12, v165, v165
    v_dot2c_f32_bf16 v11, v166, v15
    v_dot2c_f32_bf16 v12, v166, v166
    v_dot2c_f32_bf16 v11, v167, v15
    v_dot2c_f32_bf16 v12, v167, v167
    v_dot2c_f32_bf16 v11, v168, v15
    v_dot2c_f32_bf16 v12, v168, v168
    v_dot2c_f32_bf16 v11, v169, v15
    v_dot2c_f32_bf16 v12, v169, v169
    v_dot2c_f32_bf16 v11, v170, v15
    v_dot2c_f32_bf16 v12, v170, v170
    v_dot2c_f32_bf16 v11, v171, v15
    v_dot2c_f32_bf16 v12, v171, v171
    v_dot2c_f32_bf16 v11, v172, v15
    v_dot2c_f32_bf16 v12, v172, v172
    v_dot2c_f32_bf16 v11, v173, v15
    v_dot2c_f32_bf16 v12, v173, v173
    v_dot2c_f32_bf16 v11, v174, v15
    v_dot2c_f32_bf16 v12, v174, v174
    v_dot2c_f32_bf16 v11, v175, v15
    v_dot2c_f32_bf16 v12, v175, v175
    v_dot2c_f32_bf16 v11, v176, v15
    v_dot2c_f32_bf16 v12, v176, v176
    v_dot2c_f32_bf16 v11, v177, v15
    v_dot2c_f32_bf16 v12, v177, v177
    v_dot2c_f32_bf16 v11, v178, v15
    v_dot2c_f32_bf16 v12, v178, v178
    v_dot2c_f32_bf16 v11, v179, v15
    v_dot2c_f32_bf16 v12, v179, v179
    v_dot2c_f32_bf16 v11, v180, v15
    v_dot2c_f32_bf16 v12, v180, v180
    v_dot2c_f32_bf16 v11, v181, v15
    v_dot2c_f32_bf16 v12, v181, v181
    v_dot2c_f32_bf16 v11, v182, v15
    v_dot2c_f32_bf16 v12, v182, v182
    v_dot2c_f32_bf16 v11, v183, v15
    v_dot2c_f32_bf16 v12, v183, v183
    v_dot2c_f32_bf16 v11, v184, v15
    v_dot2c_f32_bf16 v12, v184, v184
    v_dot2c_f32_bf16 v11, v185, v15
    v_dot2c_f32_bf16 v12, v185, v185
    v_dot2c_f32_bf16 v11, v186, v15
    v_dot2c_f32_bf16 v12, v186, v186
    v_dot2c_f32_bf16 v11, v187, v15
    v_dot2c_f32_bf16 v12, v187, v187
    v_dot2c_f32_bf16 v11, v188, v15
    v_dot2c_f32_bf16 v12, v188, v188
    v_dot2c_f32_bf16 v11, v189, v15
    v_dot2c_f32_bf16 v12, v189, v189
    v_dot2c_f32_bf16 v11, v190, v15
    v_dot2c_f32_bf16 v12, v190, v190
    v_dot2c_f32_bf16 v11, v191, v15
    v_dot2c_f32_bf16 v12, v191, v191
    v_dot2c_f32_bf16 v11, v192, v15
    v_dot2c_f32_bf16 v12, v192, v192
    v_dot2c_f32_bf16 v11, v193, v15
    v_dot2c_f32_bf16 v12, v193, v193
    v_dot2c_f32_bf16 v11, v194, v15
    v_dot2c_f32_bf16 v12, v194, v194
    v_dot2c_f32_bf16 v11, v195, v15
    v_dot2c_f32_bf16 v12, v195, v195
    v_dot2c_f32_bf16 v11, v196, v15
    v_dot2c_f32_bf16 v12, v196, v196
    v_dot2c_f32_bf16 v11, v197, v15
    v_dot2c_f32_bf16 v12, v197, v197
    v_dot2c_f32_bf16 v11, v198, v15
    v_dot2c_f32_bf16 v12, v198, v198
    v_dot2c_f32_bf16 v11, v199, v15
    v_dot2c_f32_bf16 v12, v199, v199
    v_dot2c_f32_bf16 v11, v200, v15
    v_dot2c_f32_bf16 v12, v200, v200
    v_dot2c_f32_bf16 v11, v201, v15
    v_dot2c_f32_bf16 v12, v201, v201
    v_dot2c_f32_bf16 v11, v202, v15
    v_dot2c_f32_bf16 v12, v202, v202
    v_dot2c_f32_bf16 v11, v203, v15
    v_dot2c_f32_bf16 v12, v203, v203
    v_dot2c_f32_bf16 v11, v204, v15
    v_dot2c_f32_bf16 v12, v204, v204
    v_dot2c_f32_bf16 v11, v205, v15
    v_dot2c_f32_bf16 v12, v205, v205
    v_dot2c_f32_bf16 v11, v206, v15
    v_dot2c_f32_bf16 v12, v206, v206
    v_dot2c_f32_bf16 v11, v207, v15
    v_dot2c_f32_bf16 v12, v207, v207
    v_dot2c_f32_bf16 v11, v208, v15
    v_dot2c_f32_bf16 v12, v208, v208
    v_dot2c_f32_bf16 v11, v209, v15
    v_dot2c_f32_bf16 v12, v209, v209
    v_dot2c_f32_bf16 v11, v210, v15
    v_dot2c_f32_bf16 v12, v210, v210
    v_dot2c_f32_bf16 v11, v211, v15
    v_dot2c_f32_bf16 v12, v211, v211
    v_dot2c_f32_bf16 v11, v212, v15
    v_dot2c_f32_bf16 v12, v212, v212
    v_dot2c_f32_bf16 v11, v213, v15
    v_dot2c_f32_bf16 v12, v213, v213
    v_dot2c_f32_bf16 v11, v214, v15
    v_dot2c_f32_bf16 v12, v214, v214
    v_dot2c_f32_bf16 v11, v215, v15
    v_dot2c_f32_bf16 v12, v215, v215
    s_nop 3
    ds_swizzle_b32 v3, v11 offset:0x401F
    s_waitcnt lgkmcnt(0)
    v_add_f32 v11, v11, v3
    s_nop 0
    ds_bpermute_b32 v3, v17, v11
    s_waitcnt lgkmcnt(0)
    v_add_f32 v11, v11, v3
    ds_swizzle_b32 v3, v12 offset:0x401F
    s_waitcnt lgkmcnt(0)
    v_add_f32 v12, v12, v3
    s_nop 0
    ds_bpermute_b32 v3, v17, v12
    s_waitcnt lgkmcnt(0)
    v_add_f32 v12, v12, v3
    v_mul_f32 v11, 0x3acccccd, v11
    v_mul_f32 v12, 0x3acccccd, v12
    v_fma_f32 v12, -v11, v11, v12
    v_max_f32 v12, 0, v12
    v_add_f32 v12, 0x3727c5ac, v12
    v_rsq_f32 v13, v12
    s_nop 0
    v_mul_f32 v14, v11, v13
    v_sub_f32 v14, 0, v14
    v_lshlrev_b32 v3, 16, v136
    v_and_b32 v4, 0xffff0000, v136
    v_fma_f32 v3, v3, v13, v14
    v_fma_f32 v4, v4, v13, v14
    v_cvt_pk_bf16_f32 v136, v3, v4
    v_lshlrev_b32 v5, 16, v137
    v_and_b32 v6, 0xffff0000, v137
    v_fma_f32 v5, v5, v13, v14
    v_fma_f32 v6, v6, v13, v14
    v_cvt_pk_bf16_f32 v137, v5, v6
    v_lshlrev_b32 v3, 16, v138
    v_and_b32 v4, 0xffff0000, v138
    v_fma_f32 v3, v3, v13, v14
    v_fma_f32 v4, v4, v13, v14
    v_cvt_pk_bf16_f32 v138, v3, v4
    v_lshlrev_b32 v5, 16, v139
    v_and_b32 v6, 0xffff0000, v139
    v_fma_f32 v5, v5, v13, v14
    v_fma_f32 v6, v6, v13, v14
    v_cvt_pk_bf16_f32 v139, v5, v6
    v_lshlrev_b32 v3, 16, v140
    v_and_b32 v4, 0xffff0000, v140
    v_fma_f32 v3, v3, v13, v14
    v_fma_f32 v4, v4, v13, v14
    v_cvt_pk_bf16_f32 v140, v3, v4
    v_lshlrev_b32 v5, 16, v141
    v_and_b32 v6, 0xffff0000, v141
    v_fma_f32 v5, v5, v13, v14
    v_fma_f32 v6, v6, v13, v14
    v_cvt_pk_bf16_f32 v141, v5, v6
    v_lshlrev_b32 v3, 16, v142
    v_and_b32 v4, 0xffff0000, v142
    v_fma_f32 v3, v3, v13, v14
    v_fma_f32 v4, v4, v13, v14
    v_cvt_pk_bf16_f32 v142, v3, v4
    v_lshlrev_b32 v5, 16, v143
    v_and_b32 v6, 0xffff0000, v143
    v_fma_f32 v5, v5, v13, v14
    v_fma_f32 v6, v6, v13, v14
    v_cvt_pk_bf16_f32 v143, v5, v6
    v_lshlrev_b32 v3, 16, v144
    v_and_b32 v4, 0xffff0000, v144
    v_fma_f32 v3, v3, v13, v14
    v_fma_f32 v4, v4, v13, v14
    v_cvt_pk_bf16_f32 v144, v3, v4
    v_lshlrev_b32 v5, 16, v145
    v_and_b32 v6, 0xffff0000, v145
    v_fma_f32 v5, v5, v13, v14
    v_fma_f32 v6, v6, v13, v14
    v_cvt_pk_bf16_f32 v145, v5, v6
    v_lshlrev_b32 v3, 16, v146
    v_and_b32 v4, 0xffff0000, v146
    v_fma_f32 v3, v3, v13, v14
    v_fma_f32 v4, v4, v13, v14
    v_cvt_pk_bf16_f32 v146, v3, v4
    v_lshlrev_b32 v5, 16, v147
    v_and_b32 v6, 0xffff0000, v147
    v_fma_f32 v5, v5, v13, v14
    v_fma_f32 v6, v6, v13, v14
    v_cvt_pk_bf16_f32 v147, v5, v6
    v_lshlrev_b32 v3, 16, v148
    v_and_b32 v4, 0xffff0000, v148
    v_fma_f32 v3, v3, v13, v14
    v_fma_f32 v4, v4, v13, v14
    v_cvt_pk_bf16_f32 v148, v3, v4
    v_lshlrev_b32 v5, 16, v149
    v_and_b32 v6, 0xffff0000, v149
    v_fma_f32 v5, v5, v13, v14
    v_fma_f32 v6, v6, v13, v14
    v_cvt_pk_bf16_f32 v149, v5, v6
    v_lshlrev_b32 v3, 16, v150
    v_and_b32 v4, 0xffff0000, v150
    v_fma_f32 v3, v3, v13, v14
    v_fma_f32 v4, v4, v13, v14
    v_cvt_pk_bf16_f32 v150, v3, v4
    v_lshlrev_b32 v5, 16, v151
    v_and_b32 v6, 0xffff0000, v151
    v_fma_f32 v5, v5, v13, v14
    v_fma_f32 v6, v6, v13, v14
    v_cvt_pk_bf16_f32 v151, v5, v6
    v_lshlrev_b32 v3, 16, v152
    v_and_b32 v4, 0xffff0000, v152
    v_fma_f32 v3, v3, v13, v14
    v_fma_f32 v4, v4, v13, v14
    v_cvt_pk_bf16_f32 v152, v3, v4
    v_lshlrev_b32 v5, 16, v153
    v_and_b32 v6, 0xffff0000, v153
    v_fma_f32 v5, v5, v13, v14
    v_fma_f32 v6, v6, v13, v14
    v_cvt_pk_bf16_f32 v153, v5, v6
    v_lshlrev_b32 v3, 16, v154
    v_and_b32 v4, 0xffff0000, v154
    v_fma_f32 v3, v3, v13, v14
    v_fma_f32 v4, v4, v13, v14
    v_cvt_pk_bf16_f32 v154, v3, v4
    v_lshlrev_b32 v5, 16, v155
    v_and_b32 v6, 0xffff0000, v155
    v_fma_f32 v5, v5, v13, v14
    v_fma_f32 v6, v6, v13, v14
    v_cvt_pk_bf16_f32 v155, v5, v6
    v_lshlrev_b32 v3, 16, v156
    v_and_b32 v4, 0xffff0000, v156
    v_fma_f32 v3, v3, v13, v14
    v_fma_f32 v4, v4, v13, v14
    v_cvt_pk_bf16_f32 v156, v3, v4
    v_lshlrev_b32 v5, 16, v157
    v_and_b32 v6, 0xffff0000, v157
    v_fma_f32 v5, v5, v13, v14
    v_fma_f32 v6, v6, v13, v14
    v_cvt_pk_bf16_f32 v157, v5, v6
    v_lshlrev_b32 v3, 16, v158
    v_and_b32 v4, 0xffff0000, v158
    v_fma_f32 v3, v3, v13, v14
    v_fma_f32 v4, v4, v13, v14
    v_cvt_pk_bf16_f32 v158, v3, v4
    v_lshlrev_b32 v5, 16, v159
    v_and_b32 v6, 0xffff0000, v159
    v_fma_f32 v5, v5, v13, v14
    v_fma_f32 v6, v6, v13, v14
    v_cvt_pk_bf16_f32 v159, v5, v6
    v_lshlrev_b32 v3, 16, v160
    v_and_b32 v4, 0xffff0000, v160
    v_fma_f32 v3, v3, v13, v14
    v_fma_f32 v4, v4, v13, v14
    v_cvt_pk_bf16_f32 v160, v3, v4
    v_lshlrev_b32 v5, 16, v161
    v_and_b32 v6, 0xffff0000, v161
    v_fma_f32 v5, v5, v13, v14
    v_fma_f32 v6, v6, v13, v14
    v_cvt_pk_bf16_f32 v161, v5, v6
    v_lshlrev_b32 v3, 16, v162
    v_and_b32 v4, 0xffff0000, v162
    v_fma_f32 v3, v3, v13, v14
    v_fma_f32 v4, v4, v13, v14
    v_cvt_pk_bf16_f32 v162, v3, v4
    v_lshlrev_b32 v5, 16, v163
    v_and_b32 v6, 0xffff0000, v163
    v_fma_f32 v5, v5, v13, v14
    v_fma_f32 v6, v6, v13, v14
    v_cvt_pk_bf16_f32 v163, v5, v6
    v_lshlrev_b32 v3, 16, v164
    v_and_b32 v4, 0xffff0000, v164
    v_fma_f32 v3, v3, v13, v14
    v_fma_f32 v4, v4, v13, v14
    v_cvt_pk_bf16_f32 v164, v3, v4
    v_lshlrev_b32 v5, 16, v165
    v_and_b32 v6, 0xffff0000, v165
    v_fma_f32 v5, v5, v13, v14
    v_fma_f32 v6, v6, v13, v14
    v_cvt_pk_bf16_f32 v165, v5, v6
    v_lshlrev_b32 v3, 16, v166
    v_and_b32 v4, 0xffff0000, v166
    v_fma_f32 v3, v3, v13, v14
    v_fma_f32 v4, v4, v13, v14
    v_cvt_pk_bf16_f32 v166, v3, v4
    v_lshlrev_b32 v5, 16, v167
    v_and_b32 v6, 0xffff0000, v167
    v_fma_f32 v5, v5, v13, v14
    v_fma_f32 v6, v6, v13, v14
    v_cvt_pk_bf16_f32 v167, v5, v6
    v_lshlrev_b32 v3, 16, v168
    v_and_b32 v4, 0xffff0000, v168
    v_fma_f32 v3, v3, v13, v14
    v_fma_f32 v4, v4, v13, v14
    v_cvt_pk_bf16_f32 v168, v3, v4
    v_lshlrev_b32 v5, 16, v169
    v_and_b32 v6, 0xffff0000, v169
    v_fma_f32 v5, v5, v13, v14
    v_fma_f32 v6, v6, v13, v14
    v_cvt_pk_bf16_f32 v169, v5, v6
    v_lshlrev_b32 v3, 16, v170
    v_and_b32 v4, 0xffff0000, v170
    v_fma_f32 v3, v3, v13, v14
    v_fma_f32 v4, v4, v13, v14
    v_cvt_pk_bf16_f32 v170, v3, v4
    v_lshlrev_b32 v5, 16, v171
    v_and_b32 v6, 0xffff0000, v171
    v_fma_f32 v5, v5, v13, v14
    v_fma_f32 v6, v6, v13, v14
    v_cvt_pk_bf16_f32 v171, v5, v6
    v_lshlrev_b32 v3, 16, v172
    v_and_b32 v4, 0xffff0000, v172
    v_fma_f32 v3, v3, v13, v14
    v_fma_f32 v4, v4, v13, v14
    v_cvt_pk_bf16_f32 v172, v3, v4
    v_lshlrev_b32 v5, 16, v173
    v_and_b32 v6, 0xffff0000, v173
    v_fma_f32 v5, v5, v13, v14
    v_fma_f32 v6, v6, v13, v14
    v_cvt_pk_bf16_f32 v173, v5, v6
    v_lshlrev_b32 v3, 16, v174
    v_and_b32 v4, 0xffff0000, v174
    v_fma_f32 v3, v3, v13, v14
    v_fma_f32 v4, v4, v13, v14
    v_cvt_pk_bf16_f32 v174, v3, v4
    v_lshlrev_b32 v5, 16, v175
    v_and_b32 v6, 0xffff0000, v175
    v_fma_f32 v5, v5, v13, v14
    v_fma_f32 v6, v6, v13, v14
    v_cvt_pk_bf16_f32 v175, v5, v6
    v_lshlrev_b32 v3, 16, v176
    v_and_b32 v4, 0xffff0000, v176
    v_fma_f32 v3, v3, v13, v14
    v_fma_f32 v4, v4, v13, v14
    v_cvt_pk_bf16_f32 v176, v3, v4
    v_lshlrev_b32 v5, 16, v177
    v_and_b32 v6, 0xffff0000, v177
    v_fma_f32 v5, v5, v13, v14
    v_fma_f32 v6, v6, v13, v14
    v_cvt_pk_bf16_f32 v177, v5, v6
    v_lshlrev_b32 v3, 16, v178
    v_and_b32 v4, 0xffff0000, v178
    v_fma_f32 v3, v3, v13, v14
    v_fma_f32 v4, v4, v13, v14
    v_cvt_pk_bf16_f32 v178, v3, v4
    v_lshlrev_b32 v5, 16, v179
    v_and_b32 v6, 0xffff0000, v179
    v_fma_f32 v5, v5, v13, v14
    v_fma_f32 v6, v6, v13, v14
    v_cvt_pk_bf16_f32 v179, v5, v6
    v_lshlrev_b32 v3, 16, v180
    v_and_b32 v4, 0xffff0000, v180
    v_fma_f32 v3, v3, v13, v14
    v_fma_f32 v4, v4, v13, v14
    v_cvt_pk_bf16_f32 v180, v3, v4
    v_lshlrev_b32 v5, 16, v181
    v_and_b32 v6, 0xffff0000, v181
    v_fma_f32 v5, v5, v13, v14
    v_fma_f32 v6, v6, v13, v14
    v_cvt_pk_bf16_f32 v181, v5, v6
    v_lshlrev_b32 v3, 16, v182
    v_and_b32 v4, 0xffff0000, v182
    v_fma_f32 v3, v3, v13, v14
    v_fma_f32 v4, v4, v13, v14
    v_cvt_pk_bf16_f32 v182, v3, v4
    v_lshlrev_b32 v5, 16, v183
    v_and_b32 v6, 0xffff0000, v183
    v_fma_f32 v5, v5, v13, v14
    v_fma_f32 v6, v6, v13, v14
    v_cvt_pk_bf16_f32 v183, v5, v6
    v_lshlrev_b32 v3, 16, v184
    v_and_b32 v4, 0xffff0000, v184
    v_fma_f32 v3, v3, v13, v14
    v_fma_f32 v4, v4, v13, v14
    v_cvt_pk_bf16_f32 v184, v3, v4
    v_lshlrev_b32 v5, 16, v185
    v_and_b32 v6, 0xffff0000, v185
    v_fma_f32 v5, v5, v13, v14
    v_fma_f32 v6, v6, v13, v14
    v_cvt_pk_bf16_f32 v185, v5, v6
    v_lshlrev_b32 v3, 16, v186
    v_and_b32 v4, 0xffff0000, v186
    v_fma_f32 v3, v3, v13, v14
    v_fma_f32 v4, v4, v13, v14
    v_cvt_pk_bf16_f32 v186, v3, v4
    v_lshlrev_b32 v5, 16, v187
    v_and_b32 v6, 0xffff0000, v187
    v_fma_f32 v5, v5, v13, v14
    v_fma_f32 v6, v6, v13, v14
    v_cvt_pk_bf16_f32 v187, v5, v6
    v_lshlrev_b32 v3, 16, v188
    v_and_b32 v4, 0xffff0000, v188
    v_fma_f32 v3, v3, v13, v14
    v_fma_f32 v4, v4, v13, v14
    v_cvt_pk_bf16_f32 v188, v3, v4
    v_lshlrev_b32 v5, 16, v189
    v_and_b32 v6, 0xffff0000, v189
    v_fma_f32 v5, v5, v13, v14
    v_fma_f32 v6, v6, v13, v14
    v_cvt_pk_bf16_f32 v189, v5, v6
    v_lshlrev_b32 v3, 16, v190
    v_and_b32 v4, 0xffff0000, v190
    v_fma_f32 v3, v3, v13, v14
    v_fma_f32 v4, v4, v13, v14
    v_cvt_pk_bf16_f32 v190, v3, v4
    v_lshlrev_b32 v5, 16, v191
    v_and_b32 v6, 0xffff0000, v191
    v_fma_f32 v5, v5, v13, v14
    v_fma_f32 v6, v6, v13, v14
    v_cvt_pk_bf16_f32 v191, v5, v6
    v_lshlrev_b32 v3, 16, v192
    v_and_b32 v4, 0xffff0000, v192
    v_fma_f32 v3, v3, v13, v14
    v_fma_f32 v4, v4, v13, v14
    v_cvt_pk_bf16_f32 v192, v3, v4
    v_lshlrev_b32 v5, 16, v193
    v_and_b32 v6, 0xffff0000, v193
    v_fma_f32 v5, v5, v13, v14
    v_fma_f32 v6, v6, v13, v14
    v_cvt_pk_bf16_f32 v193, v5, v6
    v_lshlrev_b32 v3, 16, v194
    v_and_b32 v4, 0xffff0000, v194
    v_fma_f32 v3, v3, v13, v14
    v_fma_f32 v4, v4, v13, v14
    v_cvt_pk_bf16_f32 v194, v3, v4
    v_lshlrev_b32 v5, 16, v195
    v_and_b32 v6, 0xffff0000, v195
    v_fma_f32 v5, v5, v13, v14
    v_fma_f32 v6, v6, v13, v14
    v_cvt_pk_bf16_f32 v195, v5, v6
    v_lshlrev_b32 v3, 16, v196
    v_and_b32 v4, 0xffff0000, v196
    v_fma_f32 v3, v3, v13, v14
    v_fma_f32 v4, v4, v13, v14
    v_cvt_pk_bf16_f32 v196, v3, v4
    v_lshlrev_b32 v5, 16, v197
    v_and_b32 v6, 0xffff0000, v197
    v_fma_f32 v5, v5, v13, v14
    v_fma_f32 v6, v6, v13, v14
    v_cvt_pk_bf16_f32 v197, v5, v6
    v_lshlrev_b32 v3, 16, v198
    v_and_b32 v4, 0xffff0000, v198
    v_fma_f32 v3, v3, v13, v14
    v_fma_f32 v4, v4, v13, v14
    v_cvt_pk_bf16_f32 v198, v3, v4
    v_lshlrev_b32 v5, 16, v199
    v_and_b32 v6, 0xffff0000, v199
    v_fma_f32 v5, v5, v13, v14
    v_fma_f32 v6, v6, v13, v14
    v_cvt_pk_bf16_f32 v199, v5, v6
    v_lshlrev_b32 v3, 16, v200
    v_and_b32 v4, 0xffff0000, v200
    v_fma_f32 v3, v3, v13, v14
    v_fma_f32 v4, v4, v13, v14
    v_cvt_pk_bf16_f32 v200, v3, v4
    v_lshlrev_b32 v5, 16, v201
    v_and_b32 v6, 0xffff0000, v201
    v_fma_f32 v5, v5, v13, v14
    v_fma_f32 v6, v6, v13, v14
    v_cvt_pk_bf16_f32 v201, v5, v6
    v_lshlrev_b32 v3, 16, v202
    v_and_b32 v4, 0xffff0000, v202
    v_fma_f32 v3, v3, v13, v14
    v_fma_f32 v4, v4, v13, v14
    v_cvt_pk_bf16_f32 v202, v3, v4
    v_lshlrev_b32 v5, 16, v203
    v_and_b32 v6, 0xffff0000, v203
    v_fma_f32 v5, v5, v13, v14
    v_fma_f32 v6, v6, v13, v14
    v_cvt_pk_bf16_f32 v203, v5, v6
    v_lshlrev_b32 v3, 16, v204
    v_and_b32 v4, 0xffff0000, v204
    v_fma_f32 v3, v3, v13, v14
    v_fma_f32 v4, v4, v13, v14
    v_cvt_pk_bf16_f32 v204, v3, v4
    v_lshlrev_b32 v5, 16, v205
    v_and_b32 v6, 0xffff0000, v205
    v_fma_f32 v5, v5, v13, v14
    v_fma_f32 v6, v6, v13, v14
    v_cvt_pk_bf16_f32 v205, v5, v6
    v_lshlrev_b32 v3, 16, v206
    v_and_b32 v4, 0xffff0000, v206
    v_fma_f32 v3, v3, v13, v14
    v_fma_f32 v4, v4, v13, v14
    v_cvt_pk_bf16_f32 v206, v3, v4
    v_lshlrev_b32 v5, 16, v207
    v_and_b32 v6, 0xffff0000, v207
    v_fma_f32 v5, v5, v13, v14
    v_fma_f32 v6, v6, v13, v14
    v_cvt_pk_bf16_f32 v207, v5, v6
    v_lshlrev_b32 v3, 16, v208
    v_and_b32 v4, 0xffff0000, v208
    v_fma_f32 v3, v3, v13, v14
    v_fma_f32 v4, v4, v13, v14
    v_cvt_pk_bf16_f32 v208, v3, v4
    v_lshlrev_b32 v5, 16, v209
    v_and_b32 v6, 0xffff0000, v209
    v_fma_f32 v5, v5, v13, v14
    v_fma_f32 v6, v6, v13, v14
    v_cvt_pk_bf16_f32 v209, v5, v6
    v_lshlrev_b32 v3, 16, v210
    v_and_b32 v4, 0xffff0000, v210
    v_fma_f32 v3, v3, v13, v14
    v_fma_f32 v4, v4, v13, v14
    v_cvt_pk_bf16_f32 v210, v3, v4
    v_lshlrev_b32 v5, 16, v211
    v_and_b32 v6, 0xffff0000, v211
    v_fma_f32 v5, v5, v13, v14
    v_fma_f32 v6, v6, v13, v14
    v_cvt_pk_bf16_f32 v211, v5, v6
    v_lshlrev_b32 v3, 16, v212
    v_and_b32 v4, 0xffff0000, v212
    v_fma_f32 v3, v3, v13, v14
    v_fma_f32 v4, v4, v13, v14
    v_cvt_pk_bf16_f32 v212, v3, v4
    v_lshlrev_b32 v5, 16, v213
    v_and_b32 v6, 0xffff0000, v213
    v_fma_f32 v5, v5, v13, v14
    v_fma_f32 v6, v6, v13, v14
    v_cvt_pk_bf16_f32 v213, v5, v6
    v_lshlrev_b32 v3, 16, v214
    v_and_b32 v4, 0xffff0000, v214
    v_fma_f32 v3, v3, v13, v14
    v_fma_f32 v4, v4, v13, v14
    v_cvt_pk_bf16_f32 v214, v3, v4
    v_lshlrev_b32 v5, 16, v215
    v_and_b32 v6, 0xffff0000, v215
    v_fma_f32 v5, v5, v13, v14
    v_fma_f32 v6, v6, v13, v14
    v_cvt_pk_bf16_f32 v215, v5, v6
    s_cmp_lg_u32 s4, 0
    s_cbranch_scc1 L_k4_w1_kernel_noxp
    buffer_store_dwordx4 v[136:139], v18, s[28:31], 0 offen offset:0
    buffer_store_dwordx4 v[140:143], v18, s[28:31], 0 offen offset:64
    buffer_store_dwordx4 v[144:147], v18, s[28:31], 0 offen offset:128
    buffer_store_dwordx4 v[148:151], v18, s[28:31], 0 offen offset:192
    buffer_store_dwordx4 v[152:155], v18, s[28:31], 0 offen offset:256
    buffer_store_dwordx4 v[156:159], v18, s[28:31], 0 offen offset:320
    buffer_store_dwordx4 v[160:163], v18, s[28:31], 0 offen offset:384
    buffer_store_dwordx4 v[164:167], v18, s[28:31], 0 offen offset:448
    buffer_store_dwordx4 v[168:171], v18, s[28:31], 0 offen offset:512
    buffer_store_dwordx4 v[172:175], v18, s[28:31], 0 offen offset:576
    buffer_store_dwordx4 v[176:179], v18, s[28:31], 0 offen offset:640
    buffer_store_dwordx4 v[180:183], v18, s[28:31], 0 offen offset:704
    buffer_store_dwordx4 v[184:187], v18, s[28:31], 0 offen offset:768
    buffer_store_dwordx4 v[188:191], v18, s[28:31], 0 offen offset:832
    buffer_store_dwordx4 v[192:195], v18, s[28:31], 0 offen offset:896
    buffer_store_dwordx4 v[196:199], v18, s[28:31], 0 offen offset:960
    buffer_store_dwordx4 v[200:203], v18, s[28:31], 0 offen offset:1024
    buffer_store_dwordx4 v[204:207], v18, s[28:31], 0 offen offset:1088
    buffer_store_dwordx4 v[208:211], v18, s[28:31], 0 offen offset:1152
    buffer_store_dwordx4 v[212:215], v18, s[28:31], 0 offen offset:1216
L_k4_w1_kernel_noxp:
    v_mov_b32 v11, 0
    v_mov_b32 v12, 0
    v_mov_b32 v15, 0x3f803f80
    s_nop 0
    v_dot2c_f32_bf16 v11, v136, v15
    v_dot2c_f32_bf16 v12, v136, v136
    v_dot2c_f32_bf16 v11, v137, v15
    v_dot2c_f32_bf16 v12, v137, v137
    v_dot2c_f32_bf16 v11, v138, v15
    v_dot2c_f32_bf16 v12, v138, v138
    v_dot2c_f32_bf16 v11, v139, v15
    v_dot2c_f32_bf16 v12, v139, v139
    v_dot2c_f32_bf16 v11, v140, v15
    v_dot2c_f32_bf16 v12, v140, v140
    v_dot2c_f32_bf16 v11, v141, v15
    v_dot2c_f32_bf16 v12, v141, v141
    v_dot2c_f32_bf16 v11, v142, v15
    v_dot2c_f32_bf16 v12, v142, v142
    v_dot2c_f32_bf16 v11, v143, v15
    v_dot2c_f32_bf16 v12, v143, v143
    v_dot2c_f32_bf16 v11, v144, v15
    v_dot2c_f32_bf16 v12, v144, v144
    v_dot2c_f32_bf16 v11, v145, v15
    v_dot2c_f32_bf16 v12, v145, v145
    v_dot2c_f32_bf16 v11, v146, v15
    v_dot2c_f32_bf16 v12, v146, v146
    v_dot2c_f32_bf16 v11, v147, v15
    v_dot2c_f32_bf16 v12, v147, v147
    v_dot2c_f32_bf16 v11, v148, v15
    v_dot2c_f32_bf16 v12, v148, v148
    v_dot2c_f32_bf16 v11, v149, v15
    v_dot2c_f32_bf16 v12, v149, v149
    v_dot2c_f32_bf16 v11, v150, v15
    v_dot2c_f32_bf16 v12, v150, v150
    v_dot2c_f32_bf16 v11, v151, v15
    v_dot2c_f32_bf16 v12, v151, v151
    v_dot2c_f32_bf16 v11, v152, v15
    v_dot2c_f32_bf16 v12, v152, v152
    v_dot2c_f32_bf16 v11, v153, v15
    v_dot2c_f32_bf16 v12, v153, v153
    v_dot2c_f32_bf16 v11, v154, v15
    v_dot2c_f32_bf16 v12, v154, v154
    v_dot2c_f32_bf16 v11, v155, v15
    v_dot2c_f32_bf16 v12, v155, v155
    v_dot2c_f32_bf16 v11, v156, v15
    v_dot2c_f32_bf16 v12, v156, v156
    v_dot2c_f32_bf16 v11, v157, v15
    v_dot2c_f32_bf16 v12, v157, v157
    v_dot2c_f32_bf16 v11, v158, v15
    v_dot2c_f32_bf16 v12, v158, v158
    v_dot2c_f32_bf16 v11, v159, v15
    v_dot2c_f32_bf16 v12, v159, v159
    v_dot2c_f32_bf16 v11, v160, v15
    v_dot2c_f32_bf16 v12, v160, v160
    v_dot2c_f32_bf16 v11, v161, v15
    v_dot2c_f32_bf16 v12, v161, v161
    v_dot2c_f32_bf16 v11, v162, v15
    v_dot2c_f32_bf16 v12, v162, v162
    v_dot2c_f32_bf16 v11, v163, v15
    v_dot2c_f32_bf16 v12, v163, v163
    v_dot2c_f32_bf16 v11, v164, v15
    v_dot2c_f32_bf16 v12, v164, v164
    v_dot2c_f32_bf16 v11, v165, v15
    v_dot2c_f32_bf16 v12, v165, v165
    v_dot2c_f32_bf16 v11, v166, v15
    v_dot2c_f32_bf16 v12, v166, v166
    v_dot2c_f32_bf16 v11, v167, v15
    v_dot2c_f32_bf16 v12, v167, v167
    v_dot2c_f32_bf16 v11, v168, v15
    v_dot2c_f32_bf16 v12, v168, v168
    v_dot2c_f32_bf16 v11, v169, v15
    v_dot2c_f32_bf16 v12, v169, v169
    v_dot2c_f32_bf16 v11, v170, v15
    v_dot2c_f32_bf16 v12, v170, v170
    v_dot2c_f32_bf16 v11, v171, v15
    v_dot2c_f32_bf16 v12, v171, v171
    v_dot2c_f32_bf16 v11, v172, v15
    v_dot2c_f32_bf16 v12, v172, v172
    v_dot2c_f32_bf16 v11, v173, v15
    v_dot2c_f32_bf16 v12, v173, v173
    v_dot2c_f32_bf16 v11, v174, v15
    v_dot2c_f32_bf16 v12, v174, v174
    v_dot2c_f32_bf16 v11, v175, v15
    v_dot2c_f32_bf16 v12, v175, v175
    v_dot2c_f32_bf16 v11, v176, v15
    v_dot2c_f32_bf16 v12, v176, v176
    v_dot2c_f32_bf16 v11, v177, v15
    v_dot2c_f32_bf16 v12, v177, v177
    v_dot2c_f32_bf16 v11, v178, v15
    v_dot2c_f32_bf16 v12, v178, v178
    v_dot2c_f32_bf16 v11, v179, v15
    v_dot2c_f32_bf16 v12, v179, v179
    v_dot2c_f32_bf16 v11, v180, v15
    v_dot2c_f32_bf16 v12, v180, v180
    v_dot2c_f32_bf16 v11, v181, v15
    v_dot2c_f32_bf16 v12, v181, v181
    v_dot2c_f32_bf16 v11, v182, v15
    v_dot2c_f32_bf16 v12, v182, v182
    v_dot2c_f32_bf16 v11, v183, v15
    v_dot2c_f32_bf16 v12, v183, v183
    v_dot2c_f32_bf16 v11, v184, v15
    v_dot2c_f32_bf16 v12, v184, v184
    v_dot2c_f32_bf16 v11, v185, v15
    v_dot2c_f32_bf16 v12, v185, v185
    v_dot2c_f32_bf16 v11, v186, v15
    v_dot2c_f32_bf16 v12, v186, v186
    v_dot2c_f32_bf16 v11, v187, v15
    v_dot2c_f32_bf16 v12, v187, v187
    v_dot2c_f32_bf16 v11, v188, v15
    v_dot2c_f32_bf16 v12, v188, v188
    v_dot2c_f32_bf16 v11, v189, v15
    v_dot2c_f32_bf16 v12, v189, v189
    v_dot2c_f32_bf16 v11, v190, v15
    v_dot2c_f32_bf16 v12, v190, v190
    v_dot2c_f32_bf16 v11, v191, v15
    v_dot2c_f32_bf16 v12, v191, v191
    v_dot2c_f32_bf16 v11, v192, v15
    v_dot2c_f32_bf16 v12, v192, v192
    v_dot2c_f32_bf16 v11, v193, v15
    v_dot2c_f32_bf16 v12, v193, v193
    v_dot2c_f32_bf16 v11, v194, v15
    v_dot2c_f32_bf16 v12, v194, v194
    v_dot2c_f32_bf16 v11, v195, v15
    v_dot2c_f32_bf16 v12, v195, v195
    v_dot2c_f32_bf16 v11, v196, v15
    v_dot2c_f32_bf16 v12, v196, v196
    v_dot2c_f32_bf16 v11, v197, v15
    v_dot2c_f32_bf16 v12, v197, v197
    v_dot2c_f32_bf16 v11, v198, v15
    v_dot2c_f32_bf16 v12, v198, v198
    v_dot2c_f32_bf16 v11, v199, v15
    v_dot2c_f32_bf16 v12, v199, v199
    v_dot2c_f32_bf16 v11, v200, v15
    v_dot2c_f32_bf16 v12, v200, v200
    v_dot2c_f32_bf16 v11, v201, v15
    v_dot2c_f32_bf16 v12, v201, v201
    v_dot2c_f32_bf16 v11, v202, v15
    v_dot2c_f32_bf16 v12, v202, v202
    v_dot2c_f32_bf16 v11, v203, v15
    v_dot2c_f32_bf16 v12, v203, v203
    v_dot2c_f32_bf16 v11, v204, v15
    v_dot2c_f32_bf16 v12, v204, v204
    v_dot2c_f32_bf16 v11, v205, v15
    v_dot2c_f32_bf16 v12, v205, v205
    v_dot2c_f32_bf16 v11, v206, v15
    v_dot2c_f32_bf16 v12, v206, v206
    v_dot2c_f32_bf16 v11, v207, v15
    v_dot2c_f32_bf16 v12, v207, v207
    v_dot2c_f32_bf16 v11, v208, v15
    v_dot2c_f32_bf16 v12, v208, v208
    v_dot2c_f32_bf16 v11, v209, v15
    v_dot2c_f32_bf16 v12, v209, v209
    v_dot2c_f32_bf16 v11, v210, v15
    v_dot2c_f32_bf16 v12, v210, v210
    v_dot2c_f32_bf16 v11, v211, v15
    v_dot2c_f32_bf16 v12, v211, v211
    v_dot2c_f32_bf16 v11, v212, v15
    v_dot2c_f32_bf16 v12, v212, v212
    v_dot2c_f32_bf16 v11, v213, v15
    v_dot2c_f32_bf16 v12, v213, v213
    v_dot2c_f32_bf16 v11, v214, v15
    v_dot2c_f32_bf16 v12, v214, v214
    v_dot2c_f32_bf16 v11, v215, v15
    v_dot2c_f32_bf16 v12, v215, v215
    s_nop 3
    ds_swizzle_b32 v3, v11 offset:0x401F
    s_waitcnt lgkmcnt(0)
    v_add_f32 v11, v11, v3
    s_nop 0
    ds_bpermute_b32 v3, v17, v11
    s_waitcnt lgkmcnt(0)
    v_add_f32 v11, v11, v3
    ds_swizzle_b32 v3, v12 offset:0x401F
    s_waitcnt lgkmcnt(0)
    v_add_f32 v12, v12, v3
    s_nop 0
    ds_bpermute_b32 v3, v17, v12
    s_waitcnt lgkmcnt(0)
    v_add_f32 v12, v12, v3
    v_mul_f32 v11, 0x3acccccd, v11
    v_mul_f32 v12, 0x3acccccd, v12
    v_fma_f32 v12, -v11, v11, v12
    v_max_f32 v12, 0, v12
    v_add_f32 v12, 0x3727c5ac, v12
    v_rsq_f32 v13, v12
    s_nop 0
    v_mul_f32 v14, v11, v13
    v_sub_f32 v14, 0, v14
    v_lshlrev_b32 v3, 16, v136
    v_and_b32 v4, 0xffff0000, v136
    v_fma_f32 v3, v3, v13, v14
    v_fma_f32 v4, v4, v13, v14
    v_cvt_pk_bf16_f32 v136, v3, v4
    v_lshlrev_b32 v5, 16, v137
    v_and_b32 v6, 0xffff0000, v137
    v_fma_f32 v5, v5, v13, v14
    v_fma_f32 v6, v6, v13, v14
    v_cvt_pk_bf16_f32 v137, v5, v6
    v_lshlrev_b32 v3, 16, v138
    v_and_b32 v4, 0xffff0000, v138
    v_fma_f32 v3, v3, v13, v14
    v_fma_f32 v4, v4, v13, v14
    v_cvt_pk_bf16_f32 v138, v3, v4
    v_lshlrev_b32 v5, 16, v139
    v_and_b32 v6, 0xffff0000, v139
    v_fma_f32 v5, v5, v13, v14
    v_fma_f32 v6, v6, v13, v14
    v_cvt_pk_bf16_f32 v139, v5, v6
    v_lshlrev_b32 v3, 16, v140
    v_and_b32 v4, 0xffff0000, v140
    v_fma_f32 v3, v3, v13, v14
    v_fma_f32 v4, v4, v13, v14
    v_cvt_pk_bf16_f32 v140, v3, v4
    v_lshlrev_b32 v5, 16, v141
    v_and_b32 v6, 0xffff0000, v141
    v_fma_f32 v5, v5, v13, v14
    v_fma_f32 v6, v6, v13, v14
    v_cvt_pk_bf16_f32 v141, v5, v6
    v_lshlrev_b32 v3, 16, v142
    v_and_b32 v4, 0xffff0000, v142
    v_fma_f32 v3, v3, v13, v14
    v_fma_f32 v4, v4, v13, v14
    v_cvt_pk_bf16_f32 v142, v3, v4
    v_lshlrev_b32 v5, 16, v143
    v_and_b32 v6, 0xffff0000, v143
    v_fma_f32 v5, v5, v13, v14
    v_fma_f32 v6, v6, v13, v14
    v_cvt_pk_bf16_f32 v143, v5, v6
    v_lshlrev_b32 v3, 16, v144
    v_and_b32 v4, 0xffff0000, v144
    v_fma_f32 v3, v3, v13, v14
    v_fma_f32 v4, v4, v13, v14
    v_cvt_pk_bf16_f32 v144, v3, v4
    v_lshlrev_b32 v5, 16, v145
    v_and_b32 v6, 0xffff0000, v145
    v_fma_f32 v5, v5, v13, v14
    v_fma_f32 v6, v6, v13, v14
    v_cvt_pk_bf16_f32 v145, v5, v6
    v_lshlrev_b32 v3, 16, v146
    v_and_b32 v4, 0xffff0000, v146
    v_fma_f32 v3, v3, v13, v14
    v_fma_f32 v4, v4, v13, v14
    v_cvt_pk_bf16_f32 v146, v3, v4
    v_lshlrev_b32 v5, 16, v147
    v_and_b32 v6, 0xffff0000, v147
    v_fma_f32 v5, v5, v13, v14
    v_fma_f32 v6, v6, v13, v14
    v_cvt_pk_bf16_f32 v147, v5, v6
    v_lshlrev_b32 v3, 16, v148
    v_and_b32 v4, 0xffff0000, v148
    v_fma_f32 v3, v3, v13, v14
    v_fma_f32 v4, v4, v13, v14
    v_cvt_pk_bf16_f32 v148, v3, v4
    v_lshlrev_b32 v5, 16, v149
    v_and_b32 v6, 0xffff0000, v149
    v_fma_f32 v5, v5, v13, v14
    v_fma_f32 v6, v6, v13, v14
    v_cvt_pk_bf16_f32 v149, v5, v6
    v_lshlrev_b32 v3, 16, v150
    v_and_b32 v4, 0xffff0000, v150
    v_fma_f32 v3, v3, v13, v14
    v_fma_f32 v4, v4, v13, v14
    v_cvt_pk_bf16_f32 v150, v3, v4
    v_lshlrev_b32 v5, 16, v151
    v_and_b32 v6, 0xffff0000, v151
    v_fma_f32 v5, v5, v13, v14
    v_fma_f32 v6, v6, v13, v14
    v_cvt_pk_bf16_f32 v151, v5, v6
    v_lshlrev_b32 v3, 16, v152
    v_and_b32 v4, 0xffff0000, v152
    v_fma_f32 v3, v3, v13, v14
    v_fma_f32 v4, v4, v13, v14
    v_cvt_pk_bf16_f32 v152, v3, v4
    v_lshlrev_b32 v5, 16, v153
    v_and_b32 v6, 0xffff0000, v153
    v_fma_f32 v5, v5, v13, v14
    v_fma_f32 v6, v6, v13, v14
    v_cvt_pk_bf16_f32 v153, v5, v6
    v_lshlrev_b32 v3, 16, v154
    v_and_b32 v4, 0xffff0000, v154
    v_fma_f32 v3, v3, v13, v14
    v_fma_f32 v4, v4, v13, v14
    v_cvt_pk_bf16_f32 v154, v3, v4
    v_lshlrev_b32 v5, 16, v155
    v_and_b32 v6, 0xffff0000, v155
    v_fma_f32 v5, v5, v13, v14
    v_fma_f32 v6, v6, v13, v14
    v_cvt_pk_bf16_f32 v155, v5, v6
    v_lshlrev_b32 v3, 16, v156
    v_and_b32 v4, 0xffff0000, v156
    v_fma_f32 v3, v3, v13, v14
    v_fma_f32 v4, v4, v13, v14
    v_cvt_pk_bf16_f32 v156, v3, v4
    v_lshlrev_b32 v5, 16, v157
    v_and_b32 v6, 0xffff0000, v157
    v_fma_f32 v5, v5, v13, v14
    v_fma_f32 v6, v6, v13, v14
    v_cvt_pk_bf16_f32 v157, v5, v6
    v_lshlrev_b32 v3, 16, v158
    v_and_b32 v4, 0xffff0000, v158
    v_fma_f32 v3, v3, v13, v14
    v_fma_f32 v4, v4, v13, v14
    v_cvt_pk_bf16_f32 v158, v3, v4
    v_lshlrev_b32 v5, 16, v159
    v_and_b32 v6, 0xffff0000, v159
    v_fma_f32 v5, v5, v13, v14
    v_fma_f32 v6, v6, v13, v14
    v_cvt_pk_bf16_f32 v159, v5, v6
    v_lshlrev_b32 v3, 16, v160
    v_and_b32 v4, 0xffff0000, v160
    v_fma_f32 v3, v3, v13, v14
    v_fma_f32 v4, v4, v13, v14
    v_cvt_pk_bf16_f32 v160, v3, v4
    v_lshlrev_b32 v5, 16, v161
    v_and_b32 v6, 0xffff0000, v161
    v_fma_f32 v5, v5, v13, v14
    v_fma_f32 v6, v6, v13, v14
    v_cvt_pk_bf16_f32 v161, v5, v6
    v_lshlrev_b32 v3, 16, v162
    v_and_b32 v4, 0xffff0000, v162
    v_fma_f32 v3, v3, v13, v14
    v_fma_f32 v4, v4, v13, v14
    v_cvt_pk_bf16_f32 v162, v3, v4
    v_lshlrev_b32 v5, 16, v163
    v_and_b32 v6, 0xffff0000, v163
    v_fma_f32 v5, v5, v13, v14
    v_fma_f32 v6, v6, v13, v14
    v_cvt_pk_bf16_f32 v163, v5, v6
    v_lshlrev_b32 v3, 16, v164
    v_and_b32 v4, 0xffff0000, v164
    v_fma_f32 v3, v3, v13, v14
    v_fma_f32 v4, v4, v13, v14
    v_cvt_pk_bf16_f32 v164, v3, v4
    v_lshlrev_b32 v5, 16, v165
    v_and_b32 v6, 0xffff0000, v165
    v_fma_f32 v5, v5, v13, v14
    v_fma_f32 v6, v6, v13, v14
    v_cvt_pk_bf16_f32 v165, v5, v6
    v_lshlrev_b32 v3, 16, v166
    v_and_b32 v4, 0xffff0000, v166
    v_fma_f32 v3, v3, v13, v14
    v_fma_f32 v4, v4, v13, v14
    v_cvt_pk_bf16_f32 v166, v3, v4
    v_lshlrev_b32 v5, 16, v167
    v_and_b32 v6, 0xffff0000, v167
    v_fma_f32 v5, v5, v13, v14
    v_fma_f32 v6, v6, v13, v14
    v_cvt_pk_bf16_f32 v167, v5, v6
    v_lshlrev_b32 v3, 16, v168
    v_and_b32 v4, 0xffff0000, v168
    v_fma_f32 v3, v3, v13, v14
    v_fma_f32 v4, v4, v13, v14
    v_cvt_pk_bf16_f32 v168, v3, v4
    v_lshlrev_b32 v5, 16, v169
    v_and_b32 v6, 0xffff0000, v169
    v_fma_f32 v5, v5, v13, v14
    v_fma_f32 v6, v6, v13, v14
    v_cvt_pk_bf16_f32 v169, v5, v6
    v_lshlrev_b32 v3, 16, v170
    v_and_b32 v4, 0xffff0000, v170
    v_fma_f32 v3, v3, v13, v14
    v_fma_f32 v4, v4, v13, v14
    v_cvt_pk_bf16_f32 v170, v3, v4
    v_lshlrev_b32 v5, 16, v171
    v_and_b32 v6, 0xffff0000, v171
    v_fma_f32 v5, v5, v13, v14
    v_fma_f32 v6, v6, v13, v14
    v_cvt_pk_bf16_f32 v171, v5, v6
    v_lshlrev_b32 v3, 16, v172
    v_and_b32 v4, 0xffff0000, v172
    v_fma_f32 v3, v3, v13, v14
    v_fma_f32 v4, v4, v13, v14
    v_cvt_pk_bf16_f32 v172, v3, v4
    v_lshlrev_b32 v5, 16, v173
    v_and_b32 v6, 0xffff0000, v173
    v_fma_f32 v5, v5, v13, v14
    v_fma_f32 v6, v6, v13, v14
    v_cvt_pk_bf16_f32 v173, v5, v6
    v_lshlrev_b32 v3, 16, v174
    v_and_b32 v4, 0xffff0000, v174
    v_fma_f32 v3, v3, v13, v14
    v_fma_f32 v4, v4, v13, v14
    v_cvt_pk_bf16_f32 v174, v3, v4
    v_lshlrev_b32 v5, 16, v175
    v_and_b32 v6, 0xffff0000, v175
    v_fma_f32 v5, v5, v13, v14
    v_fma_f32 v6, v6, v13, v14
    v_cvt_pk_bf16_f32 v175, v5, v6
    v_lshlrev_b32 v3, 16, v176
    v_and_b32 v4, 0xffff0000, v176
    v_fma_f32 v3, v3, v13, v14
    v_fma_f32 v4, v4, v13, v14
    v_cvt_pk_bf16_f32 v176, v3, v4
    v_lshlrev_b32 v5, 16, v177
    v_and_b32 v6, 0xffff0000, v177
    v_fma_f32 v5, v5, v13, v14
    v_fma_f32 v6, v6, v13, v14
    v_cvt_pk_bf16_f32 v177, v5, v6
    v_lshlrev_b32 v3, 16, v178
    v_and_b32 v4, 0xffff0000, v178
    v_fma_f32 v3, v3, v13, v14
    v_fma_f32 v4, v4, v13, v14
    v_cvt_pk_bf16_f32 v178, v3, v4
    v_lshlrev_b32 v5, 16, v179
    v_and_b32 v6, 0xffff0000, v179
    v_fma_f32 v5, v5, v13, v14
    v_fma_f32 v6, v6, v13, v14
    v_cvt_pk_bf16_f32 v179, v5, v6
    v_lshlrev_b32 v3, 16, v180
    v_and_b32 v4, 0xffff0000, v180
    v_fma_f32 v3, v3, v13, v14
    v_fma_f32 v4, v4, v13, v14
    v_cvt_pk_bf16_f32 v180, v3, v4
    v_lshlrev_b32 v5, 16, v181
    v_and_b32 v6, 0xffff0000, v181
    v_fma_f32 v5, v5, v13, v14
    v_fma_f32 v6, v6, v13, v14
    v_cvt_pk_bf16_f32 v181, v5, v6
    v_lshlrev_b32 v3, 16, v182
    v_and_b32 v4, 0xffff0000, v182
    v_fma_f32 v3, v3, v13, v14
    v_fma_f32 v4, v4, v13, v14
    v_cvt_pk_bf16_f32 v182, v3, v4
    v_lshlrev_b32 v5, 16, v183
    v_and_b32 v6, 0xffff0000, v183
    v_fma_f32 v5, v5, v13, v14
    v_fma_f32 v6, v6, v13, v14
    v_cvt_pk_bf16_f32 v183, v5, v6
    v_lshlrev_b32 v3, 16, v184
    v_and_b32 v4, 0xffff0000, v184
    v_fma_f32 v3, v3, v13, v14
    v_fma_f32 v4, v4, v13, v14
    v_cvt_pk_bf16_f32 v184, v3, v4
    v_lshlrev_b32 v5, 16, v185
    v_and_b32 v6, 0xffff0000, v185
    v_fma_f32 v5, v5, v13, v14
    v_fma_f32 v6, v6, v13, v14
    v_cvt_pk_bf16_f32 v185, v5, v6
    v_lshlrev_b32 v3, 16, v186
    v_and_b32 v4, 0xffff0000, v186
    v_fma_f32 v3, v3, v13, v14
    v_fma_f32 v4, v4, v13, v14
    v_cvt_pk_bf16_f32 v186, v3, v4
    v_lshlrev_b32 v5, 16, v187
    v_and_b32 v6, 0xffff0000, v187
    v_fma_f32 v5, v5, v13, v14
    v_fma_f32 v6, v6, v13, v14
    v_cvt_pk_bf16_f32 v187, v5, v6
    v_lshlrev_b32 v3, 16, v188
    v_and_b32 v4, 0xffff0000, v188
    v_fma_f32 v3, v3, v13, v14
    v_fma_f32 v4, v4, v13, v14
    v_cvt_pk_bf16_f32 v188, v3, v4
    v_lshlrev_b32 v5, 16, v189
    v_and_b32 v6, 0xffff0000, v189
    v_fma_f32 v5, v5, v13, v14
    v_fma_f32 v6, v6, v13, v14
    v_cvt_pk_bf16_f32 v189, v5, v6
    v_lshlrev_b32 v3, 16, v190
    v_and_b32 v4, 0xffff0000, v190
    v_fma_f32 v3, v3, v13, v14
    v_fma_f32 v4, v4, v13, v14
    v_cvt_pk_bf16_f32 v190, v3, v4
    v_lshlrev_b32 v5, 16, v191
    v_and_b32 v6, 0xffff0000, v191
    v_fma_f32 v5, v5, v13, v14
    v_fma_f32 v6, v6, v13, v14
    v_cvt_pk_bf16_f32 v191, v5, v6
    v_lshlrev_b32 v3, 16, v192
    v_and_b32 v4, 0xffff0000, v192
    v_fma_f32 v3, v3, v13, v14
    v_fma_f32 v4, v4, v13, v14
    v_cvt_pk_bf16_f32 v192, v3, v4
    v_lshlrev_b32 v5, 16, v193
    v_and_b32 v6, 0xffff0000, v193
    v_fma_f32 v5, v5, v13, v14
    v_fma_f32 v6, v6, v13, v14
    v_cvt_pk_bf16_f32 v193, v5, v6
    v_lshlrev_b32 v3, 16, v194
    v_and_b32 v4, 0xffff0000, v194
    v_fma_f32 v3, v3, v13, v14
    v_fma_f32 v4, v4, v13, v14
    v_cvt_pk_bf16_f32 v194, v3, v4
    v_lshlrev_b32 v5, 16, v195
    v_and_b32 v6, 0xffff0000, v195
    v_fma_f32 v5, v5, v13, v14
    v_fma_f32 v6, v6, v13, v14
    v_cvt_pk_bf16_f32 v195, v5, v6
    v_lshlrev_b32 v3, 16, v196
    v_and_b32 v4, 0xffff0000, v196
    v_fma_f32 v3, v3, v13, v14
    v_fma_f32 v4, v4, v13, v14
    v_cvt_pk_bf16_f32 v196, v3, v4
    v_lshlrev_b32 v5, 16, v197
    v_and_b32 v6, 0xffff0000, v197
    v_fma_f32 v5, v5, v13, v14
    v_fma_f32 v6, v6, v13, v14
    v_cvt_pk_bf16_f32 v197, v5, v6
    v_lshlrev_b32 v3, 16, v198
    v_and_b32 v4, 0xffff0000, v198
    v_fma_f32 v3, v3, v13, v14
    v_fma_f32 v4, v4, v13, v14
    v_cvt_pk_bf16_f32 v198, v3, v4
    v_lshlrev_b32 v5, 16, v199
    v_and_b32 v6, 0xffff0000, v199
    v_fma_f32 v5, v5, v13, v14
    v_fma_f32 v6, v6, v13, v14
    v_cvt_pk_bf16_f32 v199, v5, v6
    v_lshlrev_b32 v3, 16, v200
    v_and_b32 v4, 0xffff0000, v200
    v_fma_f32 v3, v3, v13, v14
    v_fma_f32 v4, v4, v13, v14
    v_cvt_pk_bf16_f32 v200, v3, v4
    v_lshlrev_b32 v5, 16, v201
    v_and_b32 v6, 0xffff0000, v201
    v_fma_f32 v5, v5, v13, v14
    v_fma_f32 v6, v6, v13, v14
    v_cvt_pk_bf16_f32 v201, v5, v6
    v_lshlrev_b32 v3, 16, v202
    v_and_b32 v4, 0xffff0000, v202
    v_fma_f32 v3, v3, v13, v14
    v_fma_f32 v4, v4, v13, v14
    v_cvt_pk_bf16_f32 v202, v3, v4
    v_lshlrev_b32 v5, 16, v203
    v_and_b32 v6, 0xffff0000, v203
    v_fma_f32 v5, v5, v13, v14
    v_fma_f32 v6, v6, v13, v14
    v_cvt_pk_bf16_f32 v203, v5, v6
    v_lshlrev_b32 v3, 16, v204
    v_and_b32 v4, 0xffff0000, v204
    v_fma_f32 v3, v3, v13, v14
    v_fma_f32 v4, v4, v13, v14
    v_cvt_pk_bf16_f32 v204, v3, v4
    v_lshlrev_b32 v5, 16, v205
    v_and_b32 v6, 0xffff0000, v205
    v_fma_f32 v5, v5, v13, v14
    v_fma_f32 v6, v6, v13, v14
    v_cvt_pk_bf16_f32 v205, v5, v6
    v_lshlrev_b32 v3, 16, v206
    v_and_b32 v4, 0xffff0000, v206
    v_fma_f32 v3, v3, v13, v14
    v_fma_f32 v4, v4, v13, v14
    v_cvt_pk_bf16_f32 v206, v3, v4
    v_lshlrev_b32 v5, 16, v207
    v_and_b32 v6, 0xffff0000, v207
    v_fma_f32 v5, v5, v13, v14
    v_fma_f32 v6, v6, v13, v14
    v_cvt_pk_bf16_f32 v207, v5, v6
    v_lshlrev_b32 v3, 16, v208
    v_and_b32 v4, 0xffff0000, v208
    v_fma_f32 v3, v3, v13, v14
    v_fma_f32 v4, v4, v13, v14
    v_cvt_pk_bf16_f32 v208, v3, v4
    v_lshlrev_b32 v5, 16, v209
    v_and_b32 v6, 0xffff0000, v209
    v_fma_f32 v5, v5, v13, v14
    v_fma_f32 v6, v6, v13, v14
    v_cvt_pk_bf16_f32 v209, v5, v6
    v_lshlrev_b32 v3, 16, v210
    v_and_b32 v4, 0xffff0000, v210
    v_fma_f32 v3, v3, v13, v14
    v_fma_f32 v4, v4, v13, v14
    v_cvt_pk_bf16_f32 v210, v3, v4
    v_lshlrev_b32 v5, 16, v211
    v_and_b32 v6, 0xffff0000, v211
    v_fma_f32 v5, v5, v13, v14
    v_fma_f32 v6, v6, v13, v14
    v_cvt_pk_bf16_f32 v211, v5, v6
    v_lshlrev_b32 v3, 16, v212
    v_and_b32 v4, 0xffff0000, v212
    v_fma_f32 v3, v3, v13, v14
    v_fma_f32 v4, v4, v13, v14
    v_cvt_pk_bf16_f32 v212, v3, v4
    v_lshlrev_b32 v5, 16, v213
    v_and_b32 v6, 0xffff0000, v213
    v_fma_f32 v5, v5, v13, v14
    v_fma_f32 v6, v6, v13, v14
    v_cvt_pk_bf16_f32 v213, v5, v6
    v_lshlrev_b32 v3, 16, v214
    v_and_b32 v4, 0xffff0000, v214
    v_fma_f32 v3, v3, v13, v14
    v_fma_f32 v4, v4, v13, v14
    v_cvt_pk_bf16_f32 v214, v3, v4
    v_lshlrev_b32 v5, 16, v215
    v_and_b32 v6, 0xffff0000, v215
    v_fma_f32 v5, v5, v13, v14
    v_fma_f32 v6, v6, v13, v14
    v_cvt_pk_bf16_f32 v215, v5, v6
    s_mov_b64 s[68:69], exec
    s_mov_b32 exec_hi, 0xfffffff
    s_add_u32 m0, s65, 26880
    s_add_u32 s70, s67, 204800
    buffer_load_dwordx4 v25, s[12:15], s70 offen lds
    s_add_u32 m0, s65, 30720
    s_add_u32 s70, s67, 235520
    buffer_load_dwordx4 v25, s[12:15], s70 offen lds
    s_add_u32 m0, s65, 34560
    s_add_u32 s70, s67, 266240
    buffer_load_dwordx4 v25, s[12:15], s70 offen lds
    s_add_u32 m0, s65, 38400
    s_add_u32 s70, s67, 296960
    buffer_load_dwordx4 v25, s[12:15], s70 offen lds
    s_add_u32 m0, s65, 42240
    s_add_u32 s70, s67, 327680
    buffer_load_dwordx4 v25, s[12:15], s70 offen lds
    s_add_u32 m0, s65, 46080
    s_add_u32 s70, s67, 358400
    buffer_load_dwordx4 v25, s[12:15], s70 offen lds
    s_add_u32 m0, s65, 49920
    s_add_u32 s70, s67, 389120
    buffer_load_dwordx4 v25, s[12:15], s70 offen lds
    s_mov_b64 exec, s[68:69]
    s_waitcnt vmcnt(7)
    s_barrier
    v_add_u32 v22, 0, v23
    ds_read_b64_tr_b16 v[64:65], v22 offset:0
    ds_read_b64_tr_b16 v[66:67], v22 offset:640
    ds_read_b64_tr_b16 v[68:69], v22 offset:32
    ds_read_b64_tr_b16 v[70:71], v22 offset:672
    ds_read_b64_tr_b16 v[72:73], v22 offset:64
    ds_read_b64_tr_b16 v[74:75], v22 offset:704
    ds_read_b64_tr_b16 v[76:77], v22 offset:96
    ds_read_b64_tr_b16 v[78:79], v22 offset:736
    ds_read_b64_tr_b16 v[80:81], v22 offset:128
    ds_read_b64_tr_b16 v[82:83], v22 offset:768
    v_add_u32 v22, 5120, v23
    ds_read_b64_tr_b16 v[100:101], v22 offset:0
    ds_read_b64_tr_b16 v[102:103], v22 offset:640
    ds_read_b64_tr_b16 v[104:105], v22 offset:32
    ds_read_b64_tr_b16 v[106:107], v22 offset:672
    ds_read_b64_tr_b16 v[108:109], v22 offset:64
    ds_read_b64_tr_b16 v[110:111], v22 offset:704
    ds_read_b64_tr_b16 v[112:113], v22 offset:96
    ds_read_b64_tr_b16 v[114:115], v22 offset:736
    ds_read_b64_tr_b16 v[116:117], v22 offset:128
    ds_read_b64_tr_b16 v[118:119], v22 offset:768
    s_waitcnt lgkmcnt(10)
    v_mfma_f32_16x16x32_bf16 v[28:31], v[64:67], v[136:139], v[28:31]
    v_mfma_f32_16x16x32_bf16 v[32:35], v[68:71], v[136:139], v[32:35]
    v_mfma_f32_16x16x32_bf16 v[36:39], v[72:75], v[136:139], v[36:39]
    v_mfma_f32_16x16x32_bf16 v[40:43], v[76:79], v[136:139], v[40:43]
    v_mfma_f32_16x16x32_bf16 v[44:47], v[80:83], v[136:139], v[44:47]
    v_add_u32 v22, 10240, v23
    ds_read_b64_tr_b16 v[64:65], v22 offset:0
    ds_read_b64_tr_b16 v[66:67], v22 offset:640
    ds_read_b64_tr_b16 v[68:69], v22 offset:32
    ds_read_b64_tr_b16 v[70:71], v22 offset:672
    ds_read_b64_tr_b16 v[72:73], v22 offset:64
    ds_read_b64_tr_b16 v[74:75], v22 offset:704
    ds_read_b64_tr_b16 v[76:77], v22 offset:96
    ds_read_b64_tr_b16 v[78:79], v22 offset:736
    ds_read_b64_tr_b16 v[80:81], v22 offset:128
    ds_read_b64_tr_b16 v[82:83], v22 offset:768
    s_waitcnt lgkmcnt(10)
    v_mfma_f32_16x16x32_bf16 v[28:31], v[100:103], v[140:143], v[28:31]
    v_mfma_f32_16x16x32_bf16 v[32:35], v[104:107], v[140:143], v[32:35]
    v_mfma_f32_16x16x32_bf16 v[36:39], v[108:111], v[140:143], v[36:39]
    v_mfma_f32_16x16x32_bf16 v[40:43], v[112:115], v[140:143], v[40:43]
    v_mfma_f32_16x16x32_bf16 v[44:47], v[116:119], v[140:143], v[44:47]
    v_add_u32 v22, 15360, v23
    ds_read_b64_tr_b16 v[100:101], v22 offset:0
    ds_read_b64_tr_b16 v[102:103], v22 offset:640
    ds_read_b64_tr_b16 v[104:105], v22 offset:32
    ds_read_b64_tr_b16 v[106:107], v22 offset:672
    ds_read_b64_tr_b16 v[108:109], v22 offset:64
    ds_read_b64_tr_b16 v[110:111], v22 offset:704
    ds_read_b64_tr_b16 v[112:113], v22 offset:96
    ds_read_b64_tr_b16 v[114:115], v22 offset:736
    ds_read_b64_tr_b16 v[116:117], v22 offset:128
    ds_read_b64_tr_b16 v[118:119], v22 offset:768
    s_waitcnt lgkmcnt(10)
    v_mfma_f32_16x16x32_bf16 v[28:31], v[64:67], v[144:147], v[28:31]
    v_mfma_f32_16x16x32_bf16 v[32:35], v[68:71], v[144:147], v[32:35]
    v_mfma_f32_16x16x32_bf16 v[36:39], v[72:75], v[144:147], v[36:39]
    v_mfma_f32_16x16x32_bf16 v[40:43], v[76:79], v[144:147], v[40:43]
    v_mfma_f32_16x16x32_bf16 v[44:47], v[80:83], v[144:147], v[44:47]
    v_add_u32 v22, 20480, v23
    ds_read_b64_tr_b16 v[64:65], v22 offset:0
    ds_read_b64_tr_b16 v[66:67], v22 offset:640
    ds_read_b64_tr_b16 v[68:69], v22 offset:32
    ds_read_b64_tr_b16 v[70:71], v22 offset:672
    ds_read_b64_tr_b16 v[72:73], v22 offset:64
    ds_read_b64_tr_b16 v[74:75], v22 offset:704
    ds_read_b64_tr_b16 v[76:77], v22 offset:96
    ds_read_b64_tr_b16 v[78:79], v22 offset:736
    ds_read_b64_tr_b16 v[80:81], v22 offset:128
    ds_read_b64_tr_b16 v[82:83], v22 offset:768
    s_waitcnt lgkmcnt(10)
    v_mfma_f32_16x16x32_bf16 v[28:31], v[100:103], v[148:151], v[28:31]
    v_mfma_f32_16x16x32_bf16 v[32:35], v[104:107], v[148:151], v[32:35]
    v_mfma_f32_16x16x32_bf16 v[36:39], v[108:111], v[148:151], v[36:39]
    v_mfma_f32_16x16x32_bf16 v[40:43], v[112:115], v[148:151], v[40:43]
    v_mfma_f32_16x16x32_bf16 v[44:47], v[116:119], v[148:151], v[44:47]
    s_waitcnt lgkmcnt(0)
    v_mfma_f32_16x16x32_bf16 v[28:31], v[64:67], v[152:155], v[28:31]
    v_mfma_f32_16x16x32_bf16 v[32:35], v[68:71], v[152:155], v[32:35]
    v_mfma_f32_16x16x32_bf16 v[36:39], v[72:75], v[152:155], v[36:39]
    v_mfma_f32_16x16x32_bf16 v[40:43], v[76:79], v[152:155], v[40:43]
    v_mfma_f32_16x16x32_bf16 v[44:47], v[80:83], v[152:155], v[44:47]
    s_barrier
    s_mov_b64 s[68:69], exec
    s_mov_b32 exec_hi, 0xfffffff
    s_add_u32 m0, s65, 0
    s_add_u32 s70, s67, 409600
    buffer_load_dwordx4 v25, s[12:15], s70 offen lds
    s_add_u32 m0, s65, 3840
    s_add_u32 s70, s67, 440320
    buffer_load_dwordx4 v25, s[12:15], s70 offen lds
    s_add_u32 m0, s65, 7680
    s_add_u32 s70, s67, 471040
    buffer_load_dwordx4 v25, s[12:15], s70 offen lds
    s_add_u32 m0, s65, 11520
    s_add_u32 s70, s67, 501760
    buffer_load_dwordx4 v25, s[12:15], s70 offen lds
    s_add_u32 m0, s65, 15360
    s_add_u32 s70, s67, 532480
    buffer_load_dwordx4 v25, s[12:15], s70 offen lds
    s_add_u32 m0, s65, 19200
    s_add_u32 s70, s67, 563200
    buffer_load_dwordx4 v25, s[12:15], s70 offen lds
    s_add_u32 m0, s65, 23040
    s_add_u32 s70, s67, 593920
    buffer_load_dwordx4 v25, s[12:15], s70 offen lds
    s_mov_b64 exec, s[68:69]
    s_waitcnt vmcnt(7)
    s_barrier
    v_add_u32 v22, 26880, v23
    ds_read_b64_tr_b16 v[64:65], v22 offset:0
    ds_read_b64_tr_b16 v[66:67], v22 offset:640
    ds_read_b64_tr_b16 v[68:69], v22 offset:32
    ds_read_b64_tr_b16 v[70:71], v22 offset:672
    ds_read_b64_tr_b16 v[72:73], v22 offset:64
    ds_read_b64_tr_b16 v[74:75], v22 offset:704
    ds_read_b64_tr_b16 v[76:77], v22 offset:96
    ds_read_b64_tr_b16 v[78:79], v22 offset:736
    ds_read_b64_tr_b16 v[80:81], v22 offset:128
    ds_read_b64_tr_b16 v[82:83], v22 offset:768
    v_add_u32 v22, 32000, v23
    ds_read_b64_tr_b16 v[100:101], v22 offset:0
    ds_read_b64_tr_b16 v[102:103], v22 offset:640
    ds_read_b64_tr_b16 v[104:105], v22 offset:32
    ds_read_b64_tr_b16 v[106:107], v22 offset:672
    ds_read_b64_tr_b16 v[108:109], v22 offset:64
    ds_read_b64_tr_b16 v[110:111], v22 offset:704
    ds_read_b64_tr_b16 v[112:113], v22 offset:96
    ds_read_b64_tr_b16 v[114:115], v22 offset:736
    ds_read_b64_tr_b16 v[116:117], v22 offset:128
    ds_read_b64_tr_b16 v[118:119], v22 offset:768
    s_waitcnt lgkmcnt(10)
    v_mfma_f32_16x16x32_bf16 v[28:31], v[64:67], v[156:159], v[28:31]
    v_mfma_f32_16x16x32_bf16 v[32:35], v[68:71], v[156:159], v[32:35]
    v_mfma_f32_16x16x32_bf16 v[36:39], v[72:75], v[156:159], v[36:39]
    v_mfma_f32_16x16x32_bf16 v[40:43], v[76:79], v[156:159], v[40:43]
    v_mfma_f32_16x16x32_bf16 v[44:47], v[80:83], v[156:159], v[44:47]
    v_add_u32 v22, 37120, v23
    ds_read_b64_tr_b16 v[64:65], v22 offset:0
    ds_read_b64_tr_b16 v[66:67], v22 offset:640
    ds_read_b64_tr_b16 v[68:69], v22 offset:32
    ds_read_b64_tr_b16 v[70:71], v22 offset:672
    ds_read_b64_tr_b16 v[72:73], v22 offset:64
    ds_read_b64_tr_b16 v[74:75], v22 offset:704
    ds_read_b64_tr_b16 v[76:77], v22 offset:96
    ds_read_b64_tr_b16 v[78:79], v22 offset:736
    ds_read_b64_tr_b16 v[80:81], v22 offset:128
    ds_read_b64_tr_b16 v[82:83], v22 offset:768
    s_waitcnt lgkmcnt(10)
    v_mfma_f32_16x16x32_bf16 v[28:31], v[100:103], v[160:163], v[28:31]
    v_mfma_f32_16x16x32_bf16 v[32:35], v[104:107], v[160:163], v[32:35]
    v_mfma_f32_16x16x32_bf16 v[36:39], v[108:111], v[160:163], v[36:39]
    v_mfma_f32_16x16x32_bf16 v[40:43], v[112:115], v[160:163], v[40:43]
    v_mfma_f32_16x16x32_bf16 v[44:47], v[116:119], v[160:163], v[44:47]
    v_add_u32 v22, 42240, v23
    ds_read_b64_tr_b16 v[100:101], v22 offset:0
    ds_read_b64_tr_b16 v[102:103], v22 offset:640
    ds_read_b64_tr_b16 v[104:105], v22 offset:32
    ds_read_b64_tr_b16 v[106:107], v22 offset:672
    ds_read_b64_tr_b16 v[108:109], v22 offset:64
    ds_read_b64_tr_b16 v[110:111], v22 offset:704
    ds_read_b64_tr_b16 v[112:113], v22 offset:96
    ds_read_b64_tr_b16 v[114:115], v22 offset:736
    ds_read_b64_tr_b16 v[116:117], v22 offset:128
    ds_read_b64_tr_b16 v[118:119], v22 offset:768
    s_waitcnt lgkmcnt(10)
    v_mfma_f32_16x16x32_bf16 v[28:31], v[64:67], v[164:167], v[28:31]
    v_mfma_f32_16x16x32_bf16 v[32:35], v[68:71], v[164:167], v[32:35]
    v_mfma_f32_16x16x32_bf16 v[36:39], v[72:75], v[164:167], v[36:39]
    v_mfma_f32_16x16x32_bf16 v[40:43], v[76:79], v[164:167], v[40:43]
    v_mfma_f32_16x16x32_bf16 v[44:47], v[80:83], v[164:167], v[44:47]
    v_add_u32 v22, 47360, v23
    ds_read_b64_tr_b16 v[64:65], v22 offset:0
    ds_read_b64_tr_b16 v[66:67], v22 offset:640
    ds_read_b64_tr_b16 v[68:69], v22 offset:32
    ds_read_b64_tr_b16 v[70:71], v22 offset:672
    ds_read_b64_tr_b16 v[72:73], v22 offset:64
    ds_read_b64_tr_b16 v[74:75], v22 offset:704
    ds_read_b64_tr_b16 v[76:77], v22 offset:96
    ds_read_b64_tr_b16 v[78:79], v22 offset:736
    ds_read_b64_tr_b16 v[80:81], v22 offset:128
    ds_read_b64_tr_b16 v[82:83], v22 offset:768
    s_waitcnt lgkmcnt(10)
    v_mfma_f32_16x16x32_bf16 v[28:31], v[100:103], v[168:171], v[28:31]
    v_mfma_f32_16x16x32_bf16 v[32:35], v[104:107], v[168:171], v[32:35]
    v_mfma_f32_16x16x32_bf16 v[36:39], v[108:111], v[168:171], v[36:39]
    v_mfma_f32_16x16x32_bf16 v[40:43], v[112:115], v[168:171], v[40:43]
    v_mfma_f32_16x16x32_bf16 v[44:47], v[116:119], v[168:171], v[44:47]
    s_waitcnt lgkmcnt(0)
    v_mfma_f32_16x16x32_bf16 v[28:31], v[64:67], v[172:175], v[28:31]
    v_mfma_f32_16x16x32_bf16 v[32:35], v[68:71], v[172:175], v[32:35]
    v_mfma_f32_16x16x32_bf16 v[36:39], v[72:75], v[172:175], v[36:39]
    v_mfma_f32_16x16x32_bf16 v[40:43], v[76:79], v[172:175], v[40:43]
    v_mfma_f32_16x16x32_bf16 v[44:47], v[80:83], v[172:175], v[44:47]
    s_barrier
    s_mov_b64 s[68:69], exec
    s_mov_b32 exec_hi, 0xfffffff
    s_add_u32 m0, s65, 26880
    s_add_u32 s70, s67, 614400
    buffer_load_dwordx4 v25, s[12:15], s70 offen lds
    s_add_u32 m0, s65, 30720
    s_add_u32 s70, s67, 645120
    buffer_load_dwordx4 v25, s[12:15], s70 offen lds
    s_add_u32 m0, s65, 34560
    s_add_u32 s70, s67, 675840
    buffer_load_dwordx4 v25, s[12:15], s70 offen lds
    s_add_u32 m0, s65, 38400
    s_add_u32 s70, s67, 706560
    buffer_load_dwordx4 v25, s[12:15], s70 offen lds
    s_add_u32 m0, s65, 42240
    s_add_u32 s70, s67, 737280
    buffer_load_dwordx4 v25, s[12:15], s70 offen lds
    s_add_u32 m0, s65, 46080
    s_add_u32 s70, s67, 768000
    buffer_load_dwordx4 v25, s[12:15], s70 offen lds
    s_add_u32 m0, s65, 49920
    s_add_u32 s70, s67, 798720
    buffer_load_dwordx4 v25, s[12:15], s70 offen lds
    s_mov_b64 exec, s[68:69]
    s_waitcnt vmcnt(7)
    s_barrier
    v_add_u32 v22, 0, v23
    ds_read_b64_tr_b16 v[64:65], v22 offset:0
    ds_read_b64_tr_b16 v[66:67], v22 offset:640
    ds_read_b64_tr_b16 v[68:69], v22 offset:32
    ds_read_b64_tr_b16 v[70:71], v22 offset:672
    ds_read_b64_tr_b16 v[72:73], v22 offset:64
    ds_read_b64_tr_b16 v[74:75], v22 offset:704
    ds_read_b64_tr_b16 v[76:77], v22 offset:96
    ds_read_b64_tr_b16 v[78:79], v22 offset:736
    ds_read_b64_tr_b16 v[80:81], v22 offset:128
    ds_read_b64_tr_b16 v[82:83], v22 offset:768
    v_add_u32 v22, 5120, v23
    ds_read_b64_tr_b16 v[100:101], v22 offset:0
    ds_read_b64_tr_b16 v[102:103], v22 offset:640
    ds_read_b64_tr_b16 v[104:105], v22 offset:32
    ds_read_b64_tr_b16 v[106:107], v22 offset:672
    ds_read_b64_tr_b16 v[108:109], v22 offset:64
    ds_read_b64_tr_b16 v[110:111], v22 offset:704
    ds_read_b64_tr_b16 v[112:113], v22 offset:96
    ds_read_b64_tr_b16 v[114:115], v22 offset:736
    ds_read_b64_tr_b16 v[116:117], v22 offset:128
    ds_read_b64_tr_b16 v[118:119], v22 offset:768
    s_waitcnt lgkmcnt(10)
    v_mfma_f32_16x16x32_bf16 v[28:31], v[64:67], v[176:179], v[28:31]
    v_mfma_f32_16x16x32_bf16 v[32:35], v[68:71], v[176:179], v[32:35]
    v_mfma_f32_16x16x32_bf16 v[36:39], v[72:75], v[176:179], v[36:39]
    v_mfma_f32_16x16x32_bf16 v[40:43], v[76:79], v[176:179], v[40:43]
    v_mfma_f32_16x16x32_bf16 v[44:47], v[80:83], v[176:179], v[44:47]
    v_add_u32 v22, 10240, v23
    ds_read_b64_tr_b16 v[64:65], v22 offset:0
    ds_read_b64_tr_b16 v[66:67], v22 offset:640
    ds_read_b64_tr_b16 v[68:69], v22 offset:32
    ds_read_b64_tr_b16 v[70:71], v22 offset:672
    ds_read_b64_tr_b16 v[72:73], v22 offset:64
    ds_read_b64_tr_b16 v[74:75], v22 offset:704
    ds_read_b64_tr_b16 v[76:77], v22 offset:96
    ds_read_b64_tr_b16 v[78:79], v22 offset:736
    ds_read_b64_tr_b16 v[80:81], v22 offset:128
    ds_read_b64_tr_b16 v[82:83], v22 offset:768
    s_waitcnt lgkmcnt(10)
    v_mfma_f32_16x16x32_bf16 v[28:31], v[100:103], v[180:183], v[28:31]
    v_mfma_f32_16x16x32_bf16 v[32:35], v[104:107], v[180:183], v[32:35]
    v_mfma_f32_16x16x32_bf16 v[36:39], v[108:111], v[180:183], v[36:39]
    v_mfma_f32_16x16x32_bf16 v[40:43], v[112:115], v[180:183], v[40:43]
    v_mfma_f32_16x16x32_bf16 v[44:47], v[116:119], v[180:183], v[44:47]
    v_add_u32 v22, 15360, v23
    ds_read_b64_tr_b16 v[100:101], v22 offset:0
    ds_read_b64_tr_b16 v[102:103], v22 offset:640
    ds_read_b64_tr_b16 v[104:105], v22 offset:32
    ds_read_b64_tr_b16 v[106:107], v22 offset:672
    ds_read_b64_tr_b16 v[108:109], v22 offset:64
    ds_read_b64_tr_b16 v[110:111], v22 offset:704
    ds_read_b64_tr_b16 v[112:113], v22 offset:96
    ds_read_b64_tr_b16 v[114:115], v22 offset:736
    ds_read_b64_tr_b16 v[116:117], v22 offset:128
    ds_read_b64_tr_b16 v[118:119], v22 offset:768
    s_waitcnt lgkmcnt(10)
    v_mfma_f32_16x16x32_bf16 v[28:31], v[64:67], v[184:187], v[28:31]
    v_mfma_f32_16x16x32_bf16 v[32:35], v[68:71], v[184:187], v[32:35]
    v_mfma_f32_16x16x32_bf16 v[36:39], v[72:75], v[184:187], v[36:39]
    v_mfma_f32_16x16x32_bf16 v[40:43], v[76:79], v[184:187], v[40:43]
    v_mfma_f32_16x16x32_bf16 v[44:47], v[80:83], v[184:187], v[44:47]
    v_add_u32 v22, 20480, v23
    ds_read_b64_tr_b16 v[64:65], v22 offset:0
    ds_read_b64_tr_b16 v[66:67], v22 offset:640
    ds_read_b64_tr_b16 v[68:69], v22 offset:32
    ds_read_b64_tr_b16 v[70:71], v22 offset:672
    ds_read_b64_tr_b16 v[72:73], v22 offset:64
    ds_read_b64_tr_b16 v[74:75], v22 offset:704
    ds_read_b64_tr_b16 v[76:77], v22 offset:96
    ds_read_b64_tr_b16 v[78:79], v22 offset:736
    ds_read_b64_tr_b16 v[80:81], v22 offset:128
    ds_read_b64_tr_b16 v[82:83], v22 offset:768
    s_waitcnt lgkmcnt(10)
    v_mfma_f32_16x16x32_bf16 v[28:31], v[100:103], v[188:191], v[28:31]
    v_mfma_f32_16x16x32_bf16 v[32:35], v[104:107], v[188:191], v[32:35]
    v_mfma_f32_16x16x32_bf16 v[36:39], v[108:111], v[188:191], v[36:39]
    v_mfma_f32_16x16x32_bf16 v[40:43], v[112:115], v[188:191], v[40:43]
    v_mfma_f32_16x16x32_bf16 v[44:47], v[116:119], v[188:191], v[44:47]
    s_waitcnt lgkmcnt(0)
    v_mfma_f32_16x16x32_bf16 v[28:31], v[64:67], v[192:195], v[28:31]
    v_mfma_f32_16x16x32_bf16 v[32:35], v[68:71], v[192:195], v[32:35]
    v_mfma_f32_16x16x32_bf16 v[36:39], v[72:75], v[192:195], v[36:39]
    v_mfma_f32_16x16x32_bf16 v[40:43], v[76:79], v[192:195], v[40:43]
    v_mfma_f32_16x16x32_bf16 v[44:47], v[80:83], v[192:195], v[44:47]
    s_waitcnt vmcnt(0)
    s_barrier
    v_add_u32 v22, 26880, v23
    ds_read_b64_tr_b16 v[64:65], v22 offset:0
    ds_read_b64_tr_b16 v[66:67], v22 offset:640
    ds_read_b64_tr_b16 v[68:69], v22 offset:32
    ds_read_b64_tr_b16 v[70:71], v22 offset:672
    ds_read_b64_tr_b16 v[72:73], v22 offset:64
    ds_read_b64_tr_b16 v[74:75], v22 offset:704
    ds_read_b64_tr_b16 v[76:77], v22 offset:96
    ds_read_b64_tr_b16 v[78:79], v22 offset:736
    ds_read_b64_tr_b16 v[80:81], v22 offset:128
    ds_read_b64_tr_b16 v[82:83], v22 offset:768
    v_add_u32 v22, 32000, v23
    ds_read_b64_tr_b16 v[100:101], v22 offset:0
    ds_read_b64_tr_b16 v[102:103], v22 offset:640
    ds_read_b64_tr_b16 v[104:105], v22 offset:32
    ds_read_b64_tr_b16 v[106:107], v22 offset:672
    ds_read_b64_tr_b16 v[108:109], v22 offset:64
    ds_read_b64_tr_b16 v[110:111], v22 offset:704
    ds_read_b64_tr_b16 v[112:113], v22 offset:96
    ds_read_b64_tr_b16 v[114:115], v22 offset:736
    ds_read_b64_tr_b16 v[116:117], v22 offset:128
    ds_read_b64_tr_b16 v[118:119], v22 offset:768
    s_waitcnt lgkmcnt(10)
    v_mfma_f32_16x16x32_bf16 v[28:31], v[64:67], v[196:199], v[28:31]
    v_mfma_f32_16x16x32_bf16 v[32:35], v[68:71], v[196:199], v[32:35]
    v_mfma_f32_16x16x32_bf16 v[36:39], v[72:75], v[196:199], v[36:39]
    v_mfma_f32_16x16x32_bf16 v[40:43], v[76:79], v[196:199], v[40:43]
    v_mfma_f32_16x16x32_bf16 v[44:47], v[80:83], v[196:199], v[44:47]
    v_add_u32 v22, 37120, v23
    ds_read_b64_tr_b16 v[64:65], v22 offset:0
    ds_read_b64_tr_b16 v[66:67], v22 offset:640
    ds_read_b64_tr_b16 v[68:69], v22 offset:32
    ds_read_b64_tr_b16 v[70:71], v22 offset:672
    ds_read_b64_tr_b16 v[72:73], v22 offset:64
    ds_read_b64_tr_b16 v[74:75], v22 offset:704
    ds_read_b64_tr_b16 v[76:77], v22 offset:96
    ds_read_b64_tr_b16 v[78:79], v22 offset:736
    ds_read_b64_tr_b16 v[80:81], v22 offset:128
    ds_read_b64_tr_b16 v[82:83], v22 offset:768
    s_waitcnt lgkmcnt(10)
    v_mfma_f32_16x16x32_bf16 v[28:31], v[100:103], v[200:203], v[28:31]
    v_mfma_f32_16x16x32_bf16 v[32:35], v[104:107], v[200:203], v[32:35]
    v_mfma_f32_16x16x32_bf16 v[36:39], v[108:111], v[200:203], v[36:39]
    v_mfma_f32_16x16x32_bf16 v[40:43], v[112:115], v[200:203], v[40:43]
    v_mfma_f32_16x16x32_bf16 v[44:47], v[116:119], v[200:203], v[44:47]
    v_add_u32 v22, 42240, v23
    ds_read_b64_tr_b16 v[100:101], v22 offset:0
    ds_read_b64_tr_b16 v[102:103], v22 offset:640
    ds_read_b64_tr_b16 v[104:105], v22 offset:32
    ds_read_b64_tr_b16 v[106:107], v22 offset:672
    ds_read_b64_tr_b16 v[108:109], v22 offset:64
    ds_read_b64_tr_b16 v[110:111], v22 offset:704
    ds_read_b64_tr_b16 v[112:113], v22 offset:96
    ds_read_b64_tr_b16 v[114:115], v22 offset:736
    ds_read_b64_tr_b16 v[116:117], v22 offset:128
    ds_read_b64_tr_b16 v[118:119], v22 offset:768
    s_waitcnt lgkmcnt(10)
    v_mfma_f32_16x16x32_bf16 v[28:31], v[64:67], v[204:207], v[28:31]
    v_mfma_f32_16x16x32_bf16 v[32:35], v[68:71], v[204:207], v[32:35]
    v_mfma_f32_16x16x32_bf16 v[36:39], v[72:75], v[204:207], v[36:39]
    v_mfma_f32_16x16x32_bf16 v[40:43], v[76:79], v[204:207], v[40:43]
    v_mfma_f32_16x16x32_bf16 v[44:47], v[80:83], v[204:207], v[44:47]
    v_add_u32 v22, 47360, v23
    ds_read_b64_tr_b16 v[64:65], v22 offset:0
    ds_read_b64_tr_b16 v[66:67], v22 offset:640
    ds_read_b64_tr_b16 v[68:69], v22 offset:32
    ds_read_b64_tr_b16 v[70:71], v22 offset:672
    ds_read_b64_tr_b16 v[72:73], v22 offset:64
    ds_read_b64_tr_b16 v[74:75], v22 offset:704
    ds_read_b64_tr_b16 v[76:77], v22 offset:96
    ds_read_b64_tr_b16 v[78:79], v22 offset:736
    ds_read_b64_tr_b16 v[80:81], v22 offset:128
    ds_read_b64_tr_b16 v[82:83], v22 offset:768
    s_waitcnt lgkmcnt(10)
    v_mfma_f32_16x16x32_bf16 v[28:31], v[100:103], v[208:211], v[28:31]
    v_mfma_f32_16x16x32_bf16 v[32:35], v[104:107], v[208:211], v[32:35]
    v_mfma_f32_16x16x32_bf16 v[36:39], v[108:111], v[208:211], v[36:39]
    v_mfma_f32_16x16x32_bf16 v[40:43], v[112:115], v[208:211], v[40:43]
    v_mfma_f32_16x16x32_bf16 v[44:47], v[116:119], v[208:211], v[44:47]
    s_waitcnt lgkmcnt(0)
    v_mfma_f32_16x16x32_bf16 v[28:31], v[64:67], v[212:215], v[28:31]
    v_mfma_f32_16x16x32_bf16 v[32:35], v[68:71], v[212:215], v[32:35]
    v_mfma_f32_16x16x32_bf16 v[36:39], v[72:75], v[212:215], v[36:39]
    v_mfma_f32_16x16x32_bf16 v[40:43], v[76:79], v[212:215], v[40:43]
    v_mfma_f32_16x16x32_bf16 v[44:47], v[80:83], v[212:215], v[44:47]
    s_nop 15
    s_mov_b32 s6, 0xc0135761
    s_mov_b32 s7, 0xbdd2d3e8
    v_mul_f32 v3, v28, v28
    v_mov_b32 v5, s6
    v_fma_f32 v3, v3, s7, v5
    v_mul_f32 v3, v3, v28
    v_exp_f32 v3, v3
    s_nop 0
    v_add_f32 v3, 1.0, v3
    v_rcp_f32 v3, v3
    s_nop 0
    v_mul_f32 v28, v28, v3
    v_mul_f32 v3, v29, v29
    v_mov_b32 v5, s6
    v_fma_f32 v3, v3, s7, v5
    v_mul_f32 v3, v3, v29
    v_exp_f32 v3, v3
    s_nop 0
    v_add_f32 v3, 1.0, v3
    v_rcp_f32 v3, v3
    s_nop 0
    v_mul_f32 v29, v29, v3
    v_mul_f32 v3, v30, v30
    v_mov_b32 v5, s6
    v_fma_f32 v3, v3, s7, v5
    v_mul_f32 v3, v3, v30
    v_exp_f32 v3, v3
    s_nop 0
    v_add_f32 v3, 1.0, v3
    v_rcp_f32 v3, v3
    s_nop 0
    v_mul_f32 v30, v30, v3
    v_mul_f32 v3, v31, v31
    v_mov_b32 v5, s6
    v_fma_f32 v3, v3, s7, v5
    v_mul_f32 v3, v3, v31
    v_exp_f32 v3, v3
    s_nop 0
    v_add_f32 v3, 1.0, v3
    v_rcp_f32 v3, v3
    s_nop 0
    v_mul_f32 v31, v31, v3
    v_cvt_pk_bf16_f32 v26, v28, v29
    v_cvt_pk_bf16_f32 v27, v30, v31
    buffer_store_dwordx2 v[26:27], v24, s[16:19], 0 offen offset:0
    s_nop 0
    v_mul_f32 v3, v32, v32
    v_mov_b32 v5, s6
    v_fma_f32 v3, v3, s7, v5
    v_mul_f32 v3, v3, v32
    v_exp_f32 v3, v3
    s_nop 0
    v_add_f32 v3, 1.0, v3
    v_rcp_f32 v3, v3
    s_nop 0
    v_mul_f32 v32, v32, v3
    v_mul_f32 v3, v33, v33
    v_mov_b32 v5, s6
    v_fma_f32 v3, v3, s7, v5
    v_mul_f32 v3, v3, v33
    v_exp_f32 v3, v3
    s_nop 0
    v_add_f32 v3, 1.0, v3
    v_rcp_f32 v3, v3
    s_nop 0
    v_mul_f32 v33, v33, v3
    v_mul_f32 v3, v34, v34
    v_mov_b32 v5, s6
    v_fma_f32 v3, v3, s7, v5
    v_mul_f32 v3, v3, v34
    v_exp_f32 v3, v3
    s_nop 0
    v_add_f32 v3, 1.0, v3
    v_rcp_f32 v3, v3
    s_nop 0
    v_mul_f32 v34, v34, v3
    v_mul_f32 v3, v35, v35
    v_mov_b32 v5, s6
    v_fma_f32 v3, v3, s7, v5
    v_mul_f32 v3, v3, v35
    v_exp_f32 v3, v3
    s_nop 0
    v_add_f32 v3, 1.0, v3
    v_rcp_f32 v3, v3
    s_nop 0
    v_mul_f32 v35, v35, v3
    v_cvt_pk_bf16_f32 v26, v32, v33
    v_cvt_pk_bf16_f32 v27, v34, v35
    buffer_store_dwordx2 v[26:27], v24, s[16:19], 0 offen offset:32
    s_nop 0
    v_mul_f32 v3, v36, v36
    v_mov_b32 v5, s6
    v_fma_f32 v3, v3, s7, v5
    v_mul_f32 v3, v3, v36
    v_exp_f32 v3, v3
    s_nop 0
    v_add_f32 v3, 1.0, v3
    v_rcp_f32 v3, v3
    s_nop 0
    v_mul_f32 v36, v36, v3
    v_mul_f32 v3, v37, v37
    v_mov_b32 v5, s6
    v_fma_f32 v3, v3, s7, v5
    v_mul_f32 v3, v3, v37
    v_exp_f32 v3, v3
    s_nop 0
    v_add_f32 v3, 1.0, v3
    v_rcp_f32 v3, v3
    s_nop 0
    v_mul_f32 v37, v37, v3
    v_mul_f32 v3, v38, v38
    v_mov_b32 v5, s6
    v_fma_f32 v3, v3, s7, v5
    v_mul_f32 v3, v3, v38
    v_exp_f32 v3, v3
    s_nop 0
    v_add_f32 v3, 1.0, v3
    v_rcp_f32 v3, v3
    s_nop 0
    v_mul_f32 v38, v38, v3
    v_mul_f32 v3, v39, v39
    v_mov_b32 v5, s6
    v_fma_f32 v3, v3, s7, v5
    v_mul_f32 v3, v3, v39
    v_exp_f32 v3, v3
    s_nop 0
    v_add_f32 v3, 1.0, v3
    v_rcp_f32 v3, v3
    s_nop 0
    v_mul_f32 v39, v39, v3
    v_cvt_pk_bf16_f32 v26, v36, v37
    v_cvt_pk_bf16_f32 v27, v38, v39
    buffer_store_dwordx2 v[26:27], v24, s[16:19], 0 offen offset:64
    s_nop 0
    v_mul_f32 v3, v40, v40
    v_mov_b32 v5, s6
    v_fma_f32 v3, v3, s7, v5
    v_mul_f32 v3, v3, v40
    v_exp_f32 v3, v3
    s_nop 0
    v_add_f32 v3, 1.0, v3
    v_rcp_f32 v3, v3
    s_nop 0
    v_mul_f32 v40, v40, v3
    v_mul_f32 v3, v41, v41
    v_mov_b32 v5, s6
    v_fma_f32 v3, v3, s7, v5
    v_mul_f32 v3, v3, v41
    v_exp_f32 v3, v3
    s_nop 0
    v_add_f32 v3, 1.0, v3
    v_rcp_f32 v3, v3
    s_nop 0
    v_mul_f32 v41, v41, v3
    v_mul_f32 v3, v42, v42
    v_mov_b32 v5, s6
    v_fma_f32 v3, v3, s7, v5
    v_mul_f32 v3, v3, v42
    v_exp_f32 v3, v3
    s_nop 0
    v_add_f32 v3, 1.0, v3
    v_rcp_f32 v3, v3
    s_nop 0
    v_mul_f32 v42, v42, v3
    v_mul_f32 v3, v43, v43
    v_mov_b32 v5, s6
    v_fma_f32 v3, v3, s7, v5
    v_mul_f32 v3, v3, v43
    v_exp_f32 v3, v3
    s_nop 0
    v_add_f32 v3, 1.0, v3
    v_rcp_f32 v3, v3
    s_nop 0
    v_mul_f32 v43, v43, v3
    v_cvt_pk_bf16_f32 v26, v40, v41
    v_cvt_pk_bf16_f32 v27, v42, v43
    buffer_store_dwordx2 v[26:27], v24, s[16:19], 0 offen offset:96
    s_nop 0
    v_mul_f32 v3, v44, v44
    v_mov_b32 v5, s6
    v_fma_f32 v3, v3, s7, v5
    v_mul_f32 v3, v3, v44
    v_exp_f32 v3, v3
    s_nop 0
    v_add_f32 v3, 1.0, v3
    v_rcp_f32 v3, v3
    s_nop 0
    v_mul_f32 v44, v44, v3
    v_mul_f32 v3, v45, v45
    v_mov_b32 v5, s6
    v_fma_f32 v3, v3, s7, v5
    v_mul_f32 v3, v3, v45
    v_exp_f32 v3, v3
    s_nop 0
    v_add_f32 v3, 1.0, v3
    v_rcp_f32 v3, v3
    s_nop 0
    v_mul_f32 v45, v45, v3
    v_mul_f32 v3, v46, v46
    v_mov_b32 v5, s6
    v_fma_f32 v3, v3, s7, v5
    v_mul_f32 v3, v3, v46
    v_exp_f32 v3, v3
    s_nop 0
    v_add_f32 v3, 1.0, v3
    v_rcp_f32 v3, v3
    s_nop 0
    v_mul_f32 v46, v46, v3
    v_mul_f32 v3, v47, v47
    v_mov_b32 v5, s6
    v_fma_f32 v3, v3, s7, v5
    v_mul_f32 v3, v3, v47
    v_exp_f32 v3, v3
    s_nop 0
    v_add_f32 v3, 1.0, v3
    v_rcp_f32 v3, v3
    s_nop 0
    v_mul_f32 v47, v47, v3
    v_cvt_pk_bf16_f32 v26, v44, v45
    v_cvt_pk_bf16_f32 v27, v46, v47
    buffer_store_dwordx2 v[26:27], v24, s[16:19], 0 offen offset:128
    s_nop 0
    s_waitcnt vmcnt(0)
    s_endpgm
L_END_k4_w1_kernel:
    s_endpgm
.globl k5_w2_kernel
.p2align 8
.type k5_w2_kernel,@function
k5_w2_kernel:
    s_cmp_ge_u32 s2, 256
    s_cbranch_scc1 L_END_k5_w2_kernel
    s_load_dwordx16 s[36:51], s[0:1], 0
    s_load_dwordx8 s[52:59], s[0:1], 64
    s_load_dwordx2 s[60:61], s[0:1], 96
    s_and_b32 s3, s2, 31
    s_lshr_b32 s4, s2, 5
    s_waitcnt lgkmcnt(0)
    s_add_u32 s8, s60, 0xa80000
    s_addc_u32 s9, s61, 0
    s_mov_b32 s10, 0x280000
    s_mov_b32 s11, 0x00020000
    s_mov_b32 s12, s50
    s_mov_b32 s13, s51
    s_mov_b32 s14, 0xc8000
    s_mov_b32 s15, 0x00020000
    s_add_u32 s16, s60, 0xd00000
    s_addc_u32 s17, s61, 0
    s_mov_b32 s18, 0x280000
    s_mov_b32 s19, 0x00020000
    s_add_u32 s20, s60, 0x800000
    s_addc_u32 s21, s61, 0
    s_mov_b32 s22, 0x280000
    s_mov_b32 s23, 0x00020000
    v_and_b32 v1, 15, v0
    v_bfe_u32 v2, v0, 4, 2
    v_lshrrev_b32 v3, 6, v0
    v_lshlrev_b32 v3, 4, v3
    v_add_u32 v3, v3, v1
    s_mul_i32 s5, s3, 64
    v_add_u32 v3, s5, v3
    v_mov_b32 v10, v3
    v_and_b32 v4, 63, v0
    v_xor_b32 v17, 32, v4
    v_lshlrev_b32 v17, 2, v17
    s_mov_b32 s6, 1280
    v_lshlrev_b32 v5, 4, v2
    v_add_u32 v4, -1, v3
    v_mul_lo_u32 v4, v4, s6
    v_add_u32 v18, v4, v5
    v_add_u32 v4, 1, v3
    v_mul_lo_u32 v4, v4, s6
    v_add_u32 v19, v4, v5
    v_add_u32 v4, -2, v3
    v_mul_lo_u32 v4, v4, s6
    v_add_u32 v20, v4, v5
    v_add_u32 v4, 2, v3
    v_mul_lo_u32 v4, v4, s6
    v_add_u32 v21, v4, v5
    v_mov_b32 v28, 0
    v_mov_b32 v29, 0
    v_mov_b32 v30, 0
    v_mov_b32 v31, 0
    v_mov_b32 v32, 0
    v_mov_b32 v33, 0
    v_mov_b32 v34, 0
    v_mov_b32 v35, 0
    v_mov_b32 v36, 0
    v_mov_b32 v37, 0
    v_mov_b32 v38, 0
    v_mov_b32 v39, 0
    v_mov_b32 v40, 0
    v_mov_b32 v41, 0
    v_mov_b32 v42, 0
    v_mov_b32 v43, 0
    v_mov_b32 v44, 0
    v_mov_b32 v45, 0
    v_mov_b32 v46, 0
    v_mov_b32 v47, 0
    v_lshrrev_b32 v4, 2, v1
    v_lshl_add_u32 v4, v2, 3, v4
    s_mov_b32 s7, 160
    v_mul_lo_u32 v4, v4, s7
    v_and_b32 v5, 3, v1
    v_lshl_add_u32 v23, v5, 3, v4
    s_mul_i32 s4, s4, 160
    v_and_b32 v4, 63, v0
    v_mul_u32_u24 v5, 6554, v4
    v_lshrrev_b32 v5, 16, v5
    v_mul_u32_u24 v6, 10, v5
    v_sub_u32 v6, v4, v6
    s_mov_b32 s66, 1280
    v_mul_lo_u32 v5, v5, s66
    v_lshl_add_u32 v25, v6, 4, v5
    v_lshrrev_b32 v4, 6, v0
    s_nop 1
    v_readfirstlane_b32 s64, v4
    s_nop 3
    s_mul_i32 s65, s64, 960
    s_mul_i32 s67, s64, 7680
    s_add_u32 s67, s67, s4
    buffer_load_dwordx4 v[136:139], v18, s[8:11], 0 offen offset:0
    buffer_load_dwordx4 v[140:143], v18, s[8:11], 0 offen offset:64
    buffer_load_dwordx4 v[144:147], v18, s[8:11], 0 offen offset:128
    buffer_load_dwordx4 v[148:151], v18, s[8:11], 0 offen offset:192
    buffer_load_dwordx4 v[152:155], v18, s[8:11], 0 offen offset:256
    s_mov_b32 s6, 1280
    v_mul_lo_u32 v24, v10, s6
    v_lshl_add_u32 v24, v2, 3, v24
    v_add_u32 v24, s4, v24
    buffer_load_dwordx2 v[216:217], v24, s[20:23], 0 offen offset:0
    buffer_load_dwordx2 v[220:221], v24, s[20:23], 0 offen offset:32
    buffer_load_dwordx2 v[224:225], v24, s[20:23], 0 offen offset:64
    buffer_load_dwordx2 v[228:229], v24, s[20:23], 0 offen offset:96
    buffer_load_dwordx2 v[232:233], v24, s[20:23], 0 offen offset:128
    s_mov_b64 s[68:69], exec
    s_mov_b32 exec_hi, 0xfffffff
    s_add_u32 m0, s65, 0
    s_add_u32 s70, s67, 0
    buffer_load_dwordx4 v25, s[12:15], s70 offen lds
    s_add_u32 m0, s65, 3840
    s_add_u32 s70, s67, 30720
    buffer_load_dwordx4 v25, s[12:15], s70 offen lds
    s_add_u32 m0, s65, 7680
    s_add_u32 s70, s67, 61440
    buffer_load_dwordx4 v25, s[12:15], s70 offen lds
    s_add_u32 m0, s65, 11520
    s_add_u32 s70, s67, 92160
    buffer_load_dwordx4 v25, s[12:15], s70 offen lds
    s_add_u32 m0, s65, 15360
    s_add_u32 s70, s67, 122880
    buffer_load_dwordx4 v25, s[12:15], s70 offen lds
    s_add_u32 m0, s65, 19200
    s_add_u32 s70, s67, 153600
    buffer_load_dwordx4 v25, s[12:15], s70 offen lds
    s_add_u32 m0, s65, 23040
    s_add_u32 s70, s67, 184320
    buffer_load_dwordx4 v25, s[12:15], s70 offen lds
    s_mov_b64 exec, s[68:69]
    buffer_load_dwordx4 v[156:159], v19, s[8:11], 0 offen offset:320
    buffer_load_dwordx4 v[160:163], v19, s[8:11], 0 offen offset:384
    buffer_load_dwordx4 v[164:167], v19, s[8:11], 0 offen offset:448
    buffer_load_dwordx4 v[168:171], v19, s[8:11], 0 offen offset:512
    buffer_load_dwordx4 v[172:175], v19, s[8:11], 0 offen offset:576
    s_mov_b64 s[68:69], exec
    s_mov_b32 exec_hi, 0xfffffff
    s_add_u32 m0, s65, 26880
    s_add_u32 s70, s67, 204800
    buffer_load_dwordx4 v25, s[12:15], s70 offen lds
    s_add_u32 m0, s65, 30720
    s_add_u32 s70, s67, 235520
    buffer_load_dwordx4 v25, s[12:15], s70 offen lds
    s_add_u32 m0, s65, 34560
    s_add_u32 s70, s67, 266240
    buffer_load_dwordx4 v25, s[12:15], s70 offen lds
    s_add_u32 m0, s65, 38400
    s_add_u32 s70, s67, 296960
    buffer_load_dwordx4 v25, s[12:15], s70 offen lds
    s_add_u32 m0, s65, 42240
    s_add_u32 s70, s67, 327680
    buffer_load_dwordx4 v25, s[12:15], s70 offen lds
    s_add_u32 m0, s65, 46080
    s_add_u32 s70, s67, 358400
    buffer_load_dwordx4 v25, s[12:15], s70 offen lds
    s_add_u32 m0, s65, 49920
    s_add_u32 s70, s67, 389120
    buffer_load_dwordx4 v25, s[12:15], s70 offen lds
    s_mov_b64 exec, s[68:69]
    s_waitcnt vmcnt(12)
    s_barrier
    v_add_u32 v22, 0, v23
    ds_read_b64_tr_b16 v[64:65], v22 offset:0
    ds_read_b64_tr_b16 v[66:67], v22 offset:640
    ds_read_b64_tr_b16 v[68:69], v22 offset:32
    ds_read_b64_tr_b16 v[70:71], v22 offset:672
    ds_read_b64_tr_b16 v[72:73], v22 offset:64
    ds_read_b64_tr_b16 v[74:75], v22 offset:704
    ds_read_b64_tr_b16 v[76:77], v22 offset:96
    ds_read_b64_tr_b16 v[78:79], v22 offset:736
    ds_read_b64_tr_b16 v[80:81], v22 offset:128
    ds_read_b64_tr_b16 v[82:83], v22 offset:768
    v_add_u32 v22, 5120, v23
    ds_read_b64_tr_b16 v[100:101], v22 offset:0
    ds_read_b64_tr_b16 v[102:103], v22 offset:640
    ds_read_b64_tr_b16 v[104:105], v22 offset:32
    ds_read_b64_tr_b16 v[106:107], v22 offset:672
    ds_read_b64_tr_b16 v[108:109], v22 offset:64
    ds_read_b64_tr_b16 v[110:111], v22 offset:704
    ds_read_b64_tr_b16 v[112:113], v22 offset:96
    ds_read_b64_tr_b16 v[114:115], v22 offset:736
    ds_read_b64_tr_b16 v[116:117], v22 offset:128
    ds_read_b64_tr_b16 v[118:119], v22 offset:768
    s_waitcnt lgkmcnt(10)
    v_mfma_f32_16x16x32_bf16 v[28:31], v[64:67], v[136:139], v[28:31]
    v_mfma_f32_16x16x32_bf16 v[32:35], v[68:71], v[136:139], v[32:35]
    v_mfma_f32_16x16x32_bf16 v[36:39], v[72:75], v[136:139], v[36:39]
    v_mfma_f32_16x16x32_bf16 v[40:43], v[76:79], v[136:139], v[40:43]
    v_mfma_f32_16x16x32_bf16 v[44:47], v[80:83], v[136:139], v[44:47]
    v_add_u32 v22, 10240, v23
    ds_read_b64_tr_b16 v[64:65], v22 offset:0
    ds_read_b64_tr_b16 v[66:67], v22 offset:640
    ds_read_b64_tr_b16 v[68:69], v22 offset:32
    ds_read_b64_tr_b16 v[70:71], v22 offset:672
    ds_read_b64_tr_b16 v[72:73], v22 offset:64
    ds_read_b64_tr_b16 v[74:75], v22 offset:704
    ds_read_b64_tr_b16 v[76:77], v22 offset:96
    ds_read_b64_tr_b16 v[78:79], v22 offset:736
    ds_read_b64_tr_b16 v[80:81], v22 offset:128
    ds_read_b64_tr_b16 v[82:83], v22 offset:768
    s_waitcnt lgkmcnt(10)
    v_mfma_f32_16x16x32_bf16 v[28:31], v[100:103], v[140:143], v[28:31]
    v_mfma_f32_16x16x32_bf16 v[32:35], v[104:107], v[140:143], v[32:35]
    v_mfma_f32_16x16x32_bf16 v[36:39], v[108:111], v[140:143], v[36:39]
    v_mfma_f32_16x16x32_bf16 v[40:43], v[112:115], v[140:143], v[40:43]
    v_mfma_f32_16x16x32_bf16 v[44:47], v[116:119], v[140:143], v[44:47]
    v_add_u32 v22, 15360, v23
    ds_read_b64_tr_b16 v[100:101], v22 offset:0
    ds_read_b64_tr_b16 v[102:103], v22 offset:640
    ds_read_b64_tr_b16 v[104:105], v22 offset:32
    ds_read_b64_tr_b16 v[106:107], v22 offset:672
    ds_read_b64_tr_b16 v[108:109], v22 offset:64
    ds_read_b64_tr_b16 v[110:111], v22 offset:704
    ds_read_b64_tr_b16 v[112:113], v22 offset:96
    ds_read_b64_tr_b16 v[114:115], v22 offset:736
    ds_read_b64_tr_b16 v[116:117], v22 offset:128
    ds_read_b64_tr_b16 v[118:119], v22 offset:768
    s_waitcnt lgkmcnt(10)
    v_mfma_f32_16x16x32_bf16 v[28:31], v[64:67], v[144:147], v[28:31]
    v_mfma_f32_16x16x32_bf16 v[32:35], v[68:71], v[144:147], v[32:35]
    v_mfma_f32_16x16x32_bf16 v[36:39], v[72:75], v[144:147], v[36:39]
    v_mfma_f32_16x16x32_bf16 v[40:43], v[76:79], v[144:147], v[40:43]
    v_mfma_f32_16x16x32_bf16 v[44:47], v[80:83], v[144:147], v[44:47]
    v_add_u32 v22, 20480, v23
    ds_read_b64_tr_b16 v[64:65], v22 offset:0
    ds_read_b64_tr_b16 v[66:67], v22 offset:640
    ds_read_b64_tr_b16 v[68:69], v22 offset:32
    ds_read_b64_tr_b16 v[70:71], v22 offset:672
    ds_read_b64_tr_b16 v[72:73], v22 offset:64
    ds_read_b64_tr_b16 v[74:75], v22 offset:704
    ds_read_b64_tr_b16 v[76:77], v22 offset:96
    ds_read_b64_tr_b16 v[78:79], v22 offset:736
    ds_read_b64_tr_b16 v[80:81], v22 offset:128
    ds_read_b64_tr_b16 v[82:83], v22 offset:768
    s_waitcnt lgkmcnt(10)
    v_mfma_f32_16x16x32_bf16 v[28:31], v[100:103], v[148:151], v[28:31]
    v_mfma_f32_16x16x32_bf16 v[32:35], v[104:107], v[148:151], v[32:35]
    v_mfma_f32_16x16x32_bf16 v[36:39], v[108:111], v[148:151], v[36:39]
    v_mfma_f32_16x16x32_bf16 v[40:43], v[112:115], v[148:151], v[40:43]
    v_mfma_f32_16x16x32_bf16 v[44:47], v[116:119], v[148:151], v[44:47]
    s_waitcnt lgkmcnt(0)
    v_mfma_f32_16x16x32_bf16 v[28:31], v[64:67], v[152:155], v[28:31]
    v_mfma_f32_16x16x32_bf16 v[32:35], v[68:71], v[152:155], v[32:35]
    v_mfma_f32_16x16x32_bf16 v[36:39], v[72:75], v[152:155], v[36:39]
    v_mfma_f32_16x16x32_bf16 v[40:43], v[76:79], v[152:155], v[40:43]
    v_mfma_f32_16x16x32_bf16 v[44:47], v[80:83], v[152:155], v[44:47]
    s_barrier
    buffer_load_dwordx4 v[136:139], v20, s[8:11], 0 offen offset:640
    buffer_load_dwordx4 v[140:143], v20, s[8:11], 0 offen offset:704
    buffer_load_dwordx4 v[144:147], v20, s[8:11], 0 offen offset:768
    buffer_load_dwordx4 v[148:151], v20, s[8:11], 0 offen offset:832
    buffer_load_dwordx4 v[152:155], v20, s[8:11], 0 offen offset:896
    s_mov_b64 s[68:69], exec
    s_mov_b32 exec_hi, 0xfffffff
    s_add_u32 m0, s65, 0
    s_add_u32 s70, s67, 409600
    buffer_load_dwordx4 v25, s[12:15], s70 offen lds
    s_add_u32 m0, s65, 3840
    s_add_u32 s70, s67, 440320
    buffer_load_dwordx4 v25, s[12:15], s70 offen lds
    s_add_u32 m0, s65, 7680
    s_add_u32 s70, s67, 471040
    buffer_load_dwordx4 v25, s[12:15], s70 offen lds
    s_add_u32 m0, s65, 11520
    s_add_u32 s70, s67, 501760
    buffer_load_dwordx4 v25, s[12:15], s70 offen lds
    s_add_u32 m0, s65, 15360
    s_add_u32 s70, s67, 532480
    buffer_load_dwordx4 v25, s[12:15], s70 offen lds
    s_add_u32 m0, s65, 19200
    s_add_u32 s70, s67, 563200
    buffer_load_dwordx4 v25, s[12:15], s70 offen lds
    s_add_u32 m0, s65, 23040
    s_add_u32 s70, s67, 593920
    buffer_load_dwordx4 v25, s[12:15], s70 offen lds
    s_mov_b64 exec, s[68:69]
    s_waitcnt vmcnt(12)
    s_barrier
    v_add_u32 v22, 26880, v23
    ds_read_b64_tr_b16 v[64:65], v22 offset:0
    ds_read_b64_tr_b16 v[66:67], v22 offset:640
    ds_read_b64_tr_b16 v[68:69], v22 offset:32
    ds_read_b64_tr_b16 v[70:71], v22 offset:672
    ds_read_b64_tr_b16 v[72:73], v22 offset:64
    ds_read_b64_tr_b16 v[74:75], v22 offset:704
    ds_read_b64_tr_b16 v[76:77], v22 offset:96
    ds_read_b64_tr_b16 v[78:79], v22 offset:736
    ds_read_b64_tr_b16 v[80:81], v22 offset:128
    ds_read_b64_tr_b16 v[82:83], v22 offset:768
    v_add_u32 v22, 32000, v23
    ds_read_b64_tr_b16 v[100:101], v22 offset:0
    ds_read_b64_tr_b16 v[102:103], v22 offset:640
    ds_read_b64_tr_b16 v[104:105], v22 offset:32
    ds_read_b64_tr_b16 v[106:107], v22 offset:672
    ds_read_b64_tr_b16 v[108:109], v22 offset:64
    ds_read_b64_tr_b16 v[110:111], v22 offset:704
    ds_read_b64_tr_b16 v[112:113], v22 offset:96
    ds_read_b64_tr_b16 v[114:115], v22 offset:736
    ds_read_b64_tr_b16 v[116:117], v22 offset:128
    ds_read_b64_tr_b16 v[118:119], v22 offset:768
    s_waitcnt lgkmcnt(10)
    v_mfma_f32_16x16x32_bf16 v[28:31], v[64:67], v[156:159], v[28:31]
    v_mfma_f32_16x16x32_bf16 v[32:35], v[68:71], v[156:159], v[32:35]
    v_mfma_f32_16x16x32_bf16 v[36:39], v[72:75], v[156:159], v[36:39]
    v_mfma_f32_16x16x32_bf16 v[40:43], v[76:79], v[156:159], v[40:43]
    v_mfma_f32_16x16x32_bf16 v[44:47], v[80:83], v[156:159], v[44:47]
    v_add_u32 v22, 37120, v23
    ds_read_b64_tr_b16 v[64:65], v22 offset:0
    ds_read_b64_tr_b16 v[66:67], v22 offset:640
    ds_read_b64_tr_b16 v[68:69], v22 offset:32
    ds_read_b64_tr_b16 v[70:71], v22 offset:672
    ds_read_b64_tr_b16 v[72:73], v22 offset:64
    ds_read_b64_tr_b16 v[74:75], v22 offset:704
    ds_read_b64_tr_b16 v[76:77], v22 offset:96
    ds_read_b64_tr_b16 v[78:79], v22 offset:736
    ds_read_b64_tr_b16 v[80:81], v22 offset:128
    ds_read_b64_tr_b16 v[82:83], v22 offset:768
    s_waitcnt lgkmcnt(10)
    v_mfma_f32_16x16x32_bf16 v[28:31], v[100:103], v[160:163], v[28:31]
    v_mfma_f32_16x16x32_bf16 v[32:35], v[104:107], v[160:163], v[32:35]
    v_mfma_f32_16x16x32_bf16 v[36:39], v[108:111], v[160:163], v[36:39]
    v_mfma_f32_16x16x32_bf16 v[40:43], v[112:115], v[160:163], v[40:43]
    v_mfma_f32_16x16x32_bf16 v[44:47], v[116:119], v[160:163], v[44:47]
    v_add_u32 v22, 42240, v23
    ds_read_b64_tr_b16 v[100:101], v22 offset:0
    ds_read_b64_tr_b16 v[102:103], v22 offset:640
    ds_read_b64_tr_b16 v[104:105], v22 offset:32
    ds_read_b64_tr_b16 v[106:107], v22 offset:672
    ds_read_b64_tr_b16 v[108:109], v22 offset:64
    ds_read_b64_tr_b16 v[110:111], v22 offset:704
    ds_read_b64_tr_b16 v[112:113], v22 offset:96
    ds_read_b64_tr_b16 v[114:115], v22 offset:736
    ds_read_b64_tr_b16 v[116:117], v22 offset:128
    ds_read_b64_tr_b16 v[118:119], v22 offset:768
    s_waitcnt lgkmcnt(10)
    v_mfma_f32_16x16x32_bf16 v[28:31], v[64:67], v[164:167], v[28:31]
    v_mfma_f32_16x16x32_bf16 v[32:35], v[68:71], v[164:167], v[32:35]
    v_mfma_f32_16x16x32_bf16 v[36:39], v[72:75], v[164:167], v[36:39]
    v_mfma_f32_16x16x32_bf16 v[40:43], v[76:79], v[164:167], v[40:43]
    v_mfma_f32_16x16x32_bf16 v[44:47], v[80:83], v[164:167], v[44:47]
    v_add_u32 v22, 47360, v23
    ds_read_b64_tr_b16 v[64:65], v22 offset:0
    ds_read_b64_tr_b16 v[66:67], v22 offset:640
    ds_read_b64_tr_b16 v[68:69], v22 offset:32
    ds_read_b64_tr_b16 v[70:71], v22 offset:672
    ds_read_b64_tr_b16 v[72:73], v22 offset:64
    ds_read_b64_tr_b16 v[74:75], v22 offset:704
    ds_read_b64_tr_b16 v[76:77], v22 offset:96
    ds_read_b64_tr_b16 v[78:79], v22 offset:736
    ds_read_b64_tr_b16 v[80:81], v22 offset:128
    ds_read_b64_tr_b16 v[82:83], v22 offset:768
    s_waitcnt lgkmcnt(10)
    v_mfma_f32_16x16x32_bf16 v[28:31], v[100:103], v[168:171], v[28:31]
    v_mfma_f32_16x16x32_bf16 v[32:35], v[104:107], v[168:171], v[32:35]
    v_mfma_f32_16x16x32_bf16 v[36:39], v[108:111], v[168:171], v[36:39]
    v_mfma_f32_16x16x32_bf16 v[40:43], v[112:115], v[168:171], v[40:43]
    v_mfma_f32_16x16x32_bf16 v[44:47], v[116:119], v[168:171], v[44:47]
    s_waitcnt lgkmcnt(0)
    v_mfma_f32_16x16x32_bf16 v[28:31], v[64:67], v[172:175], v[28:31]
    v_mfma_f32_16x16x32_bf16 v[32:35], v[68:71], v[172:175], v[32:35]
    v_mfma_f32_16x16x32_bf16 v[36:39], v[72:75], v[172:175], v[36:39]
    v_mfma_f32_16x16x32_bf16 v[40:43], v[76:79], v[172:175], v[40:43]
    v_mfma_f32_16x16x32_bf16 v[44:47], v[80:83], v[172:175], v[44:47]
    s_barrier
    buffer_load_dwordx4 v[156:159], v21, s[8:11], 0 offen offset:960
    buffer_load_dwordx4 v[160:163], v21, s[8:11], 0 offen offset:1024
    buffer_load_dwordx4 v[164:167], v21, s[8:11], 0 offen offset:1088
    buffer_load_dwordx4 v[168:171], v21, s[8:11], 0 offen offset:1152
    buffer_load_dwordx4 v[172:175], v21, s[8:11], 0 offen offset:1216
    s_mov_b64 s[68:69], exec
    s_mov_b32 exec_hi, 0xfffffff
    s_add_u32 m0, s65, 26880
    s_add_u32 s70, s67, 614400
    buffer_load_dwordx4 v25, s[12:15], s70 offen lds
    s_add_u32 m0, s65, 30720
    s_add_u32 s70, s67, 645120
    buffer_load_dwordx4 v25, s[12:15], s70 offen lds
    s_add_u32 m0, s65, 34560
    s_add_u32 s70, s67, 675840
    buffer_load_dwordx4 v25, s[12:15], s70 offen lds
    s_add_u32 m0, s65, 38400
    s_add_u32 s70, s67, 706560
    buffer_load_dwordx4 v25, s[12:15], s70 offen lds
    s_add_u32 m0, s65, 42240
    s_add_u32 s70, s67, 737280
    buffer_load_dwordx4 v25, s[12:15], s70 offen lds
    s_add_u32 m0, s65, 46080
    s_add_u32 s70, s67, 768000
    buffer_load_dwordx4 v25, s[12:15], s70 offen lds
    s_add_u32 m0, s65, 49920
    s_add_u32 s70, s67, 798720
    buffer_load_dwordx4 v25, s[12:15], s70 offen lds
    s_mov_b64 exec, s[68:69]
    s_waitcnt vmcnt(12)
    s_barrier
    v_add_u32 v22, 0, v23
    ds_read_b64_tr_b16 v[64:65], v22 offset:0
    ds_read_b64_tr_b16 v[66:67], v22 offset:640
    ds_read_b64_tr_b16 v[68:69], v22 offset:32
    ds_read_b64_tr_b16 v[70:71], v22 offset:672
    ds_read_b64_tr_b16 v[72:73], v22 offset:64
    ds_read_b64_tr_b16 v[74:75], v22 offset:704
    ds_read_b64_tr_b16 v[76:77], v22 offset:96
    ds_read_b64_tr_b16 v[78:79], v22 offset:736
    ds_read_b64_tr_b16 v[80:81], v22 offset:128
    ds_read_b64_tr_b16 v[82:83], v22 offset:768
    v_add_u32 v22, 5120, v23
    ds_read_b64_tr_b16 v[100:101], v22 offset:0
    ds_read_b64_tr_b16 v[102:103], v22 offset:640
    ds_read_b64_tr_b16 v[104:105], v22 offset:32
    ds_read_b64_tr_b16 v[106:107], v22 offset:672
    ds_read_b64_tr_b16 v[108:109], v22 offset:64
    ds_read_b64_tr_b16 v[110:111], v22 offset:704
    ds_read_b64_tr_b16 v[112:113], v22 offset:96
    ds_read_b64_tr_b16 v[114:115], v22 offset:736
    ds_read_b64_tr_b16 v[116:117], v22 offset:128
    ds_read_b64_tr_b16 v[118:119], v22 offset:768
    s_waitcnt lgkmcnt(10)
    v_mfma_f32_16x16x32_bf16 v[28:31], v[64:67], v[136:139], v[28:31]
    v_mfma_f32_16x16x32_bf16 v[32:35], v[68:71], v[136:139], v[32:35]
    v_mfma_f32_16x16x32_bf16 v[36:39], v[72:75], v[136:139], v[36:39]
    v_mfma_f32_16x16x32_bf16 v[40:43], v[76:79], v[136:139], v[40:43]
    v_mfma_f32_16x16x32_bf16 v[44:47], v[80:83], v[136:139], v[44:47]
    v_add_u32 v22, 10240, v23
    ds_read_b64_tr_b16 v[64:65], v22 offset:0
    ds_read_b64_tr_b16 v[66:67], v22 offset:640
    ds_read_b64_tr_b16 v[68:69], v22 offset:32
    ds_read_b64_tr_b16 v[70:71], v22 offset:672
    ds_read_b64_tr_b16 v[72:73], v22 offset:64
    ds_read_b64_tr_b16 v[74:75], v22 offset:704
    ds_read_b64_tr_b16 v[76:77], v22 offset:96
    ds_read_b64_tr_b16 v[78:79], v22 offset:736
    ds_read_b64_tr_b16 v[80:81], v22 offset:128
    ds_read_b64_tr_b16 v[82:83], v22 offset:768
    s_waitcnt lgkmcnt(10)
    v_mfma_f32_16x16x32_bf16 v[28:31], v[100:103], v[140:143], v[28:31]
    v_mfma_f32_16x16x32_bf16 v[32:35], v[104:107], v[140:143], v[32:35]
    v_mfma_f32_16x16x32_bf16 v[36:39], v[108:111], v[140:143], v[36:39]
    v_mfma_f32_16x16x32_bf16 v[40:43], v[112:115], v[140:143], v[40:43]
    v_mfma_f32_16x16x32_bf16 v[44:47], v[116:119], v[140:143], v[44:47]
    v_add_u32 v22, 15360, v23
    ds_read_b64_tr_b16 v[100:101], v22 offset:0
    ds_read_b64_tr_b16 v[102:103], v22 offset:640
    ds_read_b64_tr_b16 v[104:105], v22 offset:32
    ds_read_b64_tr_b16 v[106:107], v22 offset:672
    ds_read_b64_tr_b16 v[108:109], v22 offset:64
    ds_read_b64_tr_b16 v[110:111], v22 offset:704
    ds_read_b64_tr_b16 v[112:113], v22 offset:96
    ds_read_b64_tr_b16 v[114:115], v22 offset:736
    ds_read_b64_tr_b16 v[116:117], v22 offset:128
    ds_read_b64_tr_b16 v[118:119], v22 offset:768
    s_waitcnt lgkmcnt(10)
    v_mfma_f32_16x16x32_bf16 v[28:31], v[64:67], v[144:147], v[28:31]
    v_mfma_f32_16x16x32_bf16 v[32:35], v[68:71], v[144:147], v[32:35]
    v_mfma_f32_16x16x32_bf16 v[36:39], v[72:75], v[144:147], v[36:39]
    v_mfma_f32_16x16x32_bf16 v[40:43], v[76:79], v[144:147], v[40:43]
    v_mfma_f32_16x16x32_bf16 v[44:47], v[80:83], v[144:147], v[44:47]
    v_add_u32 v22, 20480, v23
    ds_read_b64_tr_b16 v[64:65], v22 offset:0
    ds_read_b64_tr_b16 v[66:67], v22 offset:640
    ds_read_b64_tr_b16 v[68:69], v22 offset:32
    ds_read_b64_tr_b16 v[70:71], v22 offset:672
    ds_read_b64_tr_b16 v[72:73], v22 offset:64
    ds_read_b64_tr_b16 v[74:75], v22 offset:704
    ds_read_b64_tr_b16 v[76:77], v22 offset:96
    ds_read_b64_tr_b16 v[78:79], v22 offset:736
    ds_read_b64_tr_b16 v[80:81], v22 offset:128
    ds_read_b64_tr_b16 v[82:83], v22 offset:768
    s_waitcnt lgkmcnt(10)
    v_mfma_f32_16x16x32_bf16 v[28:31], v[100:103], v[148:151], v[28:31]
    v_mfma_f32_16x16x32_bf16 v[32:35], v[104:107], v[148:151], v[32:35]
    v_mfma_f32_16x16x32_bf16 v[36:39], v[108:111], v[148:151], v[36:39]
    v_mfma_f32_16x16x32_bf16 v[40:43], v[112:115], v[148:151], v[40:43]
    v_mfma_f32_16x16x32_bf16 v[44:47], v[116:119], v[148:151], v[44:47]
    s_waitcnt lgkmcnt(0)
    v_mfma_f32_16x16x32_bf16 v[28:31], v[64:67], v[152:155], v[28:31]
    v_mfma_f32_16x16x32_bf16 v[32:35], v[68:71], v[152:155], v[32:35]
    v_mfma_f32_16x16x32_bf16 v[36:39], v[72:75], v[152:155], v[36:39]
    v_mfma_f32_16x16x32_bf16 v[40:43], v[76:79], v[152:155], v[40:43]
    v_mfma_f32_16x16x32_bf16 v[44:47], v[80:83], v[152:155], v[44:47]
    s_waitcnt vmcnt(0)
    s_barrier
    v_add_u32 v22, 26880, v23
    ds_read_b64_tr_b16 v[64:65], v22 offset:0
    ds_read_b64_tr_b16 v[66:67], v22 offset:640
    ds_read_b64_tr_b16 v[68:69], v22 offset:32
    ds_read_b64_tr_b16 v[70:71], v22 offset:672
    ds_read_b64_tr_b16 v[72:73], v22 offset:64
    ds_read_b64_tr_b16 v[74:75], v22 offset:704
    ds_read_b64_tr_b16 v[76:77], v22 offset:96
    ds_read_b64_tr_b16 v[78:79], v22 offset:736
    ds_read_b64_tr_b16 v[80:81], v22 offset:128
    ds_read_b64_tr_b16 v[82:83], v22 offset:768
    v_add_u32 v22, 32000, v23
    ds_read_b64_tr_b16 v[100:101], v22 offset:0
    ds_read_b64_tr_b16 v[102:103], v22 offset:640
    ds_read_b64_tr_b16 v[104:105], v22 offset:32
    ds_read_b64_tr_b16 v[106:107], v22 offset:672
    ds_read_b64_tr_b16 v[108:109], v22 offset:64
    ds_read_b64_tr_b16 v[110:111], v22 offset:704
    ds_read_b64_tr_b16 v[112:113], v22 offset:96
    ds_read_b64_tr_b16 v[114:115], v22 offset:736
    ds_read_b64_tr_b16 v[116:117], v22 offset:128
    ds_read_b64_tr_b16 v[118:119], v22 offset:768
    s_waitcnt lgkmcnt(10)
    v_mfma_f32_16x16x32_bf16 v[28:31], v[64:67], v[156:159], v[28:31]
    v_mfma_f32_16x16x32_bf16 v[32:35], v[68:71], v[156:159], v[32:35]
    v_mfma_f32_16x16x32_bf16 v[36:39], v[72:75], v[156:159], v[36:39]
    v_mfma_f32_16x16x32_bf16 v[40:43], v[76:79], v[156:159], v[40:43]
    v_mfma_f32_16x16x32_bf16 v[44:47], v[80:83], v[156:159], v[44:47]
    v_add_u32 v22, 37120, v23
    ds_read_b64_tr_b16 v[64:65], v22 offset:0
    ds_read_b64_tr_b16 v[66:67], v22 offset:640
    ds_read_b64_tr_b16 v[68:69], v22 offset:32
    ds_read_b64_tr_b16 v[70:71], v22 offset:672
    ds_read_b64_tr_b16 v[72:73], v22 offset:64
    ds_read_b64_tr_b16 v[74:75], v22 offset:704
    ds_read_b64_tr_b16 v[76:77], v22 offset:96
    ds_read_b64_tr_b16 v[78:79], v22 offset:736
    ds_read_b64_tr_b16 v[80:81], v22 offset:128
    ds_read_b64_tr_b16 v[82:83], v22 offset:768
    s_waitcnt lgkmcnt(10)
    v_mfma_f32_16x16x32_bf16 v[28:31], v[100:103], v[160:163], v[28:31]
    v_mfma_f32_16x16x32_bf16 v[32:35], v[104:107], v[160:163], v[32:35]
    v_mfma_f32_16x16x32_bf16 v[36:39], v[108:111], v[160:163], v[36:39]
    v_mfma_f32_16x16x32_bf16 v[40:43], v[112:115], v[160:163], v[40:43]
    v_mfma_f32_16x16x32_bf16 v[44:47], v[116:119], v[160:163], v[44:47]
    v_add_u32 v22, 42240, v23
    ds_read_b64_tr_b16 v[100:101], v22 offset:0
    ds_read_b64_tr_b16 v[102:103], v22 offset:640
    ds_read_b64_tr_b16 v[104:105], v22 offset:32
    ds_read_b64_tr_b16 v[106:107], v22 offset:672
    ds_read_b64_tr_b16 v[108:109], v22 offset:64
    ds_read_b64_tr_b16 v[110:111], v22 offset:704
    ds_read_b64_tr_b16 v[112:113], v22 offset:96
    ds_read_b64_tr_b16 v[114:115], v22 offset:736
    ds_read_b64_tr_b16 v[116:117], v22 offset:128
    ds_read_b64_tr_b16 v[118:119], v22 offset:768
    s_waitcnt lgkmcnt(10)
    v_mfma_f32_16x16x32_bf16 v[28:31], v[64:67], v[164:167], v[28:31]
    v_mfma_f32_16x16x32_bf16 v[32:35], v[68:71], v[164:167], v[32:35]
    v_mfma_f32_16x16x32_bf16 v[36:39], v[72:75], v[164:167], v[36:39]
    v_mfma_f32_16x16x32_bf16 v[40:43], v[76:79], v[164:167], v[40:43]
    v_mfma_f32_16x16x32_bf16 v[44:47], v[80:83], v[164:167], v[44:47]
    v_add_u32 v22, 47360, v23
    ds_read_b64_tr_b16 v[64:65], v22 offset:0
    ds_read_b64_tr_b16 v[66:67], v22 offset:640
    ds_read_b64_tr_b16 v[68:69], v22 offset:32
    ds_read_b64_tr_b16 v[70:71], v22 offset:672
    ds_read_b64_tr_b16 v[72:73], v22 offset:64
    ds_read_b64_tr_b16 v[74:75], v22 offset:704
    ds_read_b64_tr_b16 v[76:77], v22 offset:96
    ds_read_b64_tr_b16 v[78:79], v22 offset:736
    ds_read_b64_tr_b16 v[80:81], v22 offset:128
    ds_read_b64_tr_b16 v[82:83], v22 offset:768
    s_waitcnt lgkmcnt(10)
    v_mfma_f32_16x16x32_bf16 v[28:31], v[100:103], v[168:171], v[28:31]
    v_mfma_f32_16x16x32_bf16 v[32:35], v[104:107], v[168:171], v[32:35]
    v_mfma_f32_16x16x32_bf16 v[36:39], v[108:111], v[168:171], v[36:39]
    v_mfma_f32_16x16x32_bf16 v[40:43], v[112:115], v[168:171], v[40:43]
    v_mfma_f32_16x16x32_bf16 v[44:47], v[116:119], v[168:171], v[44:47]
    s_waitcnt lgkmcnt(0)
    v_mfma_f32_16x16x32_bf16 v[28:31], v[64:67], v[172:175], v[28:31]
    v_mfma_f32_16x16x32_bf16 v[32:35], v[68:71], v[172:175], v[32:35]
    v_mfma_f32_16x16x32_bf16 v[36:39], v[72:75], v[172:175], v[36:39]
    v_mfma_f32_16x16x32_bf16 v[40:43], v[76:79], v[172:175], v[40:43]
    v_mfma_f32_16x16x32_bf16 v[44:47], v[80:83], v[172:175], v[44:47]
    s_nop 15
    v_lshlrev_b32 v3, 16, v216
    v_add_f32 v28, v28, v3
    v_and_b32 v3, 0xffff0000, v216
    v_add_f32 v29, v29, v3
    v_lshlrev_b32 v3, 16, v217
    v_add_f32 v30, v30, v3
    v_and_b32 v3, 0xffff0000, v217
    v_add_f32 v31, v31, v3
    v_cvt_pk_bf16_f32 v26, v28, v29
    v_cvt_pk_bf16_f32 v27, v30, v31
    buffer_store_dwordx2 v[26:27], v24, s[16:19], 0 offen offset:0
    s_nop 0
    v_lshlrev_b32 v3, 16, v220
    v_add_f32 v32, v32, v3
    v_and_b32 v3, 0xffff0000, v220
    v_add_f32 v33, v33, v3
    v_lshlrev_b32 v3, 16, v221
    v_add_f32 v34, v34, v3
    v_and_b32 v3, 0xffff0000, v221
    v_add_f32 v35, v35, v3
    v_cvt_pk_bf16_f32 v26, v32, v33
    v_cvt_pk_bf16_f32 v27, v34, v35
    buffer_store_dwordx2 v[26:27], v24, s[16:19], 0 offen offset:32
    s_nop 0
    v_lshlrev_b32 v3, 16, v224
    v_add_f32 v36, v36, v3
    v_and_b32 v3, 0xffff0000, v224
    v_add_f32 v37, v37, v3
    v_lshlrev_b32 v3, 16, v225
    v_add_f32 v38, v38, v3
    v_and_b32 v3, 0xffff0000, v225
    v_add_f32 v39, v39, v3
    v_cvt_pk_bf16_f32 v26, v36, v37
    v_cvt_pk_bf16_f32 v27, v38, v39
    buffer_store_dwordx2 v[26:27], v24, s[16:19], 0 offen offset:64
    s_nop 0
    v_lshlrev_b32 v3, 16, v228
    v_add_f32 v40, v40, v3
    v_and_b32 v3, 0xffff0000, v228
    v_add_f32 v41, v41, v3
    v_lshlrev_b32 v3, 16, v229
    v_add_f32 v42, v42, v3
    v_and_b32 v3, 0xffff0000, v229
    v_add_f32 v43, v43, v3
    v_cvt_pk_bf16_f32 v26, v40, v41
    v_cvt_pk_bf16_f32 v27, v42, v43
    buffer_store_dwordx2 v[26:27], v24, s[16:19], 0 offen offset:96
    s_nop 0
    v_lshlrev_b32 v3, 16, v232
    v_add_f32 v44, v44, v3
    v_and_b32 v3, 0xffff0000, v232
    v_add_f32 v45, v45, v3
    v_lshlrev_b32 v3, 16, v233
    v_add_f32 v46, v46, v3
    v_and_b32 v3, 0xffff0000, v233
    v_add_f32 v47, v47, v3
    v_cvt_pk_bf16_f32 v26, v44, v45
    v_cvt_pk_bf16_f32 v27, v46, v47
    buffer_store_dwordx2 v[26:27], v24, s[16:19], 0 offen offset:128
    s_nop 0
    s_waitcnt vmcnt(0)
    s_endpgm
L_END_k5_w2_kernel:
    s_endpgm
.globl k6_w3_kernel
.p2align 8
.type k6_w3_kernel,@function
k6_w3_kernel:
    s_cmp_ge_u32 s2, 192
    s_cbranch_scc1 L_END_k6_w3_kernel
    s_load_dwordx16 s[36:51], s[0:1], 0
    s_load_dwordx8 s[52:59], s[0:1], 64
    s_load_dwordx2 s[60:61], s[0:1], 96
    s_and_b32 s3, s2, 15
    s_lshr_b32 s4, s2, 4
    s_waitcnt lgkmcnt(0)
    s_add_u32 s8, s60, 0xd00000
    s_addc_u32 s9, s61, 0
    s_mov_b32 s10, 0x280000
    s_mov_b32 s11, 0x00020000
    s_mov_b32 s12, s52
    s_mov_b32 s13, s53
    s_mov_b32 s14, 0x21c000
    s_mov_b32 s15, 0x00020000
    s_add_u32 s16, s60, 0xf80000
    s_addc_u32 s17, s61, 0
    s_mov_b32 s18, 0x6c0000
    s_mov_b32 s19, 0x00020000
    v_and_b32 v1, 15, v0
    v_bfe_u32 v2, v0, 4, 2
    v_lshrrev_b32 v3, 6, v0
    v_lshlrev_b32 v3, 4, v3
    v_add_u32 v3, v3, v1
    s_mul_i32 s5, s3, 128
    v_add_u32 v3, s5, v3
    v_mov_b32 v10, v3
    v_and_b32 v4, 63, v0
    v_xor_b32 v17, 32, v4
    v_lshlrev_b32 v17, 2, v17
    s_mov_b32 s6, 1280
    v_lshlrev_b32 v5, 4, v2
    v_mov_b32 v4, v3
    v_mul_lo_u32 v4, v4, s6
    v_add_u32 v18, v4, v5
    v_mov_b32 v28, 0
    v_mov_b32 v29, 0
    v_mov_b32 v30, 0
    v_mov_b32 v31, 0
    v_mov_b32 v32, 0
    v_mov_b32 v33, 0
    v_mov_b32 v34, 0
    v_mov_b32 v35, 0
    v_mov_b32 v36, 0
    v_mov_b32 v37, 0
    v_mov_b32 v38, 0
    v_mov_b32 v39, 0
    v_mov_b32 v40, 0
    v_mov_b32 v41, 0
    v_mov_b32 v42, 0
    v_mov_b32 v43, 0
    v_mov_b32 v44, 0
    v_mov_b32 v45, 0
    v_mov_b32 v46, 0
    v_mov_b32 v47, 0
    v_mov_b32 v48, 0
    v_mov_b32 v49, 0
    v_mov_b32 v50, 0
    v_mov_b32 v51, 0
    v_mov_b32 v52, 0
    v_mov_b32 v53, 0
    v_mov_b32 v54, 0
    v_mov_b32 v55, 0
    v_mov_b32 v56, 0
    v_mov_b32 v57, 0
    v_mov_b32 v58, 0
    v_mov_b32 v59, 0
    v_mov_b32 v60, 0
    v_mov_b32 v61, 0
    v_mov_b32 v62, 0
    v_mov_b32 v63, 0
    v_lshrrev_b32 v4, 2, v1
    v_lshl_add_u32 v4, v2, 3, v4
    s_mov_b32 s7, 288
    v_mul_lo_u32 v4, v4, s7
    v_and_b32 v5, 3, v1
    v_lshl_add_u32 v23, v5, 3, v4
    s_mul_i32 s4, s4, 288
    v_and_b32 v4, 63, v0
    v_mul_u32_u24 v5, 3641, v4
    v_lshrrev_b32 v5, 16, v5
    v_mul_u32_u24 v6, 18, v5
    v_sub_u32 v6, v4, v6
    s_mov_b32 s66, 3456
    v_mul_lo_u32 v5, v5, s66
    v_lshl_add_u32 v25, v6, 4, v5
    v_lshrrev_b32 v4, 6, v0
    s_nop 1
    v_readfirstlane_b32 s64, v4
    s_nop 3
    s_mul_i32 s65, s64, 864
    s_mul_i32 s67, s64, 10368
    s_add_u32 s67, s67, s4
    buffer_load_dwordx4 v[136:139], v18, s[8:11], 0 offen offset:0
    buffer_load_dwordx4 v[140:143], v18, s[8:11], 0 offen offset:64
    buffer_load_dwordx4 v[144:147], v18, s[8:11], 0 offen offset:128
    buffer_load_dwordx4 v[148:151], v18, s[8:11], 0 offen offset:192
    buffer_load_dwordx4 v[152:155], v18, s[8:11], 0 offen offset:256
    buffer_load_dwordx4 v[156:159], v18, s[8:11], 0 offen offset:320
    buffer_load_dwordx4 v[160:163], v18, s[8:11], 0 offen offset:384
    buffer_load_dwordx4 v[164:167], v18, s[8:11], 0 offen offset:448
    buffer_load_dwordx4 v[168:171], v18, s[8:11], 0 offen offset:512
    buffer_load_dwordx4 v[172:175], v18, s[8:11], 0 offen offset:576
    buffer_load_dwordx4 v[176:179], v18, s[8:11], 0 offen offset:640
    buffer_load_dwordx4 v[180:183], v18, s[8:11], 0 offen offset:704
    buffer_load_dwordx4 v[184:187], v18, s[8:11], 0 offen offset:768
    buffer_load_dwordx4 v[188:191], v18, s[8:11], 0 offen offset:832
    buffer_load_dwordx4 v[192:195], v18, s[8:11], 0 offen offset:896
    buffer_load_dwordx4 v[196:199], v18, s[8:11], 0 offen offset:960
    buffer_load_dwordx4 v[200:203], v18, s[8:11], 0 offen offset:1024
    buffer_load_dwordx4 v[204:207], v18, s[8:11], 0 offen offset:1088
    buffer_load_dwordx4 v[208:211], v18, s[8:11], 0 offen offset:1152
    buffer_load_dwordx4 v[212:215], v18, s[8:11], 0 offen offset:1216
    s_mov_b32 s6, 3456
    v_mul_lo_u32 v24, v10, s6
    v_lshl_add_u32 v24, v2, 3, v24
    v_add_u32 v24, s4, v24
    s_mov_b64 s[68:69], exec
    s_mov_b32 exec_hi, 0x3fffff
    s_add_u32 m0, s65, 0
    s_add_u32 s70, s67, 0
    buffer_load_dwordx4 v25, s[12:15], s70 offen lds
    s_add_u32 m0, s65, 6912
    s_add_u32 s70, s67, 82944
    buffer_load_dwordx4 v25, s[12:15], s70 offen lds
    s_add_u32 m0, s65, 13824
    s_add_u32 s70, s67, 165888
    buffer_load_dwordx4 v25, s[12:15], s70 offen lds
    s_add_u32 m0, s65, 20736
    s_add_u32 s70, s67, 248832
    buffer_load_dwordx4 v25, s[12:15], s70 offen lds
    s_add_u32 m0, s65, 27648
    s_add_u32 s70, s67, 331776
    buffer_load_dwordx4 v25, s[12:15], s70 offen lds
    s_add_u32 m0, s65, 34560
    s_add_u32 s70, s67, 414720
    buffer_load_dwordx4 v25, s[12:15], s70 offen lds
    s_add_u32 m0, s65, 41472
    s_add_u32 s70, s67, 497664
    buffer_load_dwordx4 v25, s[12:15], s70 offen lds
    s_mov_b64 exec, s[68:69]
    s_waitcnt vmcnt(7)
    v_mov_b32 v11, 0
    v_mov_b32 v12, 0
    v_mov_b32 v15, 0x3f803f80
    s_nop 0
    v_dot2c_f32_bf16 v11, v136, v15
    v_dot2c_f32_bf16 v12, v136, v136
    v_dot2c_f32_bf16 v11, v137, v15
    v_dot2c_f32_bf16 v12, v137, v137
    v_dot2c_f32_bf16 v11, v138, v15
    v_dot2c_f32_bf16 v12, v138, v138
    v_dot2c_f32_bf16 v11, v139, v15
    v_dot2c_f32_bf16 v12, v139, v139
    v_dot2c_f32_bf16 v11, v140, v15
    v_dot2c_f32_bf16 v12, v140, v140
    v_dot2c_f32_bf16 v11, v141, v15
    v_dot2c_f32_bf16 v12, v141, v141
    v_dot2c_f32_bf16 v11, v142, v15
    v_dot2c_f32_bf16 v12, v142, v142
    v_dot2c_f32_bf16 v11, v143, v15
    v_dot2c_f32_bf16 v12, v143, v143
    v_dot2c_f32_bf16 v11, v144, v15
    v_dot2c_f32_bf16 v12, v144, v144
    v_dot2c_f32_bf16 v11, v145, v15
    v_dot2c_f32_bf16 v12, v145, v145
    v_dot2c_f32_bf16 v11, v146, v15
    v_dot2c_f32_bf16 v12, v146, v146
    v_dot2c_f32_bf16 v11, v147, v15
    v_dot2c_f32_bf16 v12, v147, v147
    v_dot2c_f32_bf16 v11, v148, v15
    v_dot2c_f32_bf16 v12, v148, v148
    v_dot2c_f32_bf16 v11, v149, v15
    v_dot2c_f32_bf16 v12, v149, v149
    v_dot2c_f32_bf16 v11, v150, v15
    v_dot2c_f32_bf16 v12, v150, v150
    v_dot2c_f32_bf16 v11, v151, v15
    v_dot2c_f32_bf16 v12, v151, v151
    v_dot2c_f32_bf16 v11, v152, v15
    v_dot2c_f32_bf16 v12, v152, v152
    v_dot2c_f32_bf16 v11, v153, v15
    v_dot2c_f32_bf16 v12, v153, v153
    v_dot2c_f32_bf16 v11, v154, v15
    v_dot2c_f32_bf16 v12, v154, v154
    v_dot2c_f32_bf16 v11, v155, v15
    v_dot2c_f32_bf16 v12, v155, v155
    v_dot2c_f32_bf16 v11, v156, v15
    v_dot2c_f32_bf16 v12, v156, v156
    v_dot2c_f32_bf16 v11, v157, v15
    v_dot2c_f32_bf16 v12, v157, v157
    v_dot2c_f32_bf16 v11, v158, v15
    v_dot2c_f32_bf16 v12, v158, v158
    v_dot2c_f32_bf16 v11, v159, v15
    v_dot2c_f32_bf16 v12, v159, v159
    v_dot2c_f32_bf16 v11, v160, v15
    v_dot2c_f32_bf16 v12, v160, v160
    v_dot2c_f32_bf16 v11, v161, v15
    v_dot2c_f32_bf16 v12, v161, v161
    v_dot2c_f32_bf16 v11, v162, v15
    v_dot2c_f32_bf16 v12, v162, v162
    v_dot2c_f32_bf16 v11, v163, v15
    v_dot2c_f32_bf16 v12, v163, v163
    v_dot2c_f32_bf16 v11, v164, v15
    v_dot2c_f32_bf16 v12, v164, v164
    v_dot2c_f32_bf16 v11, v165, v15
    v_dot2c_f32_bf16 v12, v165, v165
    v_dot2c_f32_bf16 v11, v166, v15
    v_dot2c_f32_bf16 v12, v166, v166
    v_dot2c_f32_bf16 v11, v167, v15
    v_dot2c_f32_bf16 v12, v167, v167
    v_dot2c_f32_bf16 v11, v168, v15
    v_dot2c_f32_bf16 v12, v168, v168
    v_dot2c_f32_bf16 v11, v169, v15
    v_dot2c_f32_bf16 v12, v169, v169
    v_dot2c_f32_bf16 v11, v170, v15
    v_dot2c_f32_bf16 v12, v170, v170
    v_dot2c_f32_bf16 v11, v171, v15
    v_dot2c_f32_bf16 v12, v171, v171
    v_dot2c_f32_bf16 v11, v172, v15
    v_dot2c_f32_bf16 v12, v172, v172
    v_dot2c_f32_bf16 v11, v173, v15
    v_dot2c_f32_bf16 v12, v173, v173
    v_dot2c_f32_bf16 v11, v174, v15
    v_dot2c_f32_bf16 v12, v174, v174
    v_dot2c_f32_bf16 v11, v175, v15
    v_dot2c_f32_bf16 v12, v175, v175
    v_dot2c_f32_bf16 v11, v176, v15
    v_dot2c_f32_bf16 v12, v176, v176
    v_dot2c_f32_bf16 v11, v177, v15
    v_dot2c_f32_bf16 v12, v177, v177
    v_dot2c_f32_bf16 v11, v178, v15
    v_dot2c_f32_bf16 v12, v178, v178
    v_dot2c_f32_bf16 v11, v179, v15
    v_dot2c_f32_bf16 v12, v179, v179
    v_dot2c_f32_bf16 v11, v180, v15
    v_dot2c_f32_bf16 v12, v180, v180
    v_dot2c_f32_bf16 v11, v181, v15
    v_dot2c_f32_bf16 v12, v181, v181
    v_dot2c_f32_bf16 v11, v182, v15
    v_dot2c_f32_bf16 v12, v182, v182
    v_dot2c_f32_bf16 v11, v183, v15
    v_dot2c_f32_bf16 v12, v183, v183
    v_dot2c_f32_bf16 v11, v184, v15
    v_dot2c_f32_bf16 v12, v184, v184
    v_dot2c_f32_bf16 v11, v185, v15
    v_dot2c_f32_bf16 v12, v185, v185
    v_dot2c_f32_bf16 v11, v186, v15
    v_dot2c_f32_bf16 v12, v186, v186
    v_dot2c_f32_bf16 v11, v187, v15
    v_dot2c_f32_bf16 v12, v187, v187
    v_dot2c_f32_bf16 v11, v188, v15
    v_dot2c_f32_bf16 v12, v188, v188
    v_dot2c_f32_bf16 v11, v189, v15
    v_dot2c_f32_bf16 v12, v189, v189
    v_dot2c_f32_bf16 v11, v190, v15
    v_dot2c_f32_bf16 v12, v190, v190
    v_dot2c_f32_bf16 v11, v191, v15
    v_dot2c_f32_bf16 v12, v191, v191
    v_dot2c_f32_bf16 v11, v192, v15
    v_dot2c_f32_bf16 v12, v192, v192
    v_dot2c_f32_bf16 v11, v193, v15
    v_dot2c_f32_bf16 v12, v193, v193
    v_dot2c_f32_bf16 v11, v194, v15
    v_dot2c_f32_bf16 v12, v194, v194
    v_dot2c_f32_bf16 v11, v195, v15
    v_dot2c_f32_bf16 v12, v195, v195
    v_dot2c_f32_bf16 v11, v196, v15
    v_dot2c_f32_bf16 v12, v196, v196
    v_dot2c_f32_bf16 v11, v197, v15
    v_dot2c_f32_bf16 v12, v197, v197
    v_dot2c_f32_bf16 v11, v198, v15
    v_dot2c_f32_bf16 v12, v198, v198
    v_dot2c_f32_bf16 v11, v199, v15
    v_dot2c_f32_bf16 v12, v199, v199
    v_dot2c_f32_bf16 v11, v200, v15
    v_dot2c_f32_bf16 v12, v200, v200
    v_dot2c_f32_bf16 v11, v201, v15
    v_dot2c_f32_bf16 v12, v201, v201
    v_dot2c_f32_bf16 v11, v202, v15
    v_dot2c_f32_bf16 v12, v202, v202
    v_dot2c_f32_bf16 v11, v203, v15
    v_dot2c_f32_bf16 v12, v203, v203
    v_dot2c_f32_bf16 v11, v204, v15
    v_dot2c_f32_bf16 v12, v204, v204
    v_dot2c_f32_bf16 v11, v205, v15
    v_dot2c_f32_bf16 v12, v205, v205
    v_dot2c_f32_bf16 v11, v206, v15
    v_dot2c_f32_bf16 v12, v206, v206
    v_dot2c_f32_bf16 v11, v207, v15
    v_dot2c_f32_bf16 v12, v207, v207
    v_dot2c_f32_bf16 v11, v208, v15
    v_dot2c_f32_bf16 v12, v208, v208
    v_dot2c_f32_bf16 v11, v209, v15
    v_dot2c_f32_bf16 v12, v209, v209
    v_dot2c_f32_bf16 v11, v210, v15
    v_dot2c_f32_bf16 v12, v210, v210
    v_dot2c_f32_bf16 v11, v211, v15
    v_dot2c_f32_bf16 v12, v211, v211
    v_dot2c_f32_bf16 v11, v212, v15
    v_dot2c_f32_bf16 v12, v212, v212
    v_dot2c_f32_bf16 v11, v213, v15
    v_dot2c_f32_bf16 v12, v213, v213
    v_dot2c_f32_bf16 v11, v214, v15
    v_dot2c_f32_bf16 v12, v214, v214
    v_dot2c_f32_bf16 v11, v215, v15
    v_dot2c_f32_bf16 v12, v215, v215
    s_nop 3
    ds_swizzle_b32 v3, v11 offset:0x401F
    s_waitcnt lgkmcnt(0)
    v_add_f32 v11, v11, v3
    s_nop 0
    ds_bpermute_b32 v3, v17, v11
    s_waitcnt lgkmcnt(0)
    v_add_f32 v11, v11, v3
    ds_swizzle_b32 v3, v12 offset:0x401F
    s_waitcnt lgkmcnt(0)
    v_add_f32 v12, v12, v3
    s_nop 0
    ds_bpermute_b32 v3, v17, v12
    s_waitcnt lgkmcnt(0)
    v_add_f32 v12, v12, v3
    v_mul_f32 v11, 0x3acccccd, v11
    v_mul_f32 v12, 0x3acccccd, v12
    v_fma_f32 v12, -v11, v11, v12
    v_max_f32 v12, 0, v12
    v_add_f32 v12, 0x3727c5ac, v12
    v_rsq_f32 v13, v12
    s_nop 0
    v_mul_f32 v14, v11, v13
    v_sub_f32 v14, 0, v14
    v_lshlrev_b32 v3, 16, v136
    v_and_b32 v4, 0xffff0000, v136
    v_fma_f32 v3, v3, v13, v14
    v_fma_f32 v4, v4, v13, v14
    v_cvt_pk_bf16_f32 v136, v3, v4
    v_lshlrev_b32 v5, 16, v137
    v_and_b32 v6, 0xffff0000, v137
    v_fma_f32 v5, v5, v13, v14
    v_fma_f32 v6, v6, v13, v14
    v_cvt_pk_bf16_f32 v137, v5, v6
    v_lshlrev_b32 v3, 16, v138
    v_and_b32 v4, 0xffff0000, v138
    v_fma_f32 v3, v3, v13, v14
    v_fma_f32 v4, v4, v13, v14
    v_cvt_pk_bf16_f32 v138, v3, v4
    v_lshlrev_b32 v5, 16, v139
    v_and_b32 v6, 0xffff0000, v139
    v_fma_f32 v5, v5, v13, v14
    v_fma_f32 v6, v6, v13, v14
    v_cvt_pk_bf16_f32 v139, v5, v6
    v_lshlrev_b32 v3, 16, v140
    v_and_b32 v4, 0xffff0000, v140
    v_fma_f32 v3, v3, v13, v14
    v_fma_f32 v4, v4, v13, v14
    v_cvt_pk_bf16_f32 v140, v3, v4
    v_lshlrev_b32 v5, 16, v141
    v_and_b32 v6, 0xffff0000, v141
    v_fma_f32 v5, v5, v13, v14
    v_fma_f32 v6, v6, v13, v14
    v_cvt_pk_bf16_f32 v141, v5, v6
    v_lshlrev_b32 v3, 16, v142
    v_and_b32 v4, 0xffff0000, v142
    v_fma_f32 v3, v3, v13, v14
    v_fma_f32 v4, v4, v13, v14
    v_cvt_pk_bf16_f32 v142, v3, v4
    v_lshlrev_b32 v5, 16, v143
    v_and_b32 v6, 0xffff0000, v143
    v_fma_f32 v5, v5, v13, v14
    v_fma_f32 v6, v6, v13, v14
    v_cvt_pk_bf16_f32 v143, v5, v6
    v_lshlrev_b32 v3, 16, v144
    v_and_b32 v4, 0xffff0000, v144
    v_fma_f32 v3, v3, v13, v14
    v_fma_f32 v4, v4, v13, v14
    v_cvt_pk_bf16_f32 v144, v3, v4
    v_lshlrev_b32 v5, 16, v145
    v_and_b32 v6, 0xffff0000, v145
    v_fma_f32 v5, v5, v13, v14
    v_fma_f32 v6, v6, v13, v14
    v_cvt_pk_bf16_f32 v145, v5, v6
    v_lshlrev_b32 v3, 16, v146
    v_and_b32 v4, 0xffff0000, v146
    v_fma_f32 v3, v3, v13, v14
    v_fma_f32 v4, v4, v13, v14
    v_cvt_pk_bf16_f32 v146, v3, v4
    v_lshlrev_b32 v5, 16, v147
    v_and_b32 v6, 0xffff0000, v147
    v_fma_f32 v5, v5, v13, v14
    v_fma_f32 v6, v6, v13, v14
    v_cvt_pk_bf16_f32 v147, v5, v6
    v_lshlrev_b32 v3, 16, v148
    v_and_b32 v4, 0xffff0000, v148
    v_fma_f32 v3, v3, v13, v14
    v_fma_f32 v4, v4, v13, v14
    v_cvt_pk_bf16_f32 v148, v3, v4
    v_lshlrev_b32 v5, 16, v149
    v_and_b32 v6, 0xffff0000, v149
    v_fma_f32 v5, v5, v13, v14
    v_fma_f32 v6, v6, v13, v14
    v_cvt_pk_bf16_f32 v149, v5, v6
    v_lshlrev_b32 v3, 16, v150
    v_and_b32 v4, 0xffff0000, v150
    v_fma_f32 v3, v3, v13, v14
    v_fma_f32 v4, v4, v13, v14
    v_cvt_pk_bf16_f32 v150, v3, v4
    v_lshlrev_b32 v5, 16, v151
    v_and_b32 v6, 0xffff0000, v151
    v_fma_f32 v5, v5, v13, v14
    v_fma_f32 v6, v6, v13, v14
    v_cvt_pk_bf16_f32 v151, v5, v6
    v_lshlrev_b32 v3, 16, v152
    v_and_b32 v4, 0xffff0000, v152
    v_fma_f32 v3, v3, v13, v14
    v_fma_f32 v4, v4, v13, v14
    v_cvt_pk_bf16_f32 v152, v3, v4
    v_lshlrev_b32 v5, 16, v153
    v_and_b32 v6, 0xffff0000, v153
    v_fma_f32 v5, v5, v13, v14
    v_fma_f32 v6, v6, v13, v14
    v_cvt_pk_bf16_f32 v153, v5, v6
    v_lshlrev_b32 v3, 16, v154
    v_and_b32 v4, 0xffff0000, v154
    v_fma_f32 v3, v3, v13, v14
    v_fma_f32 v4, v4, v13, v14
    v_cvt_pk_bf16_f32 v154, v3, v4
    v_lshlrev_b32 v5, 16, v155
    v_and_b32 v6, 0xffff0000, v155
    v_fma_f32 v5, v5, v13, v14
    v_fma_f32 v6, v6, v13, v14
    v_cvt_pk_bf16_f32 v155, v5, v6
    v_lshlrev_b32 v3, 16, v156
    v_and_b32 v4, 0xffff0000, v156
    v_fma_f32 v3, v3, v13, v14
    v_fma_f32 v4, v4, v13, v14
    v_cvt_pk_bf16_f32 v156, v3, v4
    v_lshlrev_b32 v5, 16, v157
    v_and_b32 v6, 0xffff0000, v157
    v_fma_f32 v5, v5, v13, v14
    v_fma_f32 v6, v6, v13, v14
    v_cvt_pk_bf16_f32 v157, v5, v6
    v_lshlrev_b32 v3, 16, v158
    v_and_b32 v4, 0xffff0000, v158
    v_fma_f32 v3, v3, v13, v14
    v_fma_f32 v4, v4, v13, v14
    v_cvt_pk_bf16_f32 v158, v3, v4
    v_lshlrev_b32 v5, 16, v159
    v_and_b32 v6, 0xffff0000, v159
    v_fma_f32 v5, v5, v13, v14
    v_fma_f32 v6, v6, v13, v14
    v_cvt_pk_bf16_f32 v159, v5, v6
    v_lshlrev_b32 v3, 16, v160
    v_and_b32 v4, 0xffff0000, v160
    v_fma_f32 v3, v3, v13, v14
    v_fma_f32 v4, v4, v13, v14
    v_cvt_pk_bf16_f32 v160, v3, v4
    v_lshlrev_b32 v5, 16, v161
    v_and_b32 v6, 0xffff0000, v161
    v_fma_f32 v5, v5, v13, v14
    v_fma_f32 v6, v6, v13, v14
    v_cvt_pk_bf16_f32 v161, v5, v6
    v_lshlrev_b32 v3, 16, v162
    v_and_b32 v4, 0xffff0000, v162
    v_fma_f32 v3, v3, v13, v14
    v_fma_f32 v4, v4, v13, v14
    v_cvt_pk_bf16_f32 v162, v3, v4
    v_lshlrev_b32 v5, 16, v163
    v_and_b32 v6, 0xffff0000, v163
    v_fma_f32 v5, v5, v13, v14
    v_fma_f32 v6, v6, v13, v14
    v_cvt_pk_bf16_f32 v163, v5, v6
    v_lshlrev_b32 v3, 16, v164
    v_and_b32 v4, 0xffff0000, v164
    v_fma_f32 v3, v3, v13, v14
    v_fma_f32 v4, v4, v13, v14
    v_cvt_pk_bf16_f32 v164, v3, v4
    v_lshlrev_b32 v5, 16, v165
    v_and_b32 v6, 0xffff0000, v165
    v_fma_f32 v5, v5, v13, v14
    v_fma_f32 v6, v6, v13, v14
    v_cvt_pk_bf16_f32 v165, v5, v6
    v_lshlrev_b32 v3, 16, v166
    v_and_b32 v4, 0xffff0000, v166
    v_fma_f32 v3, v3, v13, v14
    v_fma_f32 v4, v4, v13, v14
    v_cvt_pk_bf16_f32 v166, v3, v4
    v_lshlrev_b32 v5, 16, v167
    v_and_b32 v6, 0xffff0000, v167
    v_fma_f32 v5, v5, v13, v14
    v_fma_f32 v6, v6, v13, v14
    v_cvt_pk_bf16_f32 v167, v5, v6
    v_lshlrev_b32 v3, 16, v168
    v_and_b32 v4, 0xffff0000, v168
    v_fma_f32 v3, v3, v13, v14
    v_fma_f32 v4, v4, v13, v14
    v_cvt_pk_bf16_f32 v168, v3, v4
    v_lshlrev_b32 v5, 16, v169
    v_and_b32 v6, 0xffff0000, v169
    v_fma_f32 v5, v5, v13, v14
    v_fma_f32 v6, v6, v13, v14
    v_cvt_pk_bf16_f32 v169, v5, v6
    v_lshlrev_b32 v3, 16, v170
    v_and_b32 v4, 0xffff0000, v170
    v_fma_f32 v3, v3, v13, v14
    v_fma_f32 v4, v4, v13, v14
    v_cvt_pk_bf16_f32 v170, v3, v4
    v_lshlrev_b32 v5, 16, v171
    v_and_b32 v6, 0xffff0000, v171
    v_fma_f32 v5, v5, v13, v14
    v_fma_f32 v6, v6, v13, v14
    v_cvt_pk_bf16_f32 v171, v5, v6
    v_lshlrev_b32 v3, 16, v172
    v_and_b32 v4, 0xffff0000, v172
    v_fma_f32 v3, v3, v13, v14
    v_fma_f32 v4, v4, v13, v14
    v_cvt_pk_bf16_f32 v172, v3, v4
    v_lshlrev_b32 v5, 16, v173
    v_and_b32 v6, 0xffff0000, v173
    v_fma_f32 v5, v5, v13, v14
    v_fma_f32 v6, v6, v13, v14
    v_cvt_pk_bf16_f32 v173, v5, v6
    v_lshlrev_b32 v3, 16, v174
    v_and_b32 v4, 0xffff0000, v174
    v_fma_f32 v3, v3, v13, v14
    v_fma_f32 v4, v4, v13, v14
    v_cvt_pk_bf16_f32 v174, v3, v4
    v_lshlrev_b32 v5, 16, v175
    v_and_b32 v6, 0xffff0000, v175
    v_fma_f32 v5, v5, v13, v14
    v_fma_f32 v6, v6, v13, v14
    v_cvt_pk_bf16_f32 v175, v5, v6
    v_lshlrev_b32 v3, 16, v176
    v_and_b32 v4, 0xffff0000, v176
    v_fma_f32 v3, v3, v13, v14
    v_fma_f32 v4, v4, v13, v14
    v_cvt_pk_bf16_f32 v176, v3, v4
    v_lshlrev_b32 v5, 16, v177
    v_and_b32 v6, 0xffff0000, v177
    v_fma_f32 v5, v5, v13, v14
    v_fma_f32 v6, v6, v13, v14
    v_cvt_pk_bf16_f32 v177, v5, v6
    v_lshlrev_b32 v3, 16, v178
    v_and_b32 v4, 0xffff0000, v178
    v_fma_f32 v3, v3, v13, v14
    v_fma_f32 v4, v4, v13, v14
    v_cvt_pk_bf16_f32 v178, v3, v4
    v_lshlrev_b32 v5, 16, v179
    v_and_b32 v6, 0xffff0000, v179
    v_fma_f32 v5, v5, v13, v14
    v_fma_f32 v6, v6, v13, v14
    v_cvt_pk_bf16_f32 v179, v5, v6
    v_lshlrev_b32 v3, 16, v180
    v_and_b32 v4, 0xffff0000, v180
    v_fma_f32 v3, v3, v13, v14
    v_fma_f32 v4, v4, v13, v14
    v_cvt_pk_bf16_f32 v180, v3, v4
    v_lshlrev_b32 v5, 16, v181
    v_and_b32 v6, 0xffff0000, v181
    v_fma_f32 v5, v5, v13, v14
    v_fma_f32 v6, v6, v13, v14
    v_cvt_pk_bf16_f32 v181, v5, v6
    v_lshlrev_b32 v3, 16, v182
    v_and_b32 v4, 0xffff0000, v182
    v_fma_f32 v3, v3, v13, v14
    v_fma_f32 v4, v4, v13, v14
    v_cvt_pk_bf16_f32 v182, v3, v4
    v_lshlrev_b32 v5, 16, v183
    v_and_b32 v6, 0xffff0000, v183
    v_fma_f32 v5, v5, v13, v14
    v_fma_f32 v6, v6, v13, v14
    v_cvt_pk_bf16_f32 v183, v5, v6
    v_lshlrev_b32 v3, 16, v184
    v_and_b32 v4, 0xffff0000, v184
    v_fma_f32 v3, v3, v13, v14
    v_fma_f32 v4, v4, v13, v14
    v_cvt_pk_bf16_f32 v184, v3, v4
    v_lshlrev_b32 v5, 16, v185
    v_and_b32 v6, 0xffff0000, v185
    v_fma_f32 v5, v5, v13, v14
    v_fma_f32 v6, v6, v13, v14
    v_cvt_pk_bf16_f32 v185, v5, v6
    v_lshlrev_b32 v3, 16, v186
    v_and_b32 v4, 0xffff0000, v186
    v_fma_f32 v3, v3, v13, v14
    v_fma_f32 v4, v4, v13, v14
    v_cvt_pk_bf16_f32 v186, v3, v4
    v_lshlrev_b32 v5, 16, v187
    v_and_b32 v6, 0xffff0000, v187
    v_fma_f32 v5, v5, v13, v14
    v_fma_f32 v6, v6, v13, v14
    v_cvt_pk_bf16_f32 v187, v5, v6
    v_lshlrev_b32 v3, 16, v188
    v_and_b32 v4, 0xffff0000, v188
    v_fma_f32 v3, v3, v13, v14
    v_fma_f32 v4, v4, v13, v14
    v_cvt_pk_bf16_f32 v188, v3, v4
    v_lshlrev_b32 v5, 16, v189
    v_and_b32 v6, 0xffff0000, v189
    v_fma_f32 v5, v5, v13, v14
    v_fma_f32 v6, v6, v13, v14
    v_cvt_pk_bf16_f32 v189, v5, v6
    v_lshlrev_b32 v3, 16, v190
    v_and_b32 v4, 0xffff0000, v190
    v_fma_f32 v3, v3, v13, v14
    v_fma_f32 v4, v4, v13, v14
    v_cvt_pk_bf16_f32 v190, v3, v4
    v_lshlrev_b32 v5, 16, v191
    v_and_b32 v6, 0xffff0000, v191
    v_fma_f32 v5, v5, v13, v14
    v_fma_f32 v6, v6, v13, v14
    v_cvt_pk_bf16_f32 v191, v5, v6
    v_lshlrev_b32 v3, 16, v192
    v_and_b32 v4, 0xffff0000, v192
    v_fma_f32 v3, v3, v13, v14
    v_fma_f32 v4, v4, v13, v14
    v_cvt_pk_bf16_f32 v192, v3, v4
    v_lshlrev_b32 v5, 16, v193
    v_and_b32 v6, 0xffff0000, v193
    v_fma_f32 v5, v5, v13, v14
    v_fma_f32 v6, v6, v13, v14
    v_cvt_pk_bf16_f32 v193, v5, v6
    v_lshlrev_b32 v3, 16, v194
    v_and_b32 v4, 0xffff0000, v194
    v_fma_f32 v3, v3, v13, v14
    v_fma_f32 v4, v4, v13, v14
    v_cvt_pk_bf16_f32 v194, v3, v4
    v_lshlrev_b32 v5, 16, v195
    v_and_b32 v6, 0xffff0000, v195
    v_fma_f32 v5, v5, v13, v14
    v_fma_f32 v6, v6, v13, v14
    v_cvt_pk_bf16_f32 v195, v5, v6
    v_lshlrev_b32 v3, 16, v196
    v_and_b32 v4, 0xffff0000, v196
    v_fma_f32 v3, v3, v13, v14
    v_fma_f32 v4, v4, v13, v14
    v_cvt_pk_bf16_f32 v196, v3, v4
    v_lshlrev_b32 v5, 16, v197
    v_and_b32 v6, 0xffff0000, v197
    v_fma_f32 v5, v5, v13, v14
    v_fma_f32 v6, v6, v13, v14
    v_cvt_pk_bf16_f32 v197, v5, v6
    v_lshlrev_b32 v3, 16, v198
    v_and_b32 v4, 0xffff0000, v198
    v_fma_f32 v3, v3, v13, v14
    v_fma_f32 v4, v4, v13, v14
    v_cvt_pk_bf16_f32 v198, v3, v4
    v_lshlrev_b32 v5, 16, v199
    v_and_b32 v6, 0xffff0000, v199
    v_fma_f32 v5, v5, v13, v14
    v_fma_f32 v6, v6, v13, v14
    v_cvt_pk_bf16_f32 v199, v5, v6
    v_lshlrev_b32 v3, 16, v200
    v_and_b32 v4, 0xffff0000, v200
    v_fma_f32 v3, v3, v13, v14
    v_fma_f32 v4, v4, v13, v14
    v_cvt_pk_bf16_f32 v200, v3, v4
    v_lshlrev_b32 v5, 16, v201
    v_and_b32 v6, 0xffff0000, v201
    v_fma_f32 v5, v5, v13, v14
    v_fma_f32 v6, v6, v13, v14
    v_cvt_pk_bf16_f32 v201, v5, v6
    v_lshlrev_b32 v3, 16, v202
    v_and_b32 v4, 0xffff0000, v202
    v_fma_f32 v3, v3, v13, v14
    v_fma_f32 v4, v4, v13, v14
    v_cvt_pk_bf16_f32 v202, v3, v4
    v_lshlrev_b32 v5, 16, v203
    v_and_b32 v6, 0xffff0000, v203
    v_fma_f32 v5, v5, v13, v14
    v_fma_f32 v6, v6, v13, v14
    v_cvt_pk_bf16_f32 v203, v5, v6
    v_lshlrev_b32 v3, 16, v204
    v_and_b32 v4, 0xffff0000, v204
    v_fma_f32 v3, v3, v13, v14
    v_fma_f32 v4, v4, v13, v14
    v_cvt_pk_bf16_f32 v204, v3, v4
    v_lshlrev_b32 v5, 16, v205
    v_and_b32 v6, 0xffff0000, v205
    v_fma_f32 v5, v5, v13, v14
    v_fma_f32 v6, v6, v13, v14
    v_cvt_pk_bf16_f32 v205, v5, v6
    v_lshlrev_b32 v3, 16, v206
    v_and_b32 v4, 0xffff0000, v206
    v_fma_f32 v3, v3, v13, v14
    v_fma_f32 v4, v4, v13, v14
    v_cvt_pk_bf16_f32 v206, v3, v4
    v_lshlrev_b32 v5, 16, v207
    v_and_b32 v6, 0xffff0000, v207
    v_fma_f32 v5, v5, v13, v14
    v_fma_f32 v6, v6, v13, v14
    v_cvt_pk_bf16_f32 v207, v5, v6
    v_lshlrev_b32 v3, 16, v208
    v_and_b32 v4, 0xffff0000, v208
    v_fma_f32 v3, v3, v13, v14
    v_fma_f32 v4, v4, v13, v14
    v_cvt_pk_bf16_f32 v208, v3, v4
    v_lshlrev_b32 v5, 16, v209
    v_and_b32 v6, 0xffff0000, v209
    v_fma_f32 v5, v5, v13, v14
    v_fma_f32 v6, v6, v13, v14
    v_cvt_pk_bf16_f32 v209, v5, v6
    v_lshlrev_b32 v3, 16, v210
    v_and_b32 v4, 0xffff0000, v210
    v_fma_f32 v3, v3, v13, v14
    v_fma_f32 v4, v4, v13, v14
    v_cvt_pk_bf16_f32 v210, v3, v4
    v_lshlrev_b32 v5, 16, v211
    v_and_b32 v6, 0xffff0000, v211
    v_fma_f32 v5, v5, v13, v14
    v_fma_f32 v6, v6, v13, v14
    v_cvt_pk_bf16_f32 v211, v5, v6
    v_lshlrev_b32 v3, 16, v212
    v_and_b32 v4, 0xffff0000, v212
    v_fma_f32 v3, v3, v13, v14
    v_fma_f32 v4, v4, v13, v14
    v_cvt_pk_bf16_f32 v212, v3, v4
    v_lshlrev_b32 v5, 16, v213
    v_and_b32 v6, 0xffff0000, v213
    v_fma_f32 v5, v5, v13, v14
    v_fma_f32 v6, v6, v13, v14
    v_cvt_pk_bf16_f32 v213, v5, v6
    v_lshlrev_b32 v3, 16, v214
    v_and_b32 v4, 0xffff0000, v214
    v_fma_f32 v3, v3, v13, v14
    v_fma_f32 v4, v4, v13, v14
    v_cvt_pk_bf16_f32 v214, v3, v4
    v_lshlrev_b32 v5, 16, v215
    v_and_b32 v6, 0xffff0000, v215
    v_fma_f32 v5, v5, v13, v14
    v_fma_f32 v6, v6, v13, v14
    v_cvt_pk_bf16_f32 v215, v5, v6
    s_mov_b64 s[68:69], exec
    s_mov_b32 exec_hi, 0x3fffff
    s_add_u32 m0, s65, 48384
    s_add_u32 s70, s67, 552960
    buffer_load_dwordx4 v25, s[12:15], s70 offen lds
    s_add_u32 m0, s65, 55296
    s_add_u32 s70, s67, 635904
    buffer_load_dwordx4 v25, s[12:15], s70 offen lds
    s_add_u32 m0, s65, 62208
    s_add_u32 s70, s67, 718848
    buffer_load_dwordx4 v25, s[12:15], s70 offen lds
    s_add_u32 m0, s65, 69120
    s_add_u32 s70, s67, 801792
    buffer_load_dwordx4 v25, s[12:15], s70 offen lds
    s_add_u32 m0, s65, 76032
    s_add_u32 s70, s67, 884736
    buffer_load_dwordx4 v25, s[12:15], s70 offen lds
    s_add_u32 m0, s65, 82944
    s_add_u32 s70, s67, 967680
    buffer_load_dwordx4 v25, s[12:15], s70 offen lds
    s_add_u32 m0, s65, 89856
    s_add_u32 s70, s67, 1050624
    buffer_load_dwordx4 v25, s[12:15], s70 offen lds
    s_mov_b64 exec, s[68:69]
    s_waitcnt vmcnt(7)
    s_barrier
    v_add_u32 v22, 0, v23
    ds_read_b64_tr_b16 v[64:65], v22 offset:0
    ds_read_b64_tr_b16 v[66:67], v22 offset:1152
    ds_read_b64_tr_b16 v[68:69], v22 offset:32
    ds_read_b64_tr_b16 v[70:71], v22 offset:1184
    ds_read_b64_tr_b16 v[72:73], v22 offset:64
    ds_read_b64_tr_b16 v[74:75], v22 offset:1216
    ds_read_b64_tr_b16 v[76:77], v22 offset:96
    ds_read_b64_tr_b16 v[78:79], v22 offset:1248
    ds_read_b64_tr_b16 v[80:81], v22 offset:128
    ds_read_b64_tr_b16 v[82:83], v22 offset:1280
    ds_read_b64_tr_b16 v[84:85], v22 offset:160
    ds_read_b64_tr_b16 v[86:87], v22 offset:1312
    ds_read_b64_tr_b16 v[88:89], v22 offset:192
    ds_read_b64_tr_b16 v[90:91], v22 offset:1344
    ds_read_b64_tr_b16 v[92:93], v22 offset:224
    ds_read_b64_tr_b16 v[94:95], v22 offset:1376
    ds_read_b64_tr_b16 v[96:97], v22 offset:256
    ds_read_b64_tr_b16 v[98:99], v22 offset:1408
    v_add_u32 v22, 9216, v23
    ds_read_b64_tr_b16 v[100:101], v22 offset:0
    ds_read_b64_tr_b16 v[102:103], v22 offset:1152
    ds_read_b64_tr_b16 v[104:105], v22 offset:32
    ds_read_b64_tr_b16 v[106:107], v22 offset:1184
    ds_read_b64_tr_b16 v[108:109], v22 offset:64
    ds_read_b64_tr_b16 v[110:111], v22 offset:1216
    ds_read_b64_tr_b16 v[112:113], v22 offset:96
    ds_read_b64_tr_b16 v[114:115], v22 offset:1248
    ds_read_b64_tr_b16 v[116:117], v22 offset:128
    ds_read_b64_tr_b16 v[118:119], v22 offset:1280
    ds_read_b64_tr_b16 v[120:121], v22 offset:160
    ds_read_b64_tr_b16 v[122:123], v22 offset:1312
    ds_read_b64_tr_b16 v[124:125], v22 offset:192
    ds_read_b64_tr_b16 v[126:127], v22 offset:1344
    ds_read_b64_tr_b16 v[128:129], v22 offset:224
    ds_read_b64_tr_b16 v[130:131], v22 offset:1376
    ds_read_b64_tr_b16 v[132:133], v22 offset:256
    ds_read_b64_tr_b16 v[134:135], v22 offset:1408
    s_waitcnt lgkmcnt(0)
    v_mfma_f32_16x16x32_bf16 v[28:31], v[64:67], v[136:139], v[28:31]
    v_mfma_f32_16x16x32_bf16 v[32:35], v[68:71], v[136:139], v[32:35]
    v_mfma_f32_16x16x32_bf16 v[36:39], v[72:75], v[136:139], v[36:39]
    v_mfma_f32_16x16x32_bf16 v[40:43], v[76:79], v[136:139], v[40:43]
    v_mfma_f32_16x16x32_bf16 v[44:47], v[80:83], v[136:139], v[44:47]
    v_mfma_f32_16x16x32_bf16 v[48:51], v[84:87], v[136:139], v[48:51]
    v_mfma_f32_16x16x32_bf16 v[52:55], v[88:91], v[136:139], v[52:55]
    v_mfma_f32_16x16x32_bf16 v[56:59], v[92:95], v[136:139], v[56:59]
    v_mfma_f32_16x16x32_bf16 v[60:63], v[96:99], v[136:139], v[60:63]
    v_add_u32 v22, 18432, v23
    ds_read_b64_tr_b16 v[64:65], v22 offset:0
    ds_read_b64_tr_b16 v[66:67], v22 offset:1152
    ds_read_b64_tr_b16 v[68:69], v22 offset:32
    ds_read_b64_tr_b16 v[70:71], v22 offset:1184
    ds_read_b64_tr_b16 v[72:73], v22 offset:64
    ds_read_b64_tr_b16 v[74:75], v22 offset:1216
    ds_read_b64_tr_b16 v[76:77], v22 offset:96
    ds_read_b64_tr_b16 v[78:79], v22 offset:1248
    ds_read_b64_tr_b16 v[80:81], v22 offset:128
    ds_read_b64_tr_b16 v[82:83], v22 offset:1280
    ds_read_b64_tr_b16 v[84:85], v22 offset:160
    ds_read_b64_tr_b16 v[86:87], v22 offset:1312
    ds_read_b64_tr_b16 v[88:89], v22 offset:192
    ds_read_b64_tr_b16 v[90:91], v22 offset:1344
    ds_read_b64_tr_b16 v[92:93], v22 offset:224
    ds_read_b64_tr_b16 v[94:95], v22 offset:1376
    ds_read_b64_tr_b16 v[96:97], v22 offset:256
    ds_read_b64_tr_b16 v[98:99], v22 offset:1408
    s_waitcnt lgkmcnt(0)
    v_mfma_f32_16x16x32_bf16 v[28:31], v[100:103], v[140:143], v[28:31]
    v_mfma_f32_16x16x32_bf16 v[32:35], v[104:107], v[140:143], v[32:35]
    v_mfma_f32_16x16x32_bf16 v[36:39], v[108:111], v[140:143], v[36:39]
    v_mfma_f32_16x16x32_bf16 v[40:43], v[112:115], v[140:143], v[40:43]
    v_mfma_f32_16x16x32_bf16 v[44:47], v[116:119], v[140:143], v[44:47]
    v_mfma_f32_16x16x32_bf16 v[48:51], v[120:123], v[140:143], v[48:51]
    v_mfma_f32_16x16x32_bf16 v[52:55], v[124:127], v[140:143], v[52:55]
    v_mfma_f32_16x16x32_bf16 v[56:59], v[128:131], v[140:143], v[56:59]
    v_mfma_f32_16x16x32_bf16 v[60:63], v[132:135], v[140:143], v[60:63]
    v_add_u32 v22, 27648, v23
    ds_read_b64_tr_b16 v[100:101], v22 offset:0
    ds_read_b64_tr_b16 v[102:103], v22 offset:1152
    ds_read_b64_tr_b16 v[104:105], v22 offset:32
    ds_read_b64_tr_b16 v[106:107], v22 offset:1184
    ds_read_b64_tr_b16 v[108:109], v22 offset:64
    ds_read_b64_tr_b16 v[110:111], v22 offset:1216
    ds_read_b64_tr_b16 v[112:113], v22 offset:96
    ds_read_b64_tr_b16 v[114:115], v22 offset:1248
    ds_read_b64_tr_b16 v[116:117], v22 offset:128
    ds_read_b64_tr_b16 v[118:119], v22 offset:1280
    ds_read_b64_tr_b16 v[120:121], v22 offset:160
    ds_read_b64_tr_b16 v[122:123], v22 offset:1312
    ds_read_b64_tr_b16 v[124:125], v22 offset:192
    ds_read_b64_tr_b16 v[126:127], v22 offset:1344
    ds_read_b64_tr_b16 v[128:129], v22 offset:224
    ds_read_b64_tr_b16 v[130:131], v22 offset:1376
    ds_read_b64_tr_b16 v[132:133], v22 offset:256
    ds_read_b64_tr_b16 v[134:135], v22 offset:1408
    s_waitcnt lgkmcnt(0)
    v_mfma_f32_16x16x32_bf16 v[28:31], v[64:67], v[144:147], v[28:31]
    v_mfma_f32_16x16x32_bf16 v[32:35], v[68:71], v[144:147], v[32:35]
    v_mfma_f32_16x16x32_bf16 v[36:39], v[72:75], v[144:147], v[36:39]
    v_mfma_f32_16x16x32_bf16 v[40:43], v[76:79], v[144:147], v[40:43]
    v_mfma_f32_16x16x32_bf16 v[44:47], v[80:83], v[144:147], v[44:47]
    v_mfma_f32_16x16x32_bf16 v[48:51], v[84:87], v[144:147], v[48:51]
    v_mfma_f32_16x16x32_bf16 v[52:55], v[88:91], v[144:147], v[52:55]
    v_mfma_f32_16x16x32_bf16 v[56:59], v[92:95], v[144:147], v[56:59]
    v_mfma_f32_16x16x32_bf16 v[60:63], v[96:99], v[144:147], v[60:63]
    v_add_u32 v22, 36864, v23
    ds_read_b64_tr_b16 v[64:65], v22 offset:0
    ds_read_b64_tr_b16 v[66:67], v22 offset:1152
    ds_read_b64_tr_b16 v[68:69], v22 offset:32
    ds_read_b64_tr_b16 v[70:71], v22 offset:1184
    ds_read_b64_tr_b16 v[72:73], v22 offset:64
    ds_read_b64_tr_b16 v[74:75], v22 offset:1216
    ds_read_b64_tr_b16 v[76:77], v22 offset:96
    ds_read_b64_tr_b16 v[78:79], v22 offset:1248
    ds_read_b64_tr_b16 v[80:81], v22 offset:128
    ds_read_b64_tr_b16 v[82:83], v22 offset:1280
    ds_read_b64_tr_b16 v[84:85], v22 offset:160
    ds_read_b64_tr_b16 v[86:87], v22 offset:1312
    ds_read_b64_tr_b16 v[88:89], v22 offset:192
    ds_read_b64_tr_b16 v[90:91], v22 offset:1344
    ds_read_b64_tr_b16 v[92:93], v22 offset:224
    ds_read_b64_tr_b16 v[94:95], v22 offset:1376
    ds_read_b64_tr_b16 v[96:97], v22 offset:256
    ds_read_b64_tr_b16 v[98:99], v22 offset:1408
    s_waitcnt lgkmcnt(0)
    v_mfma_f32_16x16x32_bf16 v[28:31], v[100:103], v[148:151], v[28:31]
    v_mfma_f32_16x16x32_bf16 v[32:35], v[104:107], v[148:151], v[32:35]
    v_mfma_f32_16x16x32_bf16 v[36:39], v[108:111], v[148:151], v[36:39]
    v_mfma_f32_16x16x32_bf16 v[40:43], v[112:115], v[148:151], v[40:43]
    v_mfma_f32_16x16x32_bf16 v[44:47], v[116:119], v[148:151], v[44:47]
    v_mfma_f32_16x16x32_bf16 v[48:51], v[120:123], v[148:151], v[48:51]
    v_mfma_f32_16x16x32_bf16 v[52:55], v[124:127], v[148:151], v[52:55]
    v_mfma_f32_16x16x32_bf16 v[56:59], v[128:131], v[148:151], v[56:59]
    v_mfma_f32_16x16x32_bf16 v[60:63], v[132:135], v[148:151], v[60:63]
    s_waitcnt lgkmcnt(0)
    v_mfma_f32_16x16x32_bf16 v[28:31], v[64:67], v[152:155], v[28:31]
    v_mfma_f32_16x16x32_bf16 v[32:35], v[68:71], v[152:155], v[32:35]
    v_mfma_f32_16x16x32_bf16 v[36:39], v[72:75], v[152:155], v[36:39]
    v_mfma_f32_16x16x32_bf16 v[40:43], v[76:79], v[152:155], v[40:43]
    v_mfma_f32_16x16x32_bf16 v[44:47], v[80:83], v[152:155], v[44:47]
    v_mfma_f32_16x16x32_bf16 v[48:51], v[84:87], v[152:155], v[48:51]
    v_mfma_f32_16x16x32_bf16 v[52:55], v[88:91], v[152:155], v[52:55]
    v_mfma_f32_16x16x32_bf16 v[56:59], v[92:95], v[152:155], v[56:59]
    v_mfma_f32_16x16x32_bf16 v[60:63], v[96:99], v[152:155], v[60:63]
    s_barrier
    s_mov_b64 s[68:69], exec
    s_mov_b32 exec_hi, 0x3fffff
    s_add_u32 m0, s65, 0
    s_add_u32 s70, s67, 1105920
    buffer_load_dwordx4 v25, s[12:15], s70 offen lds
    s_add_u32 m0, s65, 6912
    s_add_u32 s70, s67, 1188864
    buffer_load_dwordx4 v25, s[12:15], s70 offen lds
    s_add_u32 m0, s65, 13824
    s_add_u32 s70, s67, 1271808
    buffer_load_dwordx4 v25, s[12:15], s70 offen lds
    s_add_u32 m0, s65, 20736
    s_add_u32 s70, s67, 1354752
    buffer_load_dwordx4 v25, s[12:15], s70 offen lds
    s_add_u32 m0, s65, 27648
    s_add_u32 s70, s67, 1437696
    buffer_load_dwordx4 v25, s[12:15], s70 offen lds
    s_add_u32 m0, s65, 34560
    s_add_u32 s70, s67, 1520640
    buffer_load_dwordx4 v25, s[12:15], s70 offen lds
    s_add_u32 m0, s65, 41472
    s_add_u32 s70, s67, 1603584
    buffer_load_dwordx4 v25, s[12:15], s70 offen lds
    s_mov_b64 exec, s[68:69]
    s_waitcnt vmcnt(7)
    s_barrier
    v_add_u32 v22, 48384, v23
    ds_read_b64_tr_b16 v[64:65], v22 offset:0
    ds_read_b64_tr_b16 v[66:67], v22 offset:1152
    ds_read_b64_tr_b16 v[68:69], v22 offset:32
    ds_read_b64_tr_b16 v[70:71], v22 offset:1184
    ds_read_b64_tr_b16 v[72:73], v22 offset:64
    ds_read_b64_tr_b16 v[74:75], v22 offset:1216
    ds_read_b64_tr_b16 v[76:77], v22 offset:96
    ds_read_b64_tr_b16 v[78:79], v22 offset:1248
    ds_read_b64_tr_b16 v[80:81], v22 offset:128
    ds_read_b64_tr_b16 v[82:83], v22 offset:1280
    ds_read_b64_tr_b16 v[84:85], v22 offset:160
    ds_read_b64_tr_b16 v[86:87], v22 offset:1312
    ds_read_b64_tr_b16 v[88:89], v22 offset:192
    ds_read_b64_tr_b16 v[90:91], v22 offset:1344
    ds_read_b64_tr_b16 v[92:93], v22 offset:224
    ds_read_b64_tr_b16 v[94:95], v22 offset:1376
    ds_read_b64_tr_b16 v[96:97], v22 offset:256
    ds_read_b64_tr_b16 v[98:99], v22 offset:1408
    v_add_u32 v22, 57600, v23
    ds_read_b64_tr_b16 v[100:101], v22 offset:0
    ds_read_b64_tr_b16 v[102:103], v22 offset:1152
    ds_read_b64_tr_b16 v[104:105], v22 offset:32
    ds_read_b64_tr_b16 v[106:107], v22 offset:1184
    ds_read_b64_tr_b16 v[108:109], v22 offset:64
    ds_read_b64_tr_b16 v[110:111], v22 offset:1216
    ds_read_b64_tr_b16 v[112:113], v22 offset:96
    ds_read_b64_tr_b16 v[114:115], v22 offset:1248
    ds_read_b64_tr_b16 v[116:117], v22 offset:128
    ds_read_b64_tr_b16 v[118:119], v22 offset:1280
    ds_read_b64_tr_b16 v[120:121], v22 offset:160
    ds_read_b64_tr_b16 v[122:123], v22 offset:1312
    ds_read_b64_tr_b16 v[124:125], v22 offset:192
    ds_read_b64_tr_b16 v[126:127], v22 offset:1344
    ds_read_b64_tr_b16 v[128:129], v22 offset:224
    ds_read_b64_tr_b16 v[130:131], v22 offset:1376
    ds_read_b64_tr_b16 v[132:133], v22 offset:256
    ds_read_b64_tr_b16 v[134:135], v22 offset:1408
    s_waitcnt lgkmcnt(0)
    v_mfma_f32_16x16x32_bf16 v[28:31], v[64:67], v[156:159], v[28:31]
    v_mfma_f32_16x16x32_bf16 v[32:35], v[68:71], v[156:159], v[32:35]
    v_mfma_f32_16x16x32_bf16 v[36:39], v[72:75], v[156:159], v[36:39]
    v_mfma_f32_16x16x32_bf16 v[40:43], v[76:79], v[156:159], v[40:43]
    v_mfma_f32_16x16x32_bf16 v[44:47], v[80:83], v[156:159], v[44:47]
    v_mfma_f32_16x16x32_bf16 v[48:51], v[84:87], v[156:159], v[48:51]
    v_mfma_f32_16x16x32_bf16 v[52:55], v[88:91], v[156:159], v[52:55]
    v_mfma_f32_16x16x32_bf16 v[56:59], v[92:95], v[156:159], v[56:59]
    v_mfma_f32_16x16x32_bf16 v[60:63], v[96:99], v[156:159], v[60:63]
    v_add_u32 v22, 66816, v23
    ds_read_b64_tr_b16 v[64:65], v22 offset:0
    ds_read_b64_tr_b16 v[66:67], v22 offset:1152
    ds_read_b64_tr_b16 v[68:69], v22 offset:32
    ds_read_b64_tr_b16 v[70:71], v22 offset:1184
    ds_read_b64_tr_b16 v[72:73], v22 offset:64
    ds_read_b64_tr_b16 v[74:75], v22 offset:1216
    ds_read_b64_tr_b16 v[76:77], v22 offset:96
    ds_read_b64_tr_b16 v[78:79], v22 offset:1248
    ds_read_b64_tr_b16 v[80:81], v22 offset:128
    ds_read_b64_tr_b16 v[82:83], v22 offset:1280
    ds_read_b64_tr_b16 v[84:85], v22 offset:160
    ds_read_b64_tr_b16 v[86:87], v22 offset:1312
    ds_read_b64_tr_b16 v[88:89], v22 offset:192
    ds_read_b64_tr_b16 v[90:91], v22 offset:1344
    ds_read_b64_tr_b16 v[92:93], v22 offset:224
    ds_read_b64_tr_b16 v[94:95], v22 offset:1376
    ds_read_b64_tr_b16 v[96:97], v22 offset:256
    ds_read_b64_tr_b16 v[98:99], v22 offset:1408
    s_waitcnt lgkmcnt(0)
    v_mfma_f32_16x16x32_bf16 v[28:31], v[100:103], v[160:163], v[28:31]
    v_mfma_f32_16x16x32_bf16 v[32:35], v[104:107], v[160:163], v[32:35]
    v_mfma_f32_16x16x32_bf16 v[36:39], v[108:111], v[160:163], v[36:39]
    v_mfma_f32_16x16x32_bf16 v[40:43], v[112:115], v[160:163], v[40:43]
    v_mfma_f32_16x16x32_bf16 v[44:47], v[116:119], v[160:163], v[44:47]
    v_mfma_f32_16x16x32_bf16 v[48:51], v[120:123], v[160:163], v[48:51]
    v_mfma_f32_16x16x32_bf16 v[52:55], v[124:127], v[160:163], v[52:55]
    v_mfma_f32_16x16x32_bf16 v[56:59], v[128:131], v[160:163], v[56:59]
    v_mfma_f32_16x16x32_bf16 v[60:63], v[132:135], v[160:163], v[60:63]
    v_add_u32 v22, 76032, v23
    ds_read_b64_tr_b16 v[100:101], v22 offset:0
    ds_read_b64_tr_b16 v[102:103], v22 offset:1152
    ds_read_b64_tr_b16 v[104:105], v22 offset:32
    ds_read_b64_tr_b16 v[106:107], v22 offset:1184
    ds_read_b64_tr_b16 v[108:109], v22 offset:64
    ds_read_b64_tr_b16 v[110:111], v22 offset:1216
    ds_read_b64_tr_b16 v[112:113], v22 offset:96
    ds_read_b64_tr_b16 v[114:115], v22 offset:1248
    ds_read_b64_tr_b16 v[116:117], v22 offset:128
    ds_read_b64_tr_b16 v[118:119], v22 offset:1280
    ds_read_b64_tr_b16 v[120:121], v22 offset:160
    ds_read_b64_tr_b16 v[122:123], v22 offset:1312
    ds_read_b64_tr_b16 v[124:125], v22 offset:192
    ds_read_b64_tr_b16 v[126:127], v22 offset:1344
    ds_read_b64_tr_b16 v[128:129], v22 offset:224
    ds_read_b64_tr_b16 v[130:131], v22 offset:1376
    ds_read_b64_tr_b16 v[132:133], v22 offset:256
    ds_read_b64_tr_b16 v[134:135], v22 offset:1408
    s_waitcnt lgkmcnt(0)
    v_mfma_f32_16x16x32_bf16 v[28:31], v[64:67], v[164:167], v[28:31]
    v_mfma_f32_16x16x32_bf16 v[32:35], v[68:71], v[164:167], v[32:35]
    v_mfma_f32_16x16x32_bf16 v[36:39], v[72:75], v[164:167], v[36:39]
    v_mfma_f32_16x16x32_bf16 v[40:43], v[76:79], v[164:167], v[40:43]
    v_mfma_f32_16x16x32_bf16 v[44:47], v[80:83], v[164:167], v[44:47]
    v_mfma_f32_16x16x32_bf16 v[48:51], v[84:87], v[164:167], v[48:51]
    v_mfma_f32_16x16x32_bf16 v[52:55], v[88:91], v[164:167], v[52:55]
    v_mfma_f32_16x16x32_bf16 v[56:59], v[92:95], v[164:167], v[56:59]
    v_mfma_f32_16x16x32_bf16 v[60:63], v[96:99], v[164:167], v[60:63]
    v_add_u32 v22, 85248, v23
    ds_read_b64_tr_b16 v[64:65], v22 offset:0
    ds_read_b64_tr_b16 v[66:67], v22 offset:1152
    ds_read_b64_tr_b16 v[68:69], v22 offset:32
    ds_read_b64_tr_b16 v[70:71], v22 offset:1184
    ds_read_b64_tr_b16 v[72:73], v22 offset:64
    ds_read_b64_tr_b16 v[74:75], v22 offset:1216
    ds_read_b64_tr_b16 v[76:77], v22 offset:96
    ds_read_b64_tr_b16 v[78:79], v22 offset:1248
    ds_read_b64_tr_b16 v[80:81], v22 offset:128
    ds_read_b64_tr_b16 v[82:83], v22 offset:1280
    ds_read_b64_tr_b16 v[84:85], v22 offset:160
    ds_read_b64_tr_b16 v[86:87], v22 offset:1312
    ds_read_b64_tr_b16 v[88:89], v22 offset:192
    ds_read_b64_tr_b16 v[90:91], v22 offset:1344
    ds_read_b64_tr_b16 v[92:93], v22 offset:224
    ds_read_b64_tr_b16 v[94:95], v22 offset:1376
    ds_read_b64_tr_b16 v[96:97], v22 offset:256
    ds_read_b64_tr_b16 v[98:99], v22 offset:1408
    s_waitcnt lgkmcnt(0)
    v_mfma_f32_16x16x32_bf16 v[28:31], v[100:103], v[168:171], v[28:31]
    v_mfma_f32_16x16x32_bf16 v[32:35], v[104:107], v[168:171], v[32:35]
    v_mfma_f32_16x16x32_bf16 v[36:39], v[108:111], v[168:171], v[36:39]
    v_mfma_f32_16x16x32_bf16 v[40:43], v[112:115], v[168:171], v[40:43]
    v_mfma_f32_16x16x32_bf16 v[44:47], v[116:119], v[168:171], v[44:47]
    v_mfma_f32_16x16x32_bf16 v[48:51], v[120:123], v[168:171], v[48:51]
    v_mfma_f32_16x16x32_bf16 v[52:55], v[124:127], v[168:171], v[52:55]
    v_mfma_f32_16x16x32_bf16 v[56:59], v[128:131], v[168:171], v[56:59]
    v_mfma_f32_16x16x32_bf16 v[60:63], v[132:135], v[168:171], v[60:63]
    s_waitcnt lgkmcnt(0)
    v_mfma_f32_16x16x32_bf16 v[28:31], v[64:67], v[172:175], v[28:31]
    v_mfma_f32_16x16x32_bf16 v[32:35], v[68:71], v[172:175], v[32:35]
    v_mfma_f32_16x16x32_bf16 v[36:39], v[72:75], v[172:175], v[36:39]
    v_mfma_f32_16x16x32_bf16 v[40:43], v[76:79], v[172:175], v[40:43]
    v_mfma_f32_16x16x32_bf16 v[44:47], v[80:83], v[172:175], v[44:47]
    v_mfma_f32_16x16x32_bf16 v[48:51], v[84:87], v[172:175], v[48:51]
    v_mfma_f32_16x16x32_bf16 v[52:55], v[88:91], v[172:175], v[52:55]
    v_mfma_f32_16x16x32_bf16 v[56:59], v[92:95], v[172:175], v[56:59]
    v_mfma_f32_16x16x32_bf16 v[60:63], v[96:99], v[172:175], v[60:63]
    s_barrier
    s_mov_b64 s[68:69], exec
    s_mov_b32 exec_hi, 0x3fffff
    s_add_u32 m0, s65, 48384
    s_add_u32 s70, s67, 1658880
    buffer_load_dwordx4 v25, s[12:15], s70 offen lds
    s_add_u32 m0, s65, 55296
    s_add_u32 s70, s67, 1741824
    buffer_load_dwordx4 v25, s[12:15], s70 offen lds
    s_add_u32 m0, s65, 62208
    s_add_u32 s70, s67, 1824768
    buffer_load_dwordx4 v25, s[12:15], s70 offen lds
    s_add_u32 m0, s65, 69120
    s_add_u32 s70, s67, 1907712
    buffer_load_dwordx4 v25, s[12:15], s70 offen lds
    s_add_u32 m0, s65, 76032
    s_add_u32 s70, s67, 1990656
    buffer_load_dwordx4 v25, s[12:15], s70 offen lds
    s_add_u32 m0, s65, 82944
    s_add_u32 s70, s67, 2073600
    buffer_load_dwordx4 v25, s[12:15], s70 offen lds
    s_add_u32 m0, s65, 89856
    s_add_u32 s70, s67, 2156544
    buffer_load_dwordx4 v25, s[12:15], s70 offen lds
    s_mov_b64 exec, s[68:69]
    s_waitcnt vmcnt(7)
    s_barrier
    v_add_u32 v22, 0, v23
    ds_read_b64_tr_b16 v[64:65], v22 offset:0
    ds_read_b64_tr_b16 v[66:67], v22 offset:1152
    ds_read_b64_tr_b16 v[68:69], v22 offset:32
    ds_read_b64_tr_b16 v[70:71], v22 offset:1184
    ds_read_b64_tr_b16 v[72:73], v22 offset:64
    ds_read_b64_tr_b16 v[74:75], v22 offset:1216
    ds_read_b64_tr_b16 v[76:77], v22 offset:96
    ds_read_b64_tr_b16 v[78:79], v22 offset:1248
    ds_read_b64_tr_b16 v[80:81], v22 offset:128
    ds_read_b64_tr_b16 v[82:83], v22 offset:1280
    ds_read_b64_tr_b16 v[84:85], v22 offset:160
    ds_read_b64_tr_b16 v[86:87], v22 offset:1312
    ds_read_b64_tr_b16 v[88:89], v22 offset:192
    ds_read_b64_tr_b16 v[90:91], v22 offset:1344
    ds_read_b64_tr_b16 v[92:93], v22 offset:224
    ds_read_b64_tr_b16 v[94:95], v22 offset:1376
    ds_read_b64_tr_b16 v[96:97], v22 offset:256
    ds_read_b64_tr_b16 v[98:99], v22 offset:1408
    v_add_u32 v22, 9216, v23
    ds_read_b64_tr_b16 v[100:101], v22 offset:0
    ds_read_b64_tr_b16 v[102:103], v22 offset:1152
    ds_read_b64_tr_b16 v[104:105], v22 offset:32
    ds_read_b64_tr_b16 v[106:107], v22 offset:1184
    ds_read_b64_tr_b16 v[108:109], v22 offset:64
    ds_read_b64_tr_b16 v[110:111], v22 offset:1216
    ds_read_b64_tr_b16 v[112:113], v22 offset:96
    ds_read_b64_tr_b16 v[114:115], v22 offset:1248
    ds_read_b64_tr_b16 v[116:117], v22 offset:128
    ds_read_b64_tr_b16 v[118:119], v22 offset:1280
    ds_read_b64_tr_b16 v[120:121], v22 offset:160
    ds_read_b64_tr_b16 v[122:123], v22 offset:1312
    ds_read_b64_tr_b16 v[124:125], v22 offset:192
    ds_read_b64_tr_b16 v[126:127], v22 offset:1344
    ds_read_b64_tr_b16 v[128:129], v22 offset:224
    ds_read_b64_tr_b16 v[130:131], v22 offset:1376
    ds_read_b64_tr_b16 v[132:133], v22 offset:256
    ds_read_b64_tr_b16 v[134:135], v22 offset:1408
    s_waitcnt lgkmcnt(0)
    v_mfma_f32_16x16x32_bf16 v[28:31], v[64:67], v[176:179], v[28:31]
    v_mfma_f32_16x16x32_bf16 v[32:35], v[68:71], v[176:179], v[32:35]
    v_mfma_f32_16x16x32_bf16 v[36:39], v[72:75], v[176:179], v[36:39]
    v_mfma_f32_16x16x32_bf16 v[40:43], v[76:79], v[176:179], v[40:43]
    v_mfma_f32_16x16x32_bf16 v[44:47], v[80:83], v[176:179], v[44:47]
    v_mfma_f32_16x16x32_bf16 v[48:51], v[84:87], v[176:179], v[48:51]
    v_mfma_f32_16x16x32_bf16 v[52:55], v[88:91], v[176:179], v[52:55]
    v_mfma_f32_16x16x32_bf16 v[56:59], v[92:95], v[176:179], v[56:59]
    v_mfma_f32_16x16x32_bf16 v[60:63], v[96:99], v[176:179], v[60:63]
    v_add_u32 v22, 18432, v23
    ds_read_b64_tr_b16 v[64:65], v22 offset:0
    ds_read_b64_tr_b16 v[66:67], v22 offset:1152
    ds_read_b64_tr_b16 v[68:69], v22 offset:32
    ds_read_b64_tr_b16 v[70:71], v22 offset:1184
    ds_read_b64_tr_b16 v[72:73], v22 offset:64
    ds_read_b64_tr_b16 v[74:75], v22 offset:1216
    ds_read_b64_tr_b16 v[76:77], v22 offset:96
    ds_read_b64_tr_b16 v[78:79], v22 offset:1248
    ds_read_b64_tr_b16 v[80:81], v22 offset:128
    ds_read_b64_tr_b16 v[82:83], v22 offset:1280
    ds_read_b64_tr_b16 v[84:85], v22 offset:160
    ds_read_b64_tr_b16 v[86:87], v22 offset:1312
    ds_read_b64_tr_b16 v[88:89], v22 offset:192
    ds_read_b64_tr_b16 v[90:91], v22 offset:1344
    ds_read_b64_tr_b16 v[92:93], v22 offset:224
    ds_read_b64_tr_b16 v[94:95], v22 offset:1376
    ds_read_b64_tr_b16 v[96:97], v22 offset:256
    ds_read_b64_tr_b16 v[98:99], v22 offset:1408
    s_waitcnt lgkmcnt(0)
    v_mfma_f32_16x16x32_bf16 v[28:31], v[100:103], v[180:183], v[28:31]
    v_mfma_f32_16x16x32_bf16 v[32:35], v[104:107], v[180:183], v[32:35]
    v_mfma_f32_16x16x32_bf16 v[36:39], v[108:111], v[180:183], v[36:39]
    v_mfma_f32_16x16x32_bf16 v[40:43], v[112:115], v[180:183], v[40:43]
    v_mfma_f32_16x16x32_bf16 v[44:47], v[116:119], v[180:183], v[44:47]
    v_mfma_f32_16x16x32_bf16 v[48:51], v[120:123], v[180:183], v[48:51]
    v_mfma_f32_16x16x32_bf16 v[52:55], v[124:127], v[180:183], v[52:55]
    v_mfma_f32_16x16x32_bf16 v[56:59], v[128:131], v[180:183], v[56:59]
    v_mfma_f32_16x16x32_bf16 v[60:63], v[132:135], v[180:183], v[60:63]
    v_add_u32 v22, 27648, v23
    ds_read_b64_tr_b16 v[100:101], v22 offset:0
    ds_read_b64_tr_b16 v[102:103], v22 offset:1152
    ds_read_b64_tr_b16 v[104:105], v22 offset:32
    ds_read_b64_tr_b16 v[106:107], v22 offset:1184
    ds_read_b64_tr_b16 v[108:109], v22 offset:64
    ds_read_b64_tr_b16 v[110:111], v22 offset:1216
    ds_read_b64_tr_b16 v[112:113], v22 offset:96
    ds_read_b64_tr_b16 v[114:115], v22 offset:1248
    ds_read_b64_tr_b16 v[116:117], v22 offset:128
    ds_read_b64_tr_b16 v[118:119], v22 offset:1280
    ds_read_b64_tr_b16 v[120:121], v22 offset:160
    ds_read_b64_tr_b16 v[122:123], v22 offset:1312
    ds_read_b64_tr_b16 v[124:125], v22 offset:192
    ds_read_b64_tr_b16 v[126:127], v22 offset:1344
    ds_read_b64_tr_b16 v[128:129], v22 offset:224
    ds_read_b64_tr_b16 v[130:131], v22 offset:1376
    ds_read_b64_tr_b16 v[132:133], v22 offset:256
    ds_read_b64_tr_b16 v[134:135], v22 offset:1408
    s_waitcnt lgkmcnt(0)
    v_mfma_f32_16x16x32_bf16 v[28:31], v[64:67], v[184:187], v[28:31]
    v_mfma_f32_16x16x32_bf16 v[32:35], v[68:71], v[184:187], v[32:35]
    v_mfma_f32_16x16x32_bf16 v[36:39], v[72:75], v[184:187], v[36:39]
    v_mfma_f32_16x16x32_bf16 v[40:43], v[76:79], v[184:187], v[40:43]
    v_mfma_f32_16x16x32_bf16 v[44:47], v[80:83], v[184:187], v[44:47]
    v_mfma_f32_16x16x32_bf16 v[48:51], v[84:87], v[184:187], v[48:51]
    v_mfma_f32_16x16x32_bf16 v[52:55], v[88:91], v[184:187], v[52:55]
    v_mfma_f32_16x16x32_bf16 v[56:59], v[92:95], v[184:187], v[56:59]
    v_mfma_f32_16x16x32_bf16 v[60:63], v[96:99], v[184:187], v[60:63]
    v_add_u32 v22, 36864, v23
    ds_read_b64_tr_b16 v[64:65], v22 offset:0
    ds_read_b64_tr_b16 v[66:67], v22 offset:1152
    ds_read_b64_tr_b16 v[68:69], v22 offset:32
    ds_read_b64_tr_b16 v[70:71], v22 offset:1184
    ds_read_b64_tr_b16 v[72:73], v22 offset:64
    ds_read_b64_tr_b16 v[74:75], v22 offset:1216
    ds_read_b64_tr_b16 v[76:77], v22 offset:96
    ds_read_b64_tr_b16 v[78:79], v22 offset:1248
    ds_read_b64_tr_b16 v[80:81], v22 offset:128
    ds_read_b64_tr_b16 v[82:83], v22 offset:1280
    ds_read_b64_tr_b16 v[84:85], v22 offset:160
    ds_read_b64_tr_b16 v[86:87], v22 offset:1312
    ds_read_b64_tr_b16 v[88:89], v22 offset:192
    ds_read_b64_tr_b16 v[90:91], v22 offset:1344
    ds_read_b64_tr_b16 v[92:93], v22 offset:224
    ds_read_b64_tr_b16 v[94:95], v22 offset:1376
    ds_read_b64_tr_b16 v[96:97], v22 offset:256
    ds_read_b64_tr_b16 v[98:99], v22 offset:1408
    s_waitcnt lgkmcnt(0)
    v_mfma_f32_16x16x32_bf16 v[28:31], v[100:103], v[188:191], v[28:31]
    v_mfma_f32_16x16x32_bf16 v[32:35], v[104:107], v[188:191], v[32:35]
    v_mfma_f32_16x16x32_bf16 v[36:39], v[108:111], v[188:191], v[36:39]
    v_mfma_f32_16x16x32_bf16 v[40:43], v[112:115], v[188:191], v[40:43]
    v_mfma_f32_16x16x32_bf16 v[44:47], v[116:119], v[188:191], v[44:47]
    v_mfma_f32_16x16x32_bf16 v[48:51], v[120:123], v[188:191], v[48:51]
    v_mfma_f32_16x16x32_bf16 v[52:55], v[124:127], v[188:191], v[52:55]
    v_mfma_f32_16x16x32_bf16 v[56:59], v[128:131], v[188:191], v[56:59]
    v_mfma_f32_16x16x32_bf16 v[60:63], v[132:135], v[188:191], v[60:63]
    s_waitcnt lgkmcnt(0)
    v_mfma_f32_16x16x32_bf16 v[28:31], v[64:67], v[192:195], v[28:31]
    v_mfma_f32_16x16x32_bf16 v[32:35], v[68:71], v[192:195], v[32:35]
    v_mfma_f32_16x16x32_bf16 v[36:39], v[72:75], v[192:195], v[36:39]
    v_mfma_f32_16x16x32_bf16 v[40:43], v[76:79], v[192:195], v[40:43]
    v_mfma_f32_16x16x32_bf16 v[44:47], v[80:83], v[192:195], v[44:47]
    v_mfma_f32_16x16x32_bf16 v[48:51], v[84:87], v[192:195], v[48:51]
    v_mfma_f32_16x16x32_bf16 v[52:55], v[88:91], v[192:195], v[52:55]
    v_mfma_f32_16x16x32_bf16 v[56:59], v[92:95], v[192:195], v[56:59]
    v_mfma_f32_16x16x32_bf16 v[60:63], v[96:99], v[192:195], v[60:63]
    s_waitcnt vmcnt(0)
    s_barrier
    v_add_u32 v22, 48384, v23
    ds_read_b64_tr_b16 v[64:65], v22 offset:0
    ds_read_b64_tr_b16 v[66:67], v22 offset:1152
    ds_read_b64_tr_b16 v[68:69], v22 offset:32
    ds_read_b64_tr_b16 v[70:71], v22 offset:1184
    ds_read_b64_tr_b16 v[72:73], v22 offset:64
    ds_read_b64_tr_b16 v[74:75], v22 offset:1216
    ds_read_b64_tr_b16 v[76:77], v22 offset:96
    ds_read_b64_tr_b16 v[78:79], v22 offset:1248
    ds_read_b64_tr_b16 v[80:81], v22 offset:128
    ds_read_b64_tr_b16 v[82:83], v22 offset:1280
    ds_read_b64_tr_b16 v[84:85], v22 offset:160
    ds_read_b64_tr_b16 v[86:87], v22 offset:1312
    ds_read_b64_tr_b16 v[88:89], v22 offset:192
    ds_read_b64_tr_b16 v[90:91], v22 offset:1344
    ds_read_b64_tr_b16 v[92:93], v22 offset:224
    ds_read_b64_tr_b16 v[94:95], v22 offset:1376
    ds_read_b64_tr_b16 v[96:97], v22 offset:256
    ds_read_b64_tr_b16 v[98:99], v22 offset:1408
    v_add_u32 v22, 57600, v23
    ds_read_b64_tr_b16 v[100:101], v22 offset:0
    ds_read_b64_tr_b16 v[102:103], v22 offset:1152
    ds_read_b64_tr_b16 v[104:105], v22 offset:32
    ds_read_b64_tr_b16 v[106:107], v22 offset:1184
    ds_read_b64_tr_b16 v[108:109], v22 offset:64
    ds_read_b64_tr_b16 v[110:111], v22 offset:1216
    ds_read_b64_tr_b16 v[112:113], v22 offset:96
    ds_read_b64_tr_b16 v[114:115], v22 offset:1248
    ds_read_b64_tr_b16 v[116:117], v22 offset:128
    ds_read_b64_tr_b16 v[118:119], v22 offset:1280
    ds_read_b64_tr_b16 v[120:121], v22 offset:160
    ds_read_b64_tr_b16 v[122:123], v22 offset:1312
    ds_read_b64_tr_b16 v[124:125], v22 offset:192
    ds_read_b64_tr_b16 v[126:127], v22 offset:1344
    ds_read_b64_tr_b16 v[128:129], v22 offset:224
    ds_read_b64_tr_b16 v[130:131], v22 offset:1376
    ds_read_b64_tr_b16 v[132:133], v22 offset:256
    ds_read_b64_tr_b16 v[134:135], v22 offset:1408
    s_waitcnt lgkmcnt(0)
    v_mfma_f32_16x16x32_bf16 v[28:31], v[64:67], v[196:199], v[28:31]
    v_mfma_f32_16x16x32_bf16 v[32:35], v[68:71], v[196:199], v[32:35]
    v_mfma_f32_16x16x32_bf16 v[36:39], v[72:75], v[196:199], v[36:39]
    v_mfma_f32_16x16x32_bf16 v[40:43], v[76:79], v[196:199], v[40:43]
    v_mfma_f32_16x16x32_bf16 v[44:47], v[80:83], v[196:199], v[44:47]
    v_mfma_f32_16x16x32_bf16 v[48:51], v[84:87], v[196:199], v[48:51]
    v_mfma_f32_16x16x32_bf16 v[52:55], v[88:91], v[196:199], v[52:55]
    v_mfma_f32_16x16x32_bf16 v[56:59], v[92:95], v[196:199], v[56:59]
    v_mfma_f32_16x16x32_bf16 v[60:63], v[96:99], v[196:199], v[60:63]
    v_add_u32 v22, 66816, v23
    ds_read_b64_tr_b16 v[64:65], v22 offset:0
    ds_read_b64_tr_b16 v[66:67], v22 offset:1152
    ds_read_b64_tr_b16 v[68:69], v22 offset:32
    ds_read_b64_tr_b16 v[70:71], v22 offset:1184
    ds_read_b64_tr_b16 v[72:73], v22 offset:64
    ds_read_b64_tr_b16 v[74:75], v22 offset:1216
    ds_read_b64_tr_b16 v[76:77], v22 offset:96
    ds_read_b64_tr_b16 v[78:79], v22 offset:1248
    ds_read_b64_tr_b16 v[80:81], v22 offset:128
    ds_read_b64_tr_b16 v[82:83], v22 offset:1280
    ds_read_b64_tr_b16 v[84:85], v22 offset:160
    ds_read_b64_tr_b16 v[86:87], v22 offset:1312
    ds_read_b64_tr_b16 v[88:89], v22 offset:192
    ds_read_b64_tr_b16 v[90:91], v22 offset:1344
    ds_read_b64_tr_b16 v[92:93], v22 offset:224
    ds_read_b64_tr_b16 v[94:95], v22 offset:1376
    ds_read_b64_tr_b16 v[96:97], v22 offset:256
    ds_read_b64_tr_b16 v[98:99], v22 offset:1408
    s_waitcnt lgkmcnt(0)
    v_mfma_f32_16x16x32_bf16 v[28:31], v[100:103], v[200:203], v[28:31]
    v_mfma_f32_16x16x32_bf16 v[32:35], v[104:107], v[200:203], v[32:35]
    v_mfma_f32_16x16x32_bf16 v[36:39], v[108:111], v[200:203], v[36:39]
    v_mfma_f32_16x16x32_bf16 v[40:43], v[112:115], v[200:203], v[40:43]
    v_mfma_f32_16x16x32_bf16 v[44:47], v[116:119], v[200:203], v[44:47]
    v_mfma_f32_16x16x32_bf16 v[48:51], v[120:123], v[200:203], v[48:51]
    v_mfma_f32_16x16x32_bf16 v[52:55], v[124:127], v[200:203], v[52:55]
    v_mfma_f32_16x16x32_bf16 v[56:59], v[128:131], v[200:203], v[56:59]
    v_mfma_f32_16x16x32_bf16 v[60:63], v[132:135], v[200:203], v[60:63]
    v_add_u32 v22, 76032, v23
    ds_read_b64_tr_b16 v[100:101], v22 offset:0
    ds_read_b64_tr_b16 v[102:103], v22 offset:1152
    ds_read_b64_tr_b16 v[104:105], v22 offset:32
    ds_read_b64_tr_b16 v[106:107], v22 offset:1184
    ds_read_b64_tr_b16 v[108:109], v22 offset:64
    ds_read_b64_tr_b16 v[110:111], v22 offset:1216
    ds_read_b64_tr_b16 v[112:113], v22 offset:96
    ds_read_b64_tr_b16 v[114:115], v22 offset:1248
    ds_read_b64_tr_b16 v[116:117], v22 offset:128
    ds_read_b64_tr_b16 v[118:119], v22 offset:1280
    ds_read_b64_tr_b16 v[120:121], v22 offset:160
    ds_read_b64_tr_b16 v[122:123], v22 offset:1312
    ds_read_b64_tr_b16 v[124:125], v22 offset:192
    ds_read_b64_tr_b16 v[126:127], v22 offset:1344
    ds_read_b64_tr_b16 v[128:129], v22 offset:224
    ds_read_b64_tr_b16 v[130:131], v22 offset:1376
    ds_read_b64_tr_b16 v[132:133], v22 offset:256
    ds_read_b64_tr_b16 v[134:135], v22 offset:1408
    s_waitcnt lgkmcnt(0)
    v_mfma_f32_16x16x32_bf16 v[28:31], v[64:67], v[204:207], v[28:31]
    v_mfma_f32_16x16x32_bf16 v[32:35], v[68:71], v[204:207], v[32:35]
    v_mfma_f32_16x16x32_bf16 v[36:39], v[72:75], v[204:207], v[36:39]
    v_mfma_f32_16x16x32_bf16 v[40:43], v[76:79], v[204:207], v[40:43]
    v_mfma_f32_16x16x32_bf16 v[44:47], v[80:83], v[204:207], v[44:47]
    v_mfma_f32_16x16x32_bf16 v[48:51], v[84:87], v[204:207], v[48:51]
    v_mfma_f32_16x16x32_bf16 v[52:55], v[88:91], v[204:207], v[52:55]
    v_mfma_f32_16x16x32_bf16 v[56:59], v[92:95], v[204:207], v[56:59]
    v_mfma_f32_16x16x32_bf16 v[60:63], v[96:99], v[204:207], v[60:63]
    v_add_u32 v22, 85248, v23
    ds_read_b64_tr_b16 v[64:65], v22 offset:0
    ds_read_b64_tr_b16 v[66:67], v22 offset:1152
    ds_read_b64_tr_b16 v[68:69], v22 offset:32
    ds_read_b64_tr_b16 v[70:71], v22 offset:1184
    ds_read_b64_tr_b16 v[72:73], v22 offset:64
    ds_read_b64_tr_b16 v[74:75], v22 offset:1216
    ds_read_b64_tr_b16 v[76:77], v22 offset:96
    ds_read_b64_tr_b16 v[78:79], v22 offset:1248
    ds_read_b64_tr_b16 v[80:81], v22 offset:128
    ds_read_b64_tr_b16 v[82:83], v22 offset:1280
    ds_read_b64_tr_b16 v[84:85], v22 offset:160
    ds_read_b64_tr_b16 v[86:87], v22 offset:1312
    ds_read_b64_tr_b16 v[88:89], v22 offset:192
    ds_read_b64_tr_b16 v[90:91], v22 offset:1344
    ds_read_b64_tr_b16 v[92:93], v22 offset:224
    ds_read_b64_tr_b16 v[94:95], v22 offset:1376
    ds_read_b64_tr_b16 v[96:97], v22 offset:256
    ds_read_b64_tr_b16 v[98:99], v22 offset:1408
    s_waitcnt lgkmcnt(0)
    v_mfma_f32_16x16x32_bf16 v[28:31], v[100:103], v[208:211], v[28:31]
    v_mfma_f32_16x16x32_bf16 v[32:35], v[104:107], v[208:211], v[32:35]
    v_mfma_f32_16x16x32_bf16 v[36:39], v[108:111], v[208:211], v[36:39]
    v_mfma_f32_16x16x32_bf16 v[40:43], v[112:115], v[208:211], v[40:43]
    v_mfma_f32_16x16x32_bf16 v[44:47], v[116:119], v[208:211], v[44:47]
    v_mfma_f32_16x16x32_bf16 v[48:51], v[120:123], v[208:211], v[48:51]
    v_mfma_f32_16x16x32_bf16 v[52:55], v[124:127], v[208:211], v[52:55]
    v_mfma_f32_16x16x32_bf16 v[56:59], v[128:131], v[208:211], v[56:59]
    v_mfma_f32_16x16x32_bf16 v[60:63], v[132:135], v[208:211], v[60:63]
    s_waitcnt lgkmcnt(0)
    v_mfma_f32_16x16x32_bf16 v[28:31], v[64:67], v[212:215], v[28:31]
    v_mfma_f32_16x16x32_bf16 v[32:35], v[68:71], v[212:215], v[32:35]
    v_mfma_f32_16x16x32_bf16 v[36:39], v[72:75], v[212:215], v[36:39]
    v_mfma_f32_16x16x32_bf16 v[40:43], v[76:79], v[212:215], v[40:43]
    v_mfma_f32_16x16x32_bf16 v[44:47], v[80:83], v[212:215], v[44:47]
    v_mfma_f32_16x16x32_bf16 v[48:51], v[84:87], v[212:215], v[48:51]
    v_mfma_f32_16x16x32_bf16 v[52:55], v[88:91], v[212:215], v[52:55]
    v_mfma_f32_16x16x32_bf16 v[56:59], v[92:95], v[212:215], v[56:59]
    v_mfma_f32_16x16x32_bf16 v[60:63], v[96:99], v[212:215], v[60:63]
    s_nop 15
    s_mov_b32 s6, 0xc0135761
    s_mov_b32 s7, 0xbdd2d3e8
    v_mul_f32 v3, v28, v28
    v_mov_b32 v5, s6
    v_fma_f32 v3, v3, s7, v5
    v_mul_f32 v3, v3, v28
    v_exp_f32 v3, v3
    s_nop 0
    v_add_f32 v3, 1.0, v3
    v_rcp_f32 v3, v3
    s_nop 0
    v_mul_f32 v28, v28, v3
    v_mul_f32 v3, v29, v29
    v_mov_b32 v5, s6
    v_fma_f32 v3, v3, s7, v5
    v_mul_f32 v3, v3, v29
    v_exp_f32 v3, v3
    s_nop 0
    v_add_f32 v3, 1.0, v3
    v_rcp_f32 v3, v3
    s_nop 0
    v_mul_f32 v29, v29, v3
    v_mul_f32 v3, v30, v30
    v_mov_b32 v5, s6
    v_fma_f32 v3, v3, s7, v5
    v_mul_f32 v3, v3, v30
    v_exp_f32 v3, v3
    s_nop 0
    v_add_f32 v3, 1.0, v3
    v_rcp_f32 v3, v3
    s_nop 0
    v_mul_f32 v30, v30, v3
    v_mul_f32 v3, v31, v31
    v_mov_b32 v5, s6
    v_fma_f32 v3, v3, s7, v5
    v_mul_f32 v3, v3, v31
    v_exp_f32 v3, v3
    s_nop 0
    v_add_f32 v3, 1.0, v3
    v_rcp_f32 v3, v3
    s_nop 0
    v_mul_f32 v31, v31, v3
    v_cvt_pk_bf16_f32 v26, v28, v29
    v_cvt_pk_bf16_f32 v27, v30, v31
    buffer_store_dwordx2 v[26:27], v24, s[16:19], 0 offen offset:0
    s_nop 0
    v_mul_f32 v3, v32, v32
    v_mov_b32 v5, s6
    v_fma_f32 v3, v3, s7, v5
    v_mul_f32 v3, v3, v32
    v_exp_f32 v3, v3
    s_nop 0
    v_add_f32 v3, 1.0, v3
    v_rcp_f32 v3, v3
    s_nop 0
    v_mul_f32 v32, v32, v3
    v_mul_f32 v3, v33, v33
    v_mov_b32 v5, s6
    v_fma_f32 v3, v3, s7, v5
    v_mul_f32 v3, v3, v33
    v_exp_f32 v3, v3
    s_nop 0
    v_add_f32 v3, 1.0, v3
    v_rcp_f32 v3, v3
    s_nop 0
    v_mul_f32 v33, v33, v3
    v_mul_f32 v3, v34, v34
    v_mov_b32 v5, s6
    v_fma_f32 v3, v3, s7, v5
    v_mul_f32 v3, v3, v34
    v_exp_f32 v3, v3
    s_nop 0
    v_add_f32 v3, 1.0, v3
    v_rcp_f32 v3, v3
    s_nop 0
    v_mul_f32 v34, v34, v3
    v_mul_f32 v3, v35, v35
    v_mov_b32 v5, s6
    v_fma_f32 v3, v3, s7, v5
    v_mul_f32 v3, v3, v35
    v_exp_f32 v3, v3
    s_nop 0
    v_add_f32 v3, 1.0, v3
    v_rcp_f32 v3, v3
    s_nop 0
    v_mul_f32 v35, v35, v3
    v_cvt_pk_bf16_f32 v26, v32, v33
    v_cvt_pk_bf16_f32 v27, v34, v35
    buffer_store_dwordx2 v[26:27], v24, s[16:19], 0 offen offset:32
    s_nop 0
    v_mul_f32 v3, v36, v36
    v_mov_b32 v5, s6
    v_fma_f32 v3, v3, s7, v5
    v_mul_f32 v3, v3, v36
    v_exp_f32 v3, v3
    s_nop 0
    v_add_f32 v3, 1.0, v3
    v_rcp_f32 v3, v3
    s_nop 0
    v_mul_f32 v36, v36, v3
    v_mul_f32 v3, v37, v37
    v_mov_b32 v5, s6
    v_fma_f32 v3, v3, s7, v5
    v_mul_f32 v3, v3, v37
    v_exp_f32 v3, v3
    s_nop 0
    v_add_f32 v3, 1.0, v3
    v_rcp_f32 v3, v3
    s_nop 0
    v_mul_f32 v37, v37, v3
    v_mul_f32 v3, v38, v38
    v_mov_b32 v5, s6
    v_fma_f32 v3, v3, s7, v5
    v_mul_f32 v3, v3, v38
    v_exp_f32 v3, v3
    s_nop 0
    v_add_f32 v3, 1.0, v3
    v_rcp_f32 v3, v3
    s_nop 0
    v_mul_f32 v38, v38, v3
    v_mul_f32 v3, v39, v39
    v_mov_b32 v5, s6
    v_fma_f32 v3, v3, s7, v5
    v_mul_f32 v3, v3, v39
    v_exp_f32 v3, v3
    s_nop 0
    v_add_f32 v3, 1.0, v3
    v_rcp_f32 v3, v3
    s_nop 0
    v_mul_f32 v39, v39, v3
    v_cvt_pk_bf16_f32 v26, v36, v37
    v_cvt_pk_bf16_f32 v27, v38, v39
    buffer_store_dwordx2 v[26:27], v24, s[16:19], 0 offen offset:64
    s_nop 0
    v_mul_f32 v3, v40, v40
    v_mov_b32 v5, s6
    v_fma_f32 v3, v3, s7, v5
    v_mul_f32 v3, v3, v40
    v_exp_f32 v3, v3
    s_nop 0
    v_add_f32 v3, 1.0, v3
    v_rcp_f32 v3, v3
    s_nop 0
    v_mul_f32 v40, v40, v3
    v_mul_f32 v3, v41, v41
    v_mov_b32 v5, s6
    v_fma_f32 v3, v3, s7, v5
    v_mul_f32 v3, v3, v41
    v_exp_f32 v3, v3
    s_nop 0
    v_add_f32 v3, 1.0, v3
    v_rcp_f32 v3, v3
    s_nop 0
    v_mul_f32 v41, v41, v3
    v_mul_f32 v3, v42, v42
    v_mov_b32 v5, s6
    v_fma_f32 v3, v3, s7, v5
    v_mul_f32 v3, v3, v42
    v_exp_f32 v3, v3
    s_nop 0
    v_add_f32 v3, 1.0, v3
    v_rcp_f32 v3, v3
    s_nop 0
    v_mul_f32 v42, v42, v3
    v_mul_f32 v3, v43, v43
    v_mov_b32 v5, s6
    v_fma_f32 v3, v3, s7, v5
    v_mul_f32 v3, v3, v43
    v_exp_f32 v3, v3
    s_nop 0
    v_add_f32 v3, 1.0, v3
    v_rcp_f32 v3, v3
    s_nop 0
    v_mul_f32 v43, v43, v3
    v_cvt_pk_bf16_f32 v26, v40, v41
    v_cvt_pk_bf16_f32 v27, v42, v43
    buffer_store_dwordx2 v[26:27], v24, s[16:19], 0 offen offset:96
    s_nop 0
    v_mul_f32 v3, v44, v44
    v_mov_b32 v5, s6
    v_fma_f32 v3, v3, s7, v5
    v_mul_f32 v3, v3, v44
    v_exp_f32 v3, v3
    s_nop 0
    v_add_f32 v3, 1.0, v3
    v_rcp_f32 v3, v3
    s_nop 0
    v_mul_f32 v44, v44, v3
    v_mul_f32 v3, v45, v45
    v_mov_b32 v5, s6
    v_fma_f32 v3, v3, s7, v5
    v_mul_f32 v3, v3, v45
    v_exp_f32 v3, v3
    s_nop 0
    v_add_f32 v3, 1.0, v3
    v_rcp_f32 v3, v3
    s_nop 0
    v_mul_f32 v45, v45, v3
    v_mul_f32 v3, v46, v46
    v_mov_b32 v5, s6
    v_fma_f32 v3, v3, s7, v5
    v_mul_f32 v3, v3, v46
    v_exp_f32 v3, v3
    s_nop 0
    v_add_f32 v3, 1.0, v3
    v_rcp_f32 v3, v3
    s_nop 0
    v_mul_f32 v46, v46, v3
    v_mul_f32 v3, v47, v47
    v_mov_b32 v5, s6
    v_fma_f32 v3, v3, s7, v5
    v_mul_f32 v3, v3, v47
    v_exp_f32 v3, v3
    s_nop 0
    v_add_f32 v3, 1.0, v3
    v_rcp_f32 v3, v3
    s_nop 0
    v_mul_f32 v47, v47, v3
    v_cvt_pk_bf16_f32 v26, v44, v45
    v_cvt_pk_bf16_f32 v27, v46, v47
    buffer_store_dwordx2 v[26:27], v24, s[16:19], 0 offen offset:128
    s_nop 0
    v_mul_f32 v3, v48, v48
    v_mov_b32 v5, s6
    v_fma_f32 v3, v3, s7, v5
    v_mul_f32 v3, v3, v48
    v_exp_f32 v3, v3
    s_nop 0
    v_add_f32 v3, 1.0, v3
    v_rcp_f32 v3, v3
    s_nop 0
    v_mul_f32 v48, v48, v3
    v_mul_f32 v3, v49, v49
    v_mov_b32 v5, s6
    v_fma_f32 v3, v3, s7, v5
    v_mul_f32 v3, v3, v49
    v_exp_f32 v3, v3
    s_nop 0
    v_add_f32 v3, 1.0, v3
    v_rcp_f32 v3, v3
    s_nop 0
    v_mul_f32 v49, v49, v3
    v_mul_f32 v3, v50, v50
    v_mov_b32 v5, s6
    v_fma_f32 v3, v3, s7, v5
    v_mul_f32 v3, v3, v50
    v_exp_f32 v3, v3
    s_nop 0
    v_add_f32 v3, 1.0, v3
    v_rcp_f32 v3, v3
    s_nop 0
    v_mul_f32 v50, v50, v3
    v_mul_f32 v3, v51, v51
    v_mov_b32 v5, s6
    v_fma_f32 v3, v3, s7, v5
    v_mul_f32 v3, v3, v51
    v_exp_f32 v3, v3
    s_nop 0
    v_add_f32 v3, 1.0, v3
    v_rcp_f32 v3, v3
    s_nop 0
    v_mul_f32 v51, v51, v3
    v_cvt_pk_bf16_f32 v26, v48, v49
    v_cvt_pk_bf16_f32 v27, v50, v51
    buffer_store_dwordx2 v[26:27], v24, s[16:19], 0 offen offset:160
    s_nop 0
    v_mul_f32 v3, v52, v52
    v_mov_b32 v5, s6
    v_fma_f32 v3, v3, s7, v5
    v_mul_f32 v3, v3, v52
    v_exp_f32 v3, v3
    s_nop 0
    v_add_f32 v3, 1.0, v3
    v_rcp_f32 v3, v3
    s_nop 0
    v_mul_f32 v52, v52, v3
    v_mul_f32 v3, v53, v53
    v_mov_b32 v5, s6
    v_fma_f32 v3, v3, s7, v5
    v_mul_f32 v3, v3, v53
    v_exp_f32 v3, v3
    s_nop 0
    v_add_f32 v3, 1.0, v3
    v_rcp_f32 v3, v3
    s_nop 0
    v_mul_f32 v53, v53, v3
    v_mul_f32 v3, v54, v54
    v_mov_b32 v5, s6
    v_fma_f32 v3, v3, s7, v5
    v_mul_f32 v3, v3, v54
    v_exp_f32 v3, v3
    s_nop 0
    v_add_f32 v3, 1.0, v3
    v_rcp_f32 v3, v3
    s_nop 0
    v_mul_f32 v54, v54, v3
    v_mul_f32 v3, v55, v55
    v_mov_b32 v5, s6
    v_fma_f32 v3, v3, s7, v5
    v_mul_f32 v3, v3, v55
    v_exp_f32 v3, v3
    s_nop 0
    v_add_f32 v3, 1.0, v3
    v_rcp_f32 v3, v3
    s_nop 0
    v_mul_f32 v55, v55, v3
    v_cvt_pk_bf16_f32 v26, v52, v53
    v_cvt_pk_bf16_f32 v27, v54, v55
    buffer_store_dwordx2 v[26:27], v24, s[16:19], 0 offen offset:192
    s_nop 0
    v_mul_f32 v3, v56, v56
    v_mov_b32 v5, s6
    v_fma_f32 v3, v3, s7, v5
    v_mul_f32 v3, v3, v56
    v_exp_f32 v3, v3
    s_nop 0
    v_add_f32 v3, 1.0, v3
    v_rcp_f32 v3, v3
    s_nop 0
    v_mul_f32 v56, v56, v3
    v_mul_f32 v3, v57, v57
    v_mov_b32 v5, s6
    v_fma_f32 v3, v3, s7, v5
    v_mul_f32 v3, v3, v57
    v_exp_f32 v3, v3
    s_nop 0
    v_add_f32 v3, 1.0, v3
    v_rcp_f32 v3, v3
    s_nop 0
    v_mul_f32 v57, v57, v3
    v_mul_f32 v3, v58, v58
    v_mov_b32 v5, s6
    v_fma_f32 v3, v3, s7, v5
    v_mul_f32 v3, v3, v58
    v_exp_f32 v3, v3
    s_nop 0
    v_add_f32 v3, 1.0, v3
    v_rcp_f32 v3, v3
    s_nop 0
    v_mul_f32 v58, v58, v3
    v_mul_f32 v3, v59, v59
    v_mov_b32 v5, s6
    v_fma_f32 v3, v3, s7, v5
    v_mul_f32 v3, v3, v59
    v_exp_f32 v3, v3
    s_nop 0
    v_add_f32 v3, 1.0, v3
    v_rcp_f32 v3, v3
    s_nop 0
    v_mul_f32 v59, v59, v3
    v_cvt_pk_bf16_f32 v26, v56, v57
    v_cvt_pk_bf16_f32 v27, v58, v59
    buffer_store_dwordx2 v[26:27], v24, s[16:19], 0 offen offset:224
    s_nop 0
    v_mul_f32 v3, v60, v60
    v_mov_b32 v5, s6
    v_fma_f32 v3, v3, s7, v5
    v_mul_f32 v3, v3, v60
    v_exp_f32 v3, v3
    s_nop 0
    v_add_f32 v3, 1.0, v3
    v_rcp_f32 v3, v3
    s_nop 0
    v_mul_f32 v60, v60, v3
    v_mul_f32 v3, v61, v61
    v_mov_b32 v5, s6
    v_fma_f32 v3, v3, s7, v5
    v_mul_f32 v3, v3, v61
    v_exp_f32 v3, v3
    s_nop 0
    v_add_f32 v3, 1.0, v3
    v_rcp_f32 v3, v3
    s_nop 0
    v_mul_f32 v61, v61, v3
    v_mul_f32 v3, v62, v62
    v_mov_b32 v5, s6
    v_fma_f32 v3, v3, s7, v5
    v_mul_f32 v3, v3, v62
    v_exp_f32 v3, v3
    s_nop 0
    v_add_f32 v3, 1.0, v3
    v_rcp_f32 v3, v3
    s_nop 0
    v_mul_f32 v62, v62, v3
    v_mul_f32 v3, v63, v63
    v_mov_b32 v5, s6
    v_fma_f32 v3, v3, s7, v5
    v_mul_f32 v3, v3, v63
    v_exp_f32 v3, v3
    s_nop 0
    v_add_f32 v3, 1.0, v3
    v_rcp_f32 v3, v3
    s_nop 0
    v_mul_f32 v63, v63, v3
    v_cvt_pk_bf16_f32 v26, v60, v61
    v_cvt_pk_bf16_f32 v27, v62, v63
    buffer_store_dwordx2 v[26:27], v24, s[16:19], 0 offen offset:256
    s_nop 0
    s_waitcnt vmcnt(0)
    s_endpgm
L_END_k6_w3_kernel:
    s_endpgm
.globl k7_w4_kernel
.p2align 8
.type k7_w4_kernel,@function
k7_w4_kernel:
    s_cmp_ge_u32 s2, 256
    s_cbranch_scc1 L_END_k7_w4_kernel
    s_load_dwordx16 s[36:51], s[0:1], 0
    s_load_dwordx8 s[52:59], s[0:1], 64
    s_load_dwordx2 s[60:61], s[0:1], 96
    s_and_b32 s3, s2, 31
    s_lshr_b32 s4, s2, 5
    s_waitcnt lgkmcnt(0)
    s_add_u32 s8, s60, 0xf80000
    s_addc_u32 s9, s61, 0
    s_mov_b32 s10, 0x6c0000
    s_mov_b32 s11, 0x00020000
    s_mov_b32 s12, s54
    s_mov_b32 s13, s55
    s_mov_b32 s14, 0x21c000
    s_mov_b32 s15, 0x00020000
    s_mov_b32 s16, s56
    s_mov_b32 s17, s57
    s_mov_b32 s18, 0x280000
    s_mov_b32 s19, 0x00020000
    s_add_u32 s20, s60, 0xd00000
    s_addc_u32 s21, s61, 0
    s_mov_b32 s22, 0x280000
    s_mov_b32 s23, 0x00020000
    s_add_u32 s24, s60, 0x580000
    s_addc_u32 s25, s61, 0
    s_mov_b32 s26, 0x280000
    s_mov_b32 s27, 0x00020000
    v_and_b32 v1, 15, v0
    v_bfe_u32 v2, v0, 4, 2
    v_lshrrev_b32 v3, 6, v0
    v_lshlrev_b32 v3, 4, v3
    v_add_u32 v3, v3, v1
    s_mul_i32 s5, s3, 64
    v_add_u32 v3, s5, v3
    v_mov_b32 v10, v3
    v_and_b32 v4, 63, v0
    v_xor_b32 v17, 32, v4
    v_lshlrev_b32 v17, 2, v17
    s_mov_b32 s6, 3456
    v_lshlrev_b32 v5, 4, v2
    v_mov_b32 v4, v3
    v_mul_lo_u32 v4, v4, s6
    v_add_u32 v18, v4, v5
    v_mov_b32 v28, 0
    v_mov_b32 v29, 0
    v_mov_b32 v30, 0
    v_mov_b32 v31, 0
    v_mov_b32 v32, 0
    v_mov_b32 v33, 0
    v_mov_b32 v34, 0
    v_mov_b32 v35, 0
    v_mov_b32 v36, 0
    v_mov_b32 v37, 0
    v_mov_b32 v38, 0
    v_mov_b32 v39, 0
    v_mov_b32 v40, 0
    v_mov_b32 v41, 0
    v_mov_b32 v42, 0
    v_mov_b32 v43, 0
    v_mov_b32 v44, 0
    v_mov_b32 v45, 0
    v_mov_b32 v46, 0
    v_mov_b32 v47, 0
    v_lshrrev_b32 v4, 2, v1
    v_lshl_add_u32 v4, v2, 3, v4
    s_mov_b32 s7, 160
    v_mul_lo_u32 v4, v4, s7
    v_and_b32 v5, 3, v1
    v_lshl_add_u32 v23, v5, 3, v4
    s_mul_i32 s4, s4, 160
    v_and_b32 v4, 63, v0
    v_mul_u32_u24 v5, 6554, v4
    v_lshrrev_b32 v5, 16, v5
    v_mul_u32_u24 v6, 10, v5
    v_sub_u32 v6, v4, v6
    s_mov_b32 s66, 1280
    v_mul_lo_u32 v5, v5, s66
    v_lshl_add_u32 v25, v6, 4, v5
    v_lshrrev_b32 v4, 6, v0
    s_nop 1
    v_readfirstlane_b32 s64, v4
    s_nop 3
    s_mul_i32 s65, s64, 960
    s_mul_i32 s67, s64, 7680
    s_add_u32 s67, s67, s4
    buffer_load_dwordx4 v[136:139], v18, s[8:11], 0 offen offset:0
    buffer_load_dwordx4 v[140:143], v18, s[8:11], 0 offen offset:64
    buffer_load_dwordx4 v[144:147], v18, s[8:11], 0 offen offset:128
    buffer_load_dwordx4 v[148:151], v18, s[8:11], 0 offen offset:192
    buffer_load_dwordx4 v[152:155], v18, s[8:11], 0 offen offset:256
    buffer_load_dwordx4 v[156:159], v18, s[8:11], 0 offen offset:320
    buffer_load_dwordx4 v[160:163], v18, s[8:11], 0 offen offset:384
    buffer_load_dwordx4 v[164:167], v18, s[8:11], 0 offen offset:448
    buffer_load_dwordx4 v[168:171], v18, s[8:11], 0 offen offset:512
    s_mov_b32 s6, 1280
    v_mul_lo_u32 v24, v10, s6
    v_lshl_add_u32 v24, v2, 3, v24
    v_add_u32 v24, s4, v24
    buffer_load_dwordx2 v[216:217], v24, s[20:23], 0 offen offset:0
    buffer_load_dwordx2 v[218:219], v24, s[24:27], 0 offen offset:0
    buffer_load_dwordx2 v[220:221], v24, s[20:23], 0 offen offset:32
    buffer_load_dwordx2 v[222:223], v24, s[24:27], 0 offen offset:32
    buffer_load_dwordx2 v[224:225], v24, s[20:23], 0 offen offset:64
    buffer_load_dwordx2 v[226:227], v24, s[24:27], 0 offen offset:64
    buffer_load_dwordx2 v[228:229], v24, s[20:23], 0 offen offset:96
    buffer_load_dwordx2 v[230:231], v24, s[24:27], 0 offen offset:96
    buffer_load_dwordx2 v[232:233], v24, s[20:23], 0 offen offset:128
    buffer_load_dwordx2 v[234:235], v24, s[24:27], 0 offen offset:128
    s_mov_b64 s[68:69], exec
    s_mov_b32 exec_hi, 0xfffffff
    s_add_u32 m0, s65, 0
    s_add_u32 s70, s67, 0
    buffer_load_dwordx4 v25, s[12:15], s70 offen lds
    s_add_u32 m0, s65, 3840
    s_add_u32 s70, s67, 30720
    buffer_load_dwordx4 v25, s[12:15], s70 offen lds
    s_add_u32 m0, s65, 7680
    s_add_u32 s70, s67, 61440
    buffer_load_dwordx4 v25, s[12:15], s70 offen lds
    s_add_u32 m0, s65, 11520
    s_add_u32 s70, s67, 92160
    buffer_load_dwordx4 v25, s[12:15], s70 offen lds
    s_add_u32 m0, s65, 15360
    s_add_u32 s70, s67, 122880
    buffer_load_dwordx4 v25, s[12:15], s70 offen lds
    s_add_u32 m0, s65, 19200
    s_add_u32 s70, s67, 153600
    buffer_load_dwordx4 v25, s[12:15], s70 offen lds
    s_add_u32 m0, s65, 23040
    s_add_u32 s70, s67, 184320
    buffer_load_dwordx4 v25, s[12:15], s70 offen lds
    s_add_u32 m0, s65, 26880
    s_add_u32 s70, s67, 215040
    buffer_load_dwordx4 v25, s[12:15], s70 offen lds
    s_add_u32 m0, s65, 30720
    s_add_u32 s70, s67, 245760
    buffer_load_dwordx4 v25, s[12:15], s70 offen lds
    s_add_u32 m0, s65, 34560
    s_add_u32 s70, s67, 276480
    buffer_load_dwordx4 v25, s[12:15], s70 offen lds
    s_add_u32 m0, s65, 38400
    s_add_u32 s70, s67, 307200
    buffer_load_dwordx4 v25, s[12:15], s70 offen lds
    s_add_u32 m0, s65, 42240
    s_add_u32 s70, s67, 337920
    buffer_load_dwordx4 v25, s[12:15], s70 offen lds
    s_mov_b64 exec, s[68:69]
    buffer_load_dwordx4 v[172:175], v18, s[8:11], 0 offen offset:576
    buffer_load_dwordx4 v[176:179], v18, s[8:11], 0 offen offset:640
    buffer_load_dwordx4 v[180:183], v18, s[8:11], 0 offen offset:704
    buffer_load_dwordx4 v[184:187], v18, s[8:11], 0 offen offset:768
    buffer_load_dwordx4 v[188:191], v18, s[8:11], 0 offen offset:832
    buffer_load_dwordx4 v[192:195], v18, s[8:11], 0 offen offset:896
    buffer_load_dwordx4 v[196:199], v18, s[8:11], 0 offen offset:960
    buffer_load_dwordx4 v[200:203], v18, s[8:11], 0 offen offset:1024
    buffer_load_dwordx4 v[204:207], v18, s[8:11], 0 offen offset:1088
    s_mov_b64 s[68:69], exec
    s_mov_b32 exec_hi, 0xfffffff
    s_add_u32 m0, s65, 46080
    s_add_u32 s70, s67, 368640
    buffer_load_dwordx4 v25, s[12:15], s70 offen lds
    s_add_u32 m0, s65, 49920
    s_add_u32 s70, s67, 399360
    buffer_load_dwordx4 v25, s[12:15], s70 offen lds
    s_add_u32 m0, s65, 53760
    s_add_u32 s70, s67, 430080
    buffer_load_dwordx4 v25, s[12:15], s70 offen lds
    s_add_u32 m0, s65, 57600
    s_add_u32 s70, s67, 460800
    buffer_load_dwordx4 v25, s[12:15], s70 offen lds
    s_add_u32 m0, s65, 61440
    s_add_u32 s70, s67, 491520
    buffer_load_dwordx4 v25, s[12:15], s70 offen lds
    s_add_u32 m0, s65, 65280
    s_add_u32 s70, s67, 522240
    buffer_load_dwordx4 v25, s[12:15], s70 offen lds
    s_add_u32 m0, s65, 69120
    s_add_u32 s70, s67, 552960
    buffer_load_dwordx4 v25, s[12:15], s70 offen lds
    s_add_u32 m0, s65, 72960
    s_add_u32 s70, s67, 583680
    buffer_load_dwordx4 v25, s[12:15], s70 offen lds
    s_add_u32 m0, s65, 76800
    s_add_u32 s70, s67, 614400
    buffer_load_dwordx4 v25, s[12:15], s70 offen lds
    s_add_u32 m0, s65, 80640
    s_add_u32 s70, s67, 645120
    buffer_load_dwordx4 v25, s[12:15], s70 offen lds
    s_add_u32 m0, s65, 84480
    s_add_u32 s70, s67, 675840
    buffer_load_dwordx4 v25, s[12:15], s70 offen lds
    s_add_u32 m0, s65, 88320
    s_add_u32 s70, s67, 706560
    buffer_load_dwordx4 v25, s[12:15], s70 offen lds
    s_mov_b64 exec, s[68:69]
    s_waitcnt vmcnt(21)
    s_barrier
    v_add_u32 v22, 0, v23
    ds_read_b64_tr_b16 v[64:65], v22 offset:0
    ds_read_b64_tr_b16 v[66:67], v22 offset:640
    ds_read_b64_tr_b16 v[68:69], v22 offset:32
    ds_read_b64_tr_b16 v[70:71], v22 offset:672
    ds_read_b64_tr_b16 v[72:73], v22 offset:64
    ds_read_b64_tr_b16 v[74:75], v22 offset:704
    ds_read_b64_tr_b16 v[76:77], v22 offset:96
    ds_read_b64_tr_b16 v[78:79], v22 offset:736
    ds_read_b64_tr_b16 v[80:81], v22 offset:128
    ds_read_b64_tr_b16 v[82:83], v22 offset:768
    v_add_u32 v22, 5120, v23
    ds_read_b64_tr_b16 v[100:101], v22 offset:0
    ds_read_b64_tr_b16 v[102:103], v22 offset:640
    ds_read_b64_tr_b16 v[104:105], v22 offset:32
    ds_read_b64_tr_b16 v[106:107], v22 offset:672
    ds_read_b64_tr_b16 v[108:109], v22 offset:64
    ds_read_b64_tr_b16 v[110:111], v22 offset:704
    ds_read_b64_tr_b16 v[112:113], v22 offset:96
    ds_read_b64_tr_b16 v[114:115], v22 offset:736
    ds_read_b64_tr_b16 v[116:117], v22 offset:128
    ds_read_b64_tr_b16 v[118:119], v22 offset:768
    s_waitcnt lgkmcnt(10)
    v_mfma_f32_16x16x32_bf16 v[28:31], v[64:67], v[136:139], v[28:31]
    v_mfma_f32_16x16x32_bf16 v[32:35], v[68:71], v[136:139], v[32:35]
    v_mfma_f32_16x16x32_bf16 v[36:39], v[72:75], v[136:139], v[36:39]
    v_mfma_f32_16x16x32_bf16 v[40:43], v[76:79], v[136:139], v[40:43]
    v_mfma_f32_16x16x32_bf16 v[44:47], v[80:83], v[136:139], v[44:47]
    v_add_u32 v22, 10240, v23
    ds_read_b64_tr_b16 v[64:65], v22 offset:0
    ds_read_b64_tr_b16 v[66:67], v22 offset:640
    ds_read_b64_tr_b16 v[68:69], v22 offset:32
    ds_read_b64_tr_b16 v[70:71], v22 offset:672
    ds_read_b64_tr_b16 v[72:73], v22 offset:64
    ds_read_b64_tr_b16 v[74:75], v22 offset:704
    ds_read_b64_tr_b16 v[76:77], v22 offset:96
    ds_read_b64_tr_b16 v[78:79], v22 offset:736
    ds_read_b64_tr_b16 v[80:81], v22 offset:128
    ds_read_b64_tr_b16 v[82:83], v22 offset:768
    s_waitcnt lgkmcnt(10)
    v_mfma_f32_16x16x32_bf16 v[28:31], v[100:103], v[140:143], v[28:31]
    v_mfma_f32_16x16x32_bf16 v[32:35], v[104:107], v[140:143], v[32:35]
    v_mfma_f32_16x16x32_bf16 v[36:39], v[108:111], v[140:143], v[36:39]
    v_mfma_f32_16x16x32_bf16 v[40:43], v[112:115], v[140:143], v[40:43]
    v_mfma_f32_16x16x32_bf16 v[44:47], v[116:119], v[140:143], v[44:47]
    v_add_u32 v22, 15360, v23
    ds_read_b64_tr_b16 v[100:101], v22 offset:0
    ds_read_b64_tr_b16 v[102:103], v22 offset:640
    ds_read_b64_tr_b16 v[104:105], v22 offset:32
    ds_read_b64_tr_b16 v[106:107], v22 offset:672
    ds_read_b64_tr_b16 v[108:109], v22 offset:64
    ds_read_b64_tr_b16 v[110:111], v22 offset:704
    ds_read_b64_tr_b16 v[112:113], v22 offset:96
    ds_read_b64_tr_b16 v[114:115], v22 offset:736
    ds_read_b64_tr_b16 v[116:117], v22 offset:128
    ds_read_b64_tr_b16 v[118:119], v22 offset:768
    s_waitcnt lgkmcnt(10)
    v_mfma_f32_16x16x32_bf16 v[28:31], v[64:67], v[144:147], v[28:31]
    v_mfma_f32_16x16x32_bf16 v[32:35], v[68:71], v[144:147], v[32:35]
    v_mfma_f32_16x16x32_bf16 v[36:39], v[72:75], v[144:147], v[36:39]
    v_mfma_f32_16x16x32_bf16 v[40:43], v[76:79], v[144:147], v[40:43]
    v_mfma_f32_16x16x32_bf16 v[44:47], v[80:83], v[144:147], v[44:47]
    v_add_u32 v22, 20480, v23
    ds_read_b64_tr_b16 v[64:65], v22 offset:0
    ds_read_b64_tr_b16 v[66:67], v22 offset:640
    ds_read_b64_tr_b16 v[68:69], v22 offset:32
    ds_read_b64_tr_b16 v[70:71], v22 offset:672
    ds_read_b64_tr_b16 v[72:73], v22 offset:64
    ds_read_b64_tr_b16 v[74:75], v22 offset:704
    ds_read_b64_tr_b16 v[76:77], v22 offset:96
    ds_read_b64_tr_b16 v[78:79], v22 offset:736
    ds_read_b64_tr_b16 v[80:81], v22 offset:128
    ds_read_b64_tr_b16 v[82:83], v22 offset:768
    s_waitcnt lgkmcnt(10)
    v_mfma_f32_16x16x32_bf16 v[28:31], v[100:103], v[148:151], v[28:31]
    v_mfma_f32_16x16x32_bf16 v[32:35], v[104:107], v[148:151], v[32:35]
    v_mfma_f32_16x16x32_bf16 v[36:39], v[108:111], v[148:151], v[36:39]
    v_mfma_f32_16x16x32_bf16 v[40:43], v[112:115], v[148:151], v[40:43]
    v_mfma_f32_16x16x32_bf16 v[44:47], v[116:119], v[148:151], v[44:47]
    v_add_u32 v22, 25600, v23
    ds_read_b64_tr_b16 v[100:101], v22 offset:0
    ds_read_b64_tr_b16 v[102:103], v22 offset:640
    ds_read_b64_tr_b16 v[104:105], v22 offset:32
    ds_read_b64_tr_b16 v[106:107], v22 offset:672
    ds_read_b64_tr_b16 v[108:109], v22 offset:64
    ds_read_b64_tr_b16 v[110:111], v22 offset:704
    ds_read_b64_tr_b16 v[112:113], v22 offset:96
    ds_read_b64_tr_b16 v[114:115], v22 offset:736
    ds_read_b64_tr_b16 v[116:117], v22 offset:128
    ds_read_b64_tr_b16 v[118:119], v22 offset:768
    s_waitcnt lgkmcnt(10)
    v_mfma_f32_16x16x32_bf16 v[28:31], v[64:67], v[152:155], v[28:31]
    v_mfma_f32_16x16x32_bf16 v[32:35], v[68:71], v[152:155], v[32:35]
    v_mfma_f32_16x16x32_bf16 v[36:39], v[72:75], v[152:155], v[36:39]
    v_mfma_f32_16x16x32_bf16 v[40:43], v[76:79], v[152:155], v[40:43]
    v_mfma_f32_16x16x32_bf16 v[44:47], v[80:83], v[152:155], v[44:47]
    v_add_u32 v22, 30720, v23
    ds_read_b64_tr_b16 v[64:65], v22 offset:0
    ds_read_b64_tr_b16 v[66:67], v22 offset:640
    ds_read_b64_tr_b16 v[68:69], v22 offset:32
    ds_read_b64_tr_b16 v[70:71], v22 offset:672
    ds_read_b64_tr_b16 v[72:73], v22 offset:64
    ds_read_b64_tr_b16 v[74:75], v22 offset:704
    ds_read_b64_tr_b16 v[76:77], v22 offset:96
    ds_read_b64_tr_b16 v[78:79], v22 offset:736
    ds_read_b64_tr_b16 v[80:81], v22 offset:128
    ds_read_b64_tr_b16 v[82:83], v22 offset:768
    s_waitcnt lgkmcnt(10)
    v_mfma_f32_16x16x32_bf16 v[28:31], v[100:103], v[156:159], v[28:31]
    v_mfma_f32_16x16x32_bf16 v[32:35], v[104:107], v[156:159], v[32:35]
    v_mfma_f32_16x16x32_bf16 v[36:39], v[108:111], v[156:159], v[36:39]
    v_mfma_f32_16x16x32_bf16 v[40:43], v[112:115], v[156:159], v[40:43]
    v_mfma_f32_16x16x32_bf16 v[44:47], v[116:119], v[156:159], v[44:47]
    v_add_u32 v22, 35840, v23
    ds_read_b64_tr_b16 v[100:101], v22 offset:0
    ds_read_b64_tr_b16 v[102:103], v22 offset:640
    ds_read_b64_tr_b16 v[104:105], v22 offset:32
    ds_read_b64_tr_b16 v[106:107], v22 offset:672
    ds_read_b64_tr_b16 v[108:109], v22 offset:64
    ds_read_b64_tr_b16 v[110:111], v22 offset:704
    ds_read_b64_tr_b16 v[112:113], v22 offset:96
    ds_read_b64_tr_b16 v[114:115], v22 offset:736
    ds_read_b64_tr_b16 v[116:117], v22 offset:128
    ds_read_b64_tr_b16 v[118:119], v22 offset:768
    s_waitcnt lgkmcnt(10)
    v_mfma_f32_16x16x32_bf16 v[28:31], v[64:67], v[160:163], v[28:31]
    v_mfma_f32_16x16x32_bf16 v[32:35], v[68:71], v[160:163], v[32:35]
    v_mfma_f32_16x16x32_bf16 v[36:39], v[72:75], v[160:163], v[36:39]
    v_mfma_f32_16x16x32_bf16 v[40:43], v[76:79], v[160:163], v[40:43]
    v_mfma_f32_16x16x32_bf16 v[44:47], v[80:83], v[160:163], v[44:47]
    v_add_u32 v22, 40960, v23
    ds_read_b64_tr_b16 v[64:65], v22 offset:0
    ds_read_b64_tr_b16 v[66:67], v22 offset:640
    ds_read_b64_tr_b16 v[68:69], v22 offset:32
    ds_read_b64_tr_b16 v[70:71], v22 offset:672
    ds_read_b64_tr_b16 v[72:73], v22 offset:64
    ds_read_b64_tr_b16 v[74:75], v22 offset:704
    ds_read_b64_tr_b16 v[76:77], v22 offset:96
    ds_read_b64_tr_b16 v[78:79], v22 offset:736
    ds_read_b64_tr_b16 v[80:81], v22 offset:128
    ds_read_b64_tr_b16 v[82:83], v22 offset:768
    s_waitcnt lgkmcnt(10)
    v_mfma_f32_16x16x32_bf16 v[28:31], v[100:103], v[164:167], v[28:31]
    v_mfma_f32_16x16x32_bf16 v[32:35], v[104:107], v[164:167], v[32:35]
    v_mfma_f32_16x16x32_bf16 v[36:39], v[108:111], v[164:167], v[36:39]
    v_mfma_f32_16x16x32_bf16 v[40:43], v[112:115], v[164:167], v[40:43]
    v_mfma_f32_16x16x32_bf16 v[44:47], v[116:119], v[164:167], v[44:47]
    s_waitcnt lgkmcnt(0)
    v_mfma_f32_16x16x32_bf16 v[28:31], v[64:67], v[168:171], v[28:31]
    v_mfma_f32_16x16x32_bf16 v[32:35], v[68:71], v[168:171], v[32:35]
    v_mfma_f32_16x16x32_bf16 v[36:39], v[72:75], v[168:171], v[36:39]
    v_mfma_f32_16x16x32_bf16 v[40:43], v[76:79], v[168:171], v[40:43]
    v_mfma_f32_16x16x32_bf16 v[44:47], v[80:83], v[168:171], v[44:47]
    s_barrier
    buffer_load_dwordx4 v[136:139], v18, s[8:11], 0 offen offset:1152
    buffer_load_dwordx4 v[140:143], v18, s[8:11], 0 offen offset:1216
    buffer_load_dwordx4 v[144:147], v18, s[8:11], 0 offen offset:1280
    buffer_load_dwordx4 v[148:151], v18, s[8:11], 0 offen offset:1344
    buffer_load_dwordx4 v[152:155], v18, s[8:11], 0 offen offset:1408
    buffer_load_dwordx4 v[156:159], v18, s[8:11], 0 offen offset:1472
    buffer_load_dwordx4 v[160:163], v18, s[8:11], 0 offen offset:1536
    buffer_load_dwordx4 v[164:167], v18, s[8:11], 0 offen offset:1600
    buffer_load_dwordx4 v[168:171], v18, s[8:11], 0 offen offset:1664
    s_mov_b64 s[68:69], exec
    s_mov_b32 exec_hi, 0xfffffff
    s_add_u32 m0, s65, 0
    s_add_u32 s70, s67, 737280
    buffer_load_dwordx4 v25, s[12:15], s70 offen lds
    s_add_u32 m0, s65, 3840
    s_add_u32 s70, s67, 768000
    buffer_load_dwordx4 v25, s[12:15], s70 offen lds
    s_add_u32 m0, s65, 7680
    s_add_u32 s70, s67, 798720
    buffer_load_dwordx4 v25, s[12:15], s70 offen lds
    s_add_u32 m0, s65, 11520
    s_add_u32 s70, s67, 829440
    buffer_load_dwordx4 v25, s[12:15], s70 offen lds
    s_add_u32 m0, s65, 15360
    s_add_u32 s70, s67, 860160
    buffer_load_dwordx4 v25, s[12:15], s70 offen lds
    s_add_u32 m0, s65, 19200
    s_add_u32 s70, s67, 890880
    buffer_load_dwordx4 v25, s[12:15], s70 offen lds
    s_add_u32 m0, s65, 23040
    s_add_u32 s70, s67, 921600
    buffer_load_dwordx4 v25, s[12:15], s70 offen lds
    s_add_u32 m0, s65, 26880
    s_add_u32 s70, s67, 952320
    buffer_load_dwordx4 v25, s[12:15], s70 offen lds
    s_add_u32 m0, s65, 30720
    s_add_u32 s70, s67, 983040
    buffer_load_dwordx4 v25, s[12:15], s70 offen lds
    s_add_u32 m0, s65, 34560
    s_add_u32 s70, s67, 1013760
    buffer_load_dwordx4 v25, s[12:15], s70 offen lds
    s_add_u32 m0, s65, 38400
    s_add_u32 s70, s67, 1044480
    buffer_load_dwordx4 v25, s[12:15], s70 offen lds
    s_add_u32 m0, s65, 42240
    s_add_u32 s70, s67, 1075200
    buffer_load_dwordx4 v25, s[12:15], s70 offen lds
    s_mov_b64 exec, s[68:69]
    s_waitcnt vmcnt(21)
    s_barrier
    v_add_u32 v22, 46080, v23
    ds_read_b64_tr_b16 v[64:65], v22 offset:0
    ds_read_b64_tr_b16 v[66:67], v22 offset:640
    ds_read_b64_tr_b16 v[68:69], v22 offset:32
    ds_read_b64_tr_b16 v[70:71], v22 offset:672
    ds_read_b64_tr_b16 v[72:73], v22 offset:64
    ds_read_b64_tr_b16 v[74:75], v22 offset:704
    ds_read_b64_tr_b16 v[76:77], v22 offset:96
    ds_read_b64_tr_b16 v[78:79], v22 offset:736
    ds_read_b64_tr_b16 v[80:81], v22 offset:128
    ds_read_b64_tr_b16 v[82:83], v22 offset:768
    v_add_u32 v22, 51200, v23
    ds_read_b64_tr_b16 v[100:101], v22 offset:0
    ds_read_b64_tr_b16 v[102:103], v22 offset:640
    ds_read_b64_tr_b16 v[104:105], v22 offset:32
    ds_read_b64_tr_b16 v[106:107], v22 offset:672
    ds_read_b64_tr_b16 v[108:109], v22 offset:64
    ds_read_b64_tr_b16 v[110:111], v22 offset:704
    ds_read_b64_tr_b16 v[112:113], v22 offset:96
    ds_read_b64_tr_b16 v[114:115], v22 offset:736
    ds_read_b64_tr_b16 v[116:117], v22 offset:128
    ds_read_b64_tr_b16 v[118:119], v22 offset:768
    s_waitcnt lgkmcnt(10)
    v_mfma_f32_16x16x32_bf16 v[28:31], v[64:67], v[172:175], v[28:31]
    v_mfma_f32_16x16x32_bf16 v[32:35], v[68:71], v[172:175], v[32:35]
    v_mfma_f32_16x16x32_bf16 v[36:39], v[72:75], v[172:175], v[36:39]
    v_mfma_f32_16x16x32_bf16 v[40:43], v[76:79], v[172:175], v[40:43]
    v_mfma_f32_16x16x32_bf16 v[44:47], v[80:83], v[172:175], v[44:47]
    v_add_u32 v22, 56320, v23
    ds_read_b64_tr_b16 v[64:65], v22 offset:0
    ds_read_b64_tr_b16 v[66:67], v22 offset:640
    ds_read_b64_tr_b16 v[68:69], v22 offset:32
    ds_read_b64_tr_b16 v[70:71], v22 offset:672
    ds_read_b64_tr_b16 v[72:73], v22 offset:64
    ds_read_b64_tr_b16 v[74:75], v22 offset:704
    ds_read_b64_tr_b16 v[76:77], v22 offset:96
    ds_read_b64_tr_b16 v[78:79], v22 offset:736
    ds_read_b64_tr_b16 v[80:81], v22 offset:128
    ds_read_b64_tr_b16 v[82:83], v22 offset:768
    s_waitcnt lgkmcnt(10)
    v_mfma_f32_16x16x32_bf16 v[28:31], v[100:103], v[176:179], v[28:31]
    v_mfma_f32_16x16x32_bf16 v[32:35], v[104:107], v[176:179], v[32:35]
    v_mfma_f32_16x16x32_bf16 v[36:39], v[108:111], v[176:179], v[36:39]
    v_mfma_f32_16x16x32_bf16 v[40:43], v[112:115], v[176:179], v[40:43]
    v_mfma_f32_16x16x32_bf16 v[44:47], v[116:119], v[176:179], v[44:47]
    v_add_u32 v22, 61440, v23
    ds_read_b64_tr_b16 v[100:101], v22 offset:0
    ds_read_b64_tr_b16 v[102:103], v22 offset:640
    ds_read_b64_tr_b16 v[104:105], v22 offset:32
    ds_read_b64_tr_b16 v[106:107], v22 offset:672
    ds_read_b64_tr_b16 v[108:109], v22 offset:64
    ds_read_b64_tr_b16 v[110:111], v22 offset:704
    ds_read_b64_tr_b16 v[112:113], v22 offset:96
    ds_read_b64_tr_b16 v[114:115], v22 offset:736
    ds_read_b64_tr_b16 v[116:117], v22 offset:128
    ds_read_b64_tr_b16 v[118:119], v22 offset:768
    s_waitcnt lgkmcnt(10)
    v_mfma_f32_16x16x32_bf16 v[28:31], v[64:67], v[180:183], v[28:31]
    v_mfma_f32_16x16x32_bf16 v[32:35], v[68:71], v[180:183], v[32:35]
    v_mfma_f32_16x16x32_bf16 v[36:39], v[72:75], v[180:183], v[36:39]
    v_mfma_f32_16x16x32_bf16 v[40:43], v[76:79], v[180:183], v[40:43]
    v_mfma_f32_16x16x32_bf16 v[44:47], v[80:83], v[180:183], v[44:47]
    v_add_u32 v22, 66560, v23
    ds_read_b64_tr_b16 v[64:65], v22 offset:0
    ds_read_b64_tr_b16 v[66:67], v22 offset:640
    ds_read_b64_tr_b16 v[68:69], v22 offset:32
    ds_read_b64_tr_b16 v[70:71], v22 offset:672
    ds_read_b64_tr_b16 v[72:73], v22 offset:64
    ds_read_b64_tr_b16 v[74:75], v22 offset:704
    ds_read_b64_tr_b16 v[76:77], v22 offset:96
    ds_read_b64_tr_b16 v[78:79], v22 offset:736
    ds_read_b64_tr_b16 v[80:81], v22 offset:128
    ds_read_b64_tr_b16 v[82:83], v22 offset:768
    s_waitcnt lgkmcnt(10)
    v_mfma_f32_16x16x32_bf16 v[28:31], v[100:103], v[184:187], v[28:31]
    v_mfma_f32_16x16x32_bf16 v[32:35], v[104:107], v[184:187], v[32:35]
    v_mfma_f32_16x16x32_bf16 v[36:39], v[108:111], v[184:187], v[36:39]
    v_mfma_f32_16x16x32_bf16 v[40:43], v[112:115], v[184:187], v[40:43]
    v_mfma_f32_16x16x32_bf16 v[44:47], v[116:119], v[184:187], v[44:47]
    v_add_u32 v22, 71680, v23
    ds_read_b64_tr_b16 v[100:101], v22 offset:0
    ds_read_b64_tr_b16 v[102:103], v22 offset:640
    ds_read_b64_tr_b16 v[104:105], v22 offset:32
    ds_read_b64_tr_b16 v[106:107], v22 offset:672
    ds_read_b64_tr_b16 v[108:109], v22 offset:64
    ds_read_b64_tr_b16 v[110:111], v22 offset:704
    ds_read_b64_tr_b16 v[112:113], v22 offset:96
    ds_read_b64_tr_b16 v[114:115], v22 offset:736
    ds_read_b64_tr_b16 v[116:117], v22 offset:128
    ds_read_b64_tr_b16 v[118:119], v22 offset:768
    s_waitcnt lgkmcnt(10)
    v_mfma_f32_16x16x32_bf16 v[28:31], v[64:67], v[188:191], v[28:31]
    v_mfma_f32_16x16x32_bf16 v[32:35], v[68:71], v[188:191], v[32:35]
    v_mfma_f32_16x16x32_bf16 v[36:39], v[72:75], v[188:191], v[36:39]
    v_mfma_f32_16x16x32_bf16 v[40:43], v[76:79], v[188:191], v[40:43]
    v_mfma_f32_16x16x32_bf16 v[44:47], v[80:83], v[188:191], v[44:47]
    v_add_u32 v22, 76800, v23
    ds_read_b64_tr_b16 v[64:65], v22 offset:0
    ds_read_b64_tr_b16 v[66:67], v22 offset:640
    ds_read_b64_tr_b16 v[68:69], v22 offset:32
    ds_read_b64_tr_b16 v[70:71], v22 offset:672
    ds_read_b64_tr_b16 v[72:73], v22 offset:64
    ds_read_b64_tr_b16 v[74:75], v22 offset:704
    ds_read_b64_tr_b16 v[76:77], v22 offset:96
    ds_read_b64_tr_b16 v[78:79], v22 offset:736
    ds_read_b64_tr_b16 v[80:81], v22 offset:128
    ds_read_b64_tr_b16 v[82:83], v22 offset:768
    s_waitcnt lgkmcnt(10)
    v_mfma_f32_16x16x32_bf16 v[28:31], v[100:103], v[192:195], v[28:31]
    v_mfma_f32_16x16x32_bf16 v[32:35], v[104:107], v[192:195], v[32:35]
    v_mfma_f32_16x16x32_bf16 v[36:39], v[108:111], v[192:195], v[36:39]
    v_mfma_f32_16x16x32_bf16 v[40:43], v[112:115], v[192:195], v[40:43]
    v_mfma_f32_16x16x32_bf16 v[44:47], v[116:119], v[192:195], v[44:47]
    v_add_u32 v22, 81920, v23
    ds_read_b64_tr_b16 v[100:101], v22 offset:0
    ds_read_b64_tr_b16 v[102:103], v22 offset:640
    ds_read_b64_tr_b16 v[104:105], v22 offset:32
    ds_read_b64_tr_b16 v[106:107], v22 offset:672
    ds_read_b64_tr_b16 v[108:109], v22 offset:64
    ds_read_b64_tr_b16 v[110:111], v22 offset:704
    ds_read_b64_tr_b16 v[112:113], v22 offset:96
    ds_read_b64_tr_b16 v[114:115], v22 offset:736
    ds_read_b64_tr_b16 v[116:117], v22 offset:128
    ds_read_b64_tr_b16 v[118:119], v22 offset:768
    s_waitcnt lgkmcnt(10)
    v_mfma_f32_16x16x32_bf16 v[28:31], v[64:67], v[196:199], v[28:31]
    v_mfma_f32_16x16x32_bf16 v[32:35], v[68:71], v[196:199], v[32:35]
    v_mfma_f32_16x16x32_bf16 v[36:39], v[72:75], v[196:199], v[36:39]
    v_mfma_f32_16x16x32_bf16 v[40:43], v[76:79], v[196:199], v[40:43]
    v_mfma_f32_16x16x32_bf16 v[44:47], v[80:83], v[196:199], v[44:47]
    v_add_u32 v22, 87040, v23
    ds_read_b64_tr_b16 v[64:65], v22 offset:0
    ds_read_b64_tr_b16 v[66:67], v22 offset:640
    ds_read_b64_tr_b16 v[68:69], v22 offset:32
    ds_read_b64_tr_b16 v[70:71], v22 offset:672
    ds_read_b64_tr_b16 v[72:73], v22 offset:64
    ds_read_b64_tr_b16 v[74:75], v22 offset:704
    ds_read_b64_tr_b16 v[76:77], v22 offset:96
    ds_read_b64_tr_b16 v[78:79], v22 offset:736
    ds_read_b64_tr_b16 v[80:81], v22 offset:128
    ds_read_b64_tr_b16 v[82:83], v22 offset:768
    s_waitcnt lgkmcnt(10)
    v_mfma_f32_16x16x32_bf16 v[28:31], v[100:103], v[200:203], v[28:31]
    v_mfma_f32_16x16x32_bf16 v[32:35], v[104:107], v[200:203], v[32:35]
    v_mfma_f32_16x16x32_bf16 v[36:39], v[108:111], v[200:203], v[36:39]
    v_mfma_f32_16x16x32_bf16 v[40:43], v[112:115], v[200:203], v[40:43]
    v_mfma_f32_16x16x32_bf16 v[44:47], v[116:119], v[200:203], v[44:47]
    s_waitcnt lgkmcnt(0)
    v_mfma_f32_16x16x32_bf16 v[28:31], v[64:67], v[204:207], v[28:31]
    v_mfma_f32_16x16x32_bf16 v[32:35], v[68:71], v[204:207], v[32:35]
    v_mfma_f32_16x16x32_bf16 v[36:39], v[72:75], v[204:207], v[36:39]
    v_mfma_f32_16x16x32_bf16 v[40:43], v[76:79], v[204:207], v[40:43]
    v_mfma_f32_16x16x32_bf16 v[44:47], v[80:83], v[204:207], v[44:47]
    s_barrier
    buffer_load_dwordx4 v[172:175], v18, s[8:11], 0 offen offset:1728
    buffer_load_dwordx4 v[176:179], v18, s[8:11], 0 offen offset:1792
    buffer_load_dwordx4 v[180:183], v18, s[8:11], 0 offen offset:1856
    buffer_load_dwordx4 v[184:187], v18, s[8:11], 0 offen offset:1920
    buffer_load_dwordx4 v[188:191], v18, s[8:11], 0 offen offset:1984
    buffer_load_dwordx4 v[192:195], v18, s[8:11], 0 offen offset:2048
    buffer_load_dwordx4 v[196:199], v18, s[8:11], 0 offen offset:2112
    buffer_load_dwordx4 v[200:203], v18, s[8:11], 0 offen offset:2176
    buffer_load_dwordx4 v[204:207], v18, s[8:11], 0 offen offset:2240
    s_mov_b64 s[68:69], exec
    s_mov_b32 exec_hi, 0xfffffff
    s_add_u32 m0, s65, 46080
    s_add_u32 s70, s67, 1105920
    buffer_load_dwordx4 v25, s[12:15], s70 offen lds
    s_add_u32 m0, s65, 49920
    s_add_u32 s70, s67, 1136640
    buffer_load_dwordx4 v25, s[12:15], s70 offen lds
    s_add_u32 m0, s65, 53760
    s_add_u32 s70, s67, 1167360
    buffer_load_dwordx4 v25, s[12:15], s70 offen lds
    s_add_u32 m0, s65, 57600
    s_add_u32 s70, s67, 1198080
    buffer_load_dwordx4 v25, s[12:15], s70 offen lds
    s_add_u32 m0, s65, 61440
    s_add_u32 s70, s67, 1228800
    buffer_load_dwordx4 v25, s[12:15], s70 offen lds
    s_add_u32 m0, s65, 65280
    s_add_u32 s70, s67, 1259520
    buffer_load_dwordx4 v25, s[12:15], s70 offen lds
    s_add_u32 m0, s65, 69120
    s_add_u32 s70, s67, 1290240
    buffer_load_dwordx4 v25, s[12:15], s70 offen lds
    s_add_u32 m0, s65, 72960
    s_add_u32 s70, s67, 1320960
    buffer_load_dwordx4 v25, s[12:15], s70 offen lds
    s_add_u32 m0, s65, 76800
    s_add_u32 s70, s67, 1351680
    buffer_load_dwordx4 v25, s[12:15], s70 offen lds
    s_add_u32 m0, s65, 80640
    s_add_u32 s70, s67, 1382400
    buffer_load_dwordx4 v25, s[12:15], s70 offen lds
    s_add_u32 m0, s65, 84480
    s_add_u32 s70, s67, 1413120
    buffer_load_dwordx4 v25, s[12:15], s70 offen lds
    s_add_u32 m0, s65, 88320
    s_add_u32 s70, s67, 1443840
    buffer_load_dwordx4 v25, s[12:15], s70 offen lds
    s_mov_b64 exec, s[68:69]
    s_waitcnt vmcnt(21)
    s_barrier
    v_add_u32 v22, 0, v23
    ds_read_b64_tr_b16 v[64:65], v22 offset:0
    ds_read_b64_tr_b16 v[66:67], v22 offset:640
    ds_read_b64_tr_b16 v[68:69], v22 offset:32
    ds_read_b64_tr_b16 v[70:71], v22 offset:672
    ds_read_b64_tr_b16 v[72:73], v22 offset:64
    ds_read_b64_tr_b16 v[74:75], v22 offset:704
    ds_read_b64_tr_b16 v[76:77], v22 offset:96
    ds_read_b64_tr_b16 v[78:79], v22 offset:736
    ds_read_b64_tr_b16 v[80:81], v22 offset:128
    ds_read_b64_tr_b16 v[82:83], v22 offset:768
    v_add_u32 v22, 5120, v23
    ds_read_b64_tr_b16 v[100:101], v22 offset:0
    ds_read_b64_tr_b16 v[102:103], v22 offset:640
    ds_read_b64_tr_b16 v[104:105], v22 offset:32
    ds_read_b64_tr_b16 v[106:107], v22 offset:672
    ds_read_b64_tr_b16 v[108:109], v22 offset:64
    ds_read_b64_tr_b16 v[110:111], v22 offset:704
    ds_read_b64_tr_b16 v[112:113], v22 offset:96
    ds_read_b64_tr_b16 v[114:115], v22 offset:736
    ds_read_b64_tr_b16 v[116:117], v22 offset:128
    ds_read_b64_tr_b16 v[118:119], v22 offset:768
    s_waitcnt lgkmcnt(10)
    v_mfma_f32_16x16x32_bf16 v[28:31], v[64:67], v[136:139], v[28:31]
    v_mfma_f32_16x16x32_bf16 v[32:35], v[68:71], v[136:139], v[32:35]
    v_mfma_f32_16x16x32_bf16 v[36:39], v[72:75], v[136:139], v[36:39]
    v_mfma_f32_16x16x32_bf16 v[40:43], v[76:79], v[136:139], v[40:43]
    v_mfma_f32_16x16x32_bf16 v[44:47], v[80:83], v[136:139], v[44:47]
    v_add_u32 v22, 10240, v23
    ds_read_b64_tr_b16 v[64:65], v22 offset:0
    ds_read_b64_tr_b16 v[66:67], v22 offset:640
    ds_read_b64_tr_b16 v[68:69], v22 offset:32
    ds_read_b64_tr_b16 v[70:71], v22 offset:672
    ds_read_b64_tr_b16 v[72:73], v22 offset:64
    ds_read_b64_tr_b16 v[74:75], v22 offset:704
    ds_read_b64_tr_b16 v[76:77], v22 offset:96
    ds_read_b64_tr_b16 v[78:79], v22 offset:736
    ds_read_b64_tr_b16 v[80:81], v22 offset:128
    ds_read_b64_tr_b16 v[82:83], v22 offset:768
    s_waitcnt lgkmcnt(10)
    v_mfma_f32_16x16x32_bf16 v[28:31], v[100:103], v[140:143], v[28:31]
    v_mfma_f32_16x16x32_bf16 v[32:35], v[104:107], v[140:143], v[32:35]
    v_mfma_f32_16x16x32_bf16 v[36:39], v[108:111], v[140:143], v[36:39]
    v_mfma_f32_16x16x32_bf16 v[40:43], v[112:115], v[140:143], v[40:43]
    v_mfma_f32_16x16x32_bf16 v[44:47], v[116:119], v[140:143], v[44:47]
    v_add_u32 v22, 15360, v23
    ds_read_b64_tr_b16 v[100:101], v22 offset:0
    ds_read_b64_tr_b16 v[102:103], v22 offset:640
    ds_read_b64_tr_b16 v[104:105], v22 offset:32
    ds_read_b64_tr_b16 v[106:107], v22 offset:672
    ds_read_b64_tr_b16 v[108:109], v22 offset:64
    ds_read_b64_tr_b16 v[110:111], v22 offset:704
    ds_read_b64_tr_b16 v[112:113], v22 offset:96
    ds_read_b64_tr_b16 v[114:115], v22 offset:736
    ds_read_b64_tr_b16 v[116:117], v22 offset:128
    ds_read_b64_tr_b16 v[118:119], v22 offset:768
    s_waitcnt lgkmcnt(10)
    v_mfma_f32_16x16x32_bf16 v[28:31], v[64:67], v[144:147], v[28:31]
    v_mfma_f32_16x16x32_bf16 v[32:35], v[68:71], v[144:147], v[32:35]
    v_mfma_f32_16x16x32_bf16 v[36:39], v[72:75], v[144:147], v[36:39]
    v_mfma_f32_16x16x32_bf16 v[40:43], v[76:79], v[144:147], v[40:43]
    v_mfma_f32_16x16x32_bf16 v[44:47], v[80:83], v[144:147], v[44:47]
    v_add_u32 v22, 20480, v23
    ds_read_b64_tr_b16 v[64:65], v22 offset:0
    ds_read_b64_tr_b16 v[66:67], v22 offset:640
    ds_read_b64_tr_b16 v[68:69], v22 offset:32
    ds_read_b64_tr_b16 v[70:71], v22 offset:672
    ds_read_b64_tr_b16 v[72:73], v22 offset:64
    ds_read_b64_tr_b16 v[74:75], v22 offset:704
    ds_read_b64_tr_b16 v[76:77], v22 offset:96
    ds_read_b64_tr_b16 v[78:79], v22 offset:736
    ds_read_b64_tr_b16 v[80:81], v22 offset:128
    ds_read_b64_tr_b16 v[82:83], v22 offset:768
    s_waitcnt lgkmcnt(10)
    v_mfma_f32_16x16x32_bf16 v[28:31], v[100:103], v[148:151], v[28:31]
    v_mfma_f32_16x16x32_bf16 v[32:35], v[104:107], v[148:151], v[32:35]
    v_mfma_f32_16x16x32_bf16 v[36:39], v[108:111], v[148:151], v[36:39]
    v_mfma_f32_16x16x32_bf16 v[40:43], v[112:115], v[148:151], v[40:43]
    v_mfma_f32_16x16x32_bf16 v[44:47], v[116:119], v[148:151], v[44:47]
    v_add_u32 v22, 25600, v23
    ds_read_b64_tr_b16 v[100:101], v22 offset:0
    ds_read_b64_tr_b16 v[102:103], v22 offset:640
    ds_read_b64_tr_b16 v[104:105], v22 offset:32
    ds_read_b64_tr_b16 v[106:107], v22 offset:672
    ds_read_b64_tr_b16 v[108:109], v22 offset:64
    ds_read_b64_tr_b16 v[110:111], v22 offset:704
    ds_read_b64_tr_b16 v[112:113], v22 offset:96
    ds_read_b64_tr_b16 v[114:115], v22 offset:736
    ds_read_b64_tr_b16 v[116:117], v22 offset:128
    ds_read_b64_tr_b16 v[118:119], v22 offset:768
    s_waitcnt lgkmcnt(10)
    v_mfma_f32_16x16x32_bf16 v[28:31], v[64:67], v[152:155], v[28:31]
    v_mfma_f32_16x16x32_bf16 v[32:35], v[68:71], v[152:155], v[32:35]
    v_mfma_f32_16x16x32_bf16 v[36:39], v[72:75], v[152:155], v[36:39]
    v_mfma_f32_16x16x32_bf16 v[40:43], v[76:79], v[152:155], v[40:43]
    v_mfma_f32_16x16x32_bf16 v[44:47], v[80:83], v[152:155], v[44:47]
    v_add_u32 v22, 30720, v23
    ds_read_b64_tr_b16 v[64:65], v22 offset:0
    ds_read_b64_tr_b16 v[66:67], v22 offset:640
    ds_read_b64_tr_b16 v[68:69], v22 offset:32
    ds_read_b64_tr_b16 v[70:71], v22 offset:672
    ds_read_b64_tr_b16 v[72:73], v22 offset:64
    ds_read_b64_tr_b16 v[74:75], v22 offset:704
    ds_read_b64_tr_b16 v[76:77], v22 offset:96
    ds_read_b64_tr_b16 v[78:79], v22 offset:736
    ds_read_b64_tr_b16 v[80:81], v22 offset:128
    ds_read_b64_tr_b16 v[82:83], v22 offset:768
    s_waitcnt lgkmcnt(10)
    v_mfma_f32_16x16x32_bf16 v[28:31], v[100:103], v[156:159], v[28:31]
    v_mfma_f32_16x16x32_bf16 v[32:35], v[104:107], v[156:159], v[32:35]
    v_mfma_f32_16x16x32_bf16 v[36:39], v[108:111], v[156:159], v[36:39]
    v_mfma_f32_16x16x32_bf16 v[40:43], v[112:115], v[156:159], v[40:43]
    v_mfma_f32_16x16x32_bf16 v[44:47], v[116:119], v[156:159], v[44:47]
    v_add_u32 v22, 35840, v23
    ds_read_b64_tr_b16 v[100:101], v22 offset:0
    ds_read_b64_tr_b16 v[102:103], v22 offset:640
    ds_read_b64_tr_b16 v[104:105], v22 offset:32
    ds_read_b64_tr_b16 v[106:107], v22 offset:672
    ds_read_b64_tr_b16 v[108:109], v22 offset:64
    ds_read_b64_tr_b16 v[110:111], v22 offset:704
    ds_read_b64_tr_b16 v[112:113], v22 offset:96
    ds_read_b64_tr_b16 v[114:115], v22 offset:736
    ds_read_b64_tr_b16 v[116:117], v22 offset:128
    ds_read_b64_tr_b16 v[118:119], v22 offset:768
    s_waitcnt lgkmcnt(10)
    v_mfma_f32_16x16x32_bf16 v[28:31], v[64:67], v[160:163], v[28:31]
    v_mfma_f32_16x16x32_bf16 v[32:35], v[68:71], v[160:163], v[32:35]
    v_mfma_f32_16x16x32_bf16 v[36:39], v[72:75], v[160:163], v[36:39]
    v_mfma_f32_16x16x32_bf16 v[40:43], v[76:79], v[160:163], v[40:43]
    v_mfma_f32_16x16x32_bf16 v[44:47], v[80:83], v[160:163], v[44:47]
    v_add_u32 v22, 40960, v23
    ds_read_b64_tr_b16 v[64:65], v22 offset:0
    ds_read_b64_tr_b16 v[66:67], v22 offset:640
    ds_read_b64_tr_b16 v[68:69], v22 offset:32
    ds_read_b64_tr_b16 v[70:71], v22 offset:672
    ds_read_b64_tr_b16 v[72:73], v22 offset:64
    ds_read_b64_tr_b16 v[74:75], v22 offset:704
    ds_read_b64_tr_b16 v[76:77], v22 offset:96
    ds_read_b64_tr_b16 v[78:79], v22 offset:736
    ds_read_b64_tr_b16 v[80:81], v22 offset:128
    ds_read_b64_tr_b16 v[82:83], v22 offset:768
    s_waitcnt lgkmcnt(10)
    v_mfma_f32_16x16x32_bf16 v[28:31], v[100:103], v[164:167], v[28:31]
    v_mfma_f32_16x16x32_bf16 v[32:35], v[104:107], v[164:167], v[32:35]
    v_mfma_f32_16x16x32_bf16 v[36:39], v[108:111], v[164:167], v[36:39]
    v_mfma_f32_16x16x32_bf16 v[40:43], v[112:115], v[164:167], v[40:43]
    v_mfma_f32_16x16x32_bf16 v[44:47], v[116:119], v[164:167], v[44:47]
    s_waitcnt lgkmcnt(0)
    v_mfma_f32_16x16x32_bf16 v[28:31], v[64:67], v[168:171], v[28:31]
    v_mfma_f32_16x16x32_bf16 v[32:35], v[68:71], v[168:171], v[32:35]
    v_mfma_f32_16x16x32_bf16 v[36:39], v[72:75], v[168:171], v[36:39]
    v_mfma_f32_16x16x32_bf16 v[40:43], v[76:79], v[168:171], v[40:43]
    v_mfma_f32_16x16x32_bf16 v[44:47], v[80:83], v[168:171], v[44:47]
    s_barrier
    buffer_load_dwordx4 v[136:139], v18, s[8:11], 0 offen offset:2304
    buffer_load_dwordx4 v[140:143], v18, s[8:11], 0 offen offset:2368
    buffer_load_dwordx4 v[144:147], v18, s[8:11], 0 offen offset:2432
    buffer_load_dwordx4 v[148:151], v18, s[8:11], 0 offen offset:2496
    buffer_load_dwordx4 v[152:155], v18, s[8:11], 0 offen offset:2560
    buffer_load_dwordx4 v[156:159], v18, s[8:11], 0 offen offset:2624
    buffer_load_dwordx4 v[160:163], v18, s[8:11], 0 offen offset:2688
    buffer_load_dwordx4 v[164:167], v18, s[8:11], 0 offen offset:2752
    buffer_load_dwordx4 v[168:171], v18, s[8:11], 0 offen offset:2816
    s_mov_b64 s[68:69], exec
    s_mov_b32 exec_hi, 0xfffffff
    s_add_u32 m0, s65, 0
    s_add_u32 s70, s67, 1474560
    buffer_load_dwordx4 v25, s[12:15], s70 offen lds
    s_add_u32 m0, s65, 3840
    s_add_u32 s70, s67, 1505280
    buffer_load_dwordx4 v25, s[12:15], s70 offen lds
    s_add_u32 m0, s65, 7680
    s_add_u32 s70, s67, 1536000
    buffer_load_dwordx4 v25, s[12:15], s70 offen lds
    s_add_u32 m0, s65, 11520
    s_add_u32 s70, s67, 1566720
    buffer_load_dwordx4 v25, s[12:15], s70 offen lds
    s_add_u32 m0, s65, 15360
    s_add_u32 s70, s67, 1597440
    buffer_load_dwordx4 v25, s[12:15], s70 offen lds
    s_add_u32 m0, s65, 19200
    s_add_u32 s70, s67, 1628160
    buffer_load_dwordx4 v25, s[12:15], s70 offen lds
    s_add_u32 m0, s65, 23040
    s_add_u32 s70, s67, 1658880
    buffer_load_dwordx4 v25, s[12:15], s70 offen lds
    s_add_u32 m0, s65, 26880
    s_add_u32 s70, s67, 1689600
    buffer_load_dwordx4 v25, s[12:15], s70 offen lds
    s_add_u32 m0, s65, 30720
    s_add_u32 s70, s67, 1720320
    buffer_load_dwordx4 v25, s[12:15], s70 offen lds
    s_add_u32 m0, s65, 34560
    s_add_u32 s70, s67, 1751040
    buffer_load_dwordx4 v25, s[12:15], s70 offen lds
    s_add_u32 m0, s65, 38400
    s_add_u32 s70, s67, 1781760
    buffer_load_dwordx4 v25, s[12:15], s70 offen lds
    s_add_u32 m0, s65, 42240
    s_add_u32 s70, s67, 1812480
    buffer_load_dwordx4 v25, s[12:15], s70 offen lds
    s_mov_b64 exec, s[68:69]
    s_waitcnt vmcnt(21)
    s_barrier
    v_add_u32 v22, 46080, v23
    ds_read_b64_tr_b16 v[64:65], v22 offset:0
    ds_read_b64_tr_b16 v[66:67], v22 offset:640
    ds_read_b64_tr_b16 v[68:69], v22 offset:32
    ds_read_b64_tr_b16 v[70:71], v22 offset:672
    ds_read_b64_tr_b16 v[72:73], v22 offset:64
    ds_read_b64_tr_b16 v[74:75], v22 offset:704
    ds_read_b64_tr_b16 v[76:77], v22 offset:96
    ds_read_b64_tr_b16 v[78:79], v22 offset:736
    ds_read_b64_tr_b16 v[80:81], v22 offset:128
    ds_read_b64_tr_b16 v[82:83], v22 offset:768
    v_add_u32 v22, 51200, v23
    ds_read_b64_tr_b16 v[100:101], v22 offset:0
    ds_read_b64_tr_b16 v[102:103], v22 offset:640
    ds_read_b64_tr_b16 v[104:105], v22 offset:32
    ds_read_b64_tr_b16 v[106:107], v22 offset:672
    ds_read_b64_tr_b16 v[108:109], v22 offset:64
    ds_read_b64_tr_b16 v[110:111], v22 offset:704
    ds_read_b64_tr_b16 v[112:113], v22 offset:96
    ds_read_b64_tr_b16 v[114:115], v22 offset:736
    ds_read_b64_tr_b16 v[116:117], v22 offset:128
    ds_read_b64_tr_b16 v[118:119], v22 offset:768
    s_waitcnt lgkmcnt(10)
    v_mfma_f32_16x16x32_bf16 v[28:31], v[64:67], v[172:175], v[28:31]
    v_mfma_f32_16x16x32_bf16 v[32:35], v[68:71], v[172:175], v[32:35]
    v_mfma_f32_16x16x32_bf16 v[36:39], v[72:75], v[172:175], v[36:39]
    v_mfma_f32_16x16x32_bf16 v[40:43], v[76:79], v[172:175], v[40:43]
    v_mfma_f32_16x16x32_bf16 v[44:47], v[80:83], v[172:175], v[44:47]
    v_add_u32 v22, 56320, v23
    ds_read_b64_tr_b16 v[64:65], v22 offset:0
    ds_read_b64_tr_b16 v[66:67], v22 offset:640
    ds_read_b64_tr_b16 v[68:69], v22 offset:32
    ds_read_b64_tr_b16 v[70:71], v22 offset:672
    ds_read_b64_tr_b16 v[72:73], v22 offset:64
    ds_read_b64_tr_b16 v[74:75], v22 offset:704
    ds_read_b64_tr_b16 v[76:77], v22 offset:96
    ds_read_b64_tr_b16 v[78:79], v22 offset:736
    ds_read_b64_tr_b16 v[80:81], v22 offset:128
    ds_read_b64_tr_b16 v[82:83], v22 offset:768
    s_waitcnt lgkmcnt(10)
    v_mfma_f32_16x16x32_bf16 v[28:31], v[100:103], v[176:179], v[28:31]
    v_mfma_f32_16x16x32_bf16 v[32:35], v[104:107], v[176:179], v[32:35]
    v_mfma_f32_16x16x32_bf16 v[36:39], v[108:111], v[176:179], v[36:39]
    v_mfma_f32_16x16x32_bf16 v[40:43], v[112:115], v[176:179], v[40:43]
    v_mfma_f32_16x16x32_bf16 v[44:47], v[116:119], v[176:179], v[44:47]
    v_add_u32 v22, 61440, v23
    ds_read_b64_tr_b16 v[100:101], v22 offset:0
    ds_read_b64_tr_b16 v[102:103], v22 offset:640
    ds_read_b64_tr_b16 v[104:105], v22 offset:32
    ds_read_b64_tr_b16 v[106:107], v22 offset:672
    ds_read_b64_tr_b16 v[108:109], v22 offset:64
    ds_read_b64_tr_b16 v[110:111], v22 offset:704
    ds_read_b64_tr_b16 v[112:113], v22 offset:96
    ds_read_b64_tr_b16 v[114:115], v22 offset:736
    ds_read_b64_tr_b16 v[116:117], v22 offset:128
    ds_read_b64_tr_b16 v[118:119], v22 offset:768
    s_waitcnt lgkmcnt(10)
    v_mfma_f32_16x16x32_bf16 v[28:31], v[64:67], v[180:183], v[28:31]
    v_mfma_f32_16x16x32_bf16 v[32:35], v[68:71], v[180:183], v[32:35]
    v_mfma_f32_16x16x32_bf16 v[36:39], v[72:75], v[180:183], v[36:39]
    v_mfma_f32_16x16x32_bf16 v[40:43], v[76:79], v[180:183], v[40:43]
    v_mfma_f32_16x16x32_bf16 v[44:47], v[80:83], v[180:183], v[44:47]
    v_add_u32 v22, 66560, v23
    ds_read_b64_tr_b16 v[64:65], v22 offset:0
    ds_read_b64_tr_b16 v[66:67], v22 offset:640
    ds_read_b64_tr_b16 v[68:69], v22 offset:32
    ds_read_b64_tr_b16 v[70:71], v22 offset:672
    ds_read_b64_tr_b16 v[72:73], v22 offset:64
    ds_read_b64_tr_b16 v[74:75], v22 offset:704
    ds_read_b64_tr_b16 v[76:77], v22 offset:96
    ds_read_b64_tr_b16 v[78:79], v22 offset:736
    ds_read_b64_tr_b16 v[80:81], v22 offset:128
    ds_read_b64_tr_b16 v[82:83], v22 offset:768
    s_waitcnt lgkmcnt(10)
    v_mfma_f32_16x16x32_bf16 v[28:31], v[100:103], v[184:187], v[28:31]
    v_mfma_f32_16x16x32_bf16 v[32:35], v[104:107], v[184:187], v[32:35]
    v_mfma_f32_16x16x32_bf16 v[36:39], v[108:111], v[184:187], v[36:39]
    v_mfma_f32_16x16x32_bf16 v[40:43], v[112:115], v[184:187], v[40:43]
    v_mfma_f32_16x16x32_bf16 v[44:47], v[116:119], v[184:187], v[44:47]
    v_add_u32 v22, 71680, v23
    ds_read_b64_tr_b16 v[100:101], v22 offset:0
    ds_read_b64_tr_b16 v[102:103], v22 offset:640
    ds_read_b64_tr_b16 v[104:105], v22 offset:32
    ds_read_b64_tr_b16 v[106:107], v22 offset:672
    ds_read_b64_tr_b16 v[108:109], v22 offset:64
    ds_read_b64_tr_b16 v[110:111], v22 offset:704
    ds_read_b64_tr_b16 v[112:113], v22 offset:96
    ds_read_b64_tr_b16 v[114:115], v22 offset:736
    ds_read_b64_tr_b16 v[116:117], v22 offset:128
    ds_read_b64_tr_b16 v[118:119], v22 offset:768
    s_waitcnt lgkmcnt(10)
    v_mfma_f32_16x16x32_bf16 v[28:31], v[64:67], v[188:191], v[28:31]
    v_mfma_f32_16x16x32_bf16 v[32:35], v[68:71], v[188:191], v[32:35]
    v_mfma_f32_16x16x32_bf16 v[36:39], v[72:75], v[188:191], v[36:39]
    v_mfma_f32_16x16x32_bf16 v[40:43], v[76:79], v[188:191], v[40:43]
    v_mfma_f32_16x16x32_bf16 v[44:47], v[80:83], v[188:191], v[44:47]
    v_add_u32 v22, 76800, v23
    ds_read_b64_tr_b16 v[64:65], v22 offset:0
    ds_read_b64_tr_b16 v[66:67], v22 offset:640
    ds_read_b64_tr_b16 v[68:69], v22 offset:32
    ds_read_b64_tr_b16 v[70:71], v22 offset:672
    ds_read_b64_tr_b16 v[72:73], v22 offset:64
    ds_read_b64_tr_b16 v[74:75], v22 offset:704
    ds_read_b64_tr_b16 v[76:77], v22 offset:96
    ds_read_b64_tr_b16 v[78:79], v22 offset:736
    ds_read_b64_tr_b16 v[80:81], v22 offset:128
    ds_read_b64_tr_b16 v[82:83], v22 offset:768
    s_waitcnt lgkmcnt(10)
    v_mfma_f32_16x16x32_bf16 v[28:31], v[100:103], v[192:195], v[28:31]
    v_mfma_f32_16x16x32_bf16 v[32:35], v[104:107], v[192:195], v[32:35]
    v_mfma_f32_16x16x32_bf16 v[36:39], v[108:111], v[192:195], v[36:39]
    v_mfma_f32_16x16x32_bf16 v[40:43], v[112:115], v[192:195], v[40:43]
    v_mfma_f32_16x16x32_bf16 v[44:47], v[116:119], v[192:195], v[44:47]
    v_add_u32 v22, 81920, v23
    ds_read_b64_tr_b16 v[100:101], v22 offset:0
    ds_read_b64_tr_b16 v[102:103], v22 offset:640
    ds_read_b64_tr_b16 v[104:105], v22 offset:32
    ds_read_b64_tr_b16 v[106:107], v22 offset:672
    ds_read_b64_tr_b16 v[108:109], v22 offset:64
    ds_read_b64_tr_b16 v[110:111], v22 offset:704
    ds_read_b64_tr_b16 v[112:113], v22 offset:96
    ds_read_b64_tr_b16 v[114:115], v22 offset:736
    ds_read_b64_tr_b16 v[116:117], v22 offset:128
    ds_read_b64_tr_b16 v[118:119], v22 offset:768
    s_waitcnt lgkmcnt(10)
    v_mfma_f32_16x16x32_bf16 v[28:31], v[64:67], v[196:199], v[28:31]
    v_mfma_f32_16x16x32_bf16 v[32:35], v[68:71], v[196:199], v[32:35]
    v_mfma_f32_16x16x32_bf16 v[36:39], v[72:75], v[196:199], v[36:39]
    v_mfma_f32_16x16x32_bf16 v[40:43], v[76:79], v[196:199], v[40:43]
    v_mfma_f32_16x16x32_bf16 v[44:47], v[80:83], v[196:199], v[44:47]
    v_add_u32 v22, 87040, v23
    ds_read_b64_tr_b16 v[64:65], v22 offset:0
    ds_read_b64_tr_b16 v[66:67], v22 offset:640
    ds_read_b64_tr_b16 v[68:69], v22 offset:32
    ds_read_b64_tr_b16 v[70:71], v22 offset:672
    ds_read_b64_tr_b16 v[72:73], v22 offset:64
    ds_read_b64_tr_b16 v[74:75], v22 offset:704
    ds_read_b64_tr_b16 v[76:77], v22 offset:96
    ds_read_b64_tr_b16 v[78:79], v22 offset:736
    ds_read_b64_tr_b16 v[80:81], v22 offset:128
    ds_read_b64_tr_b16 v[82:83], v22 offset:768
    s_waitcnt lgkmcnt(10)
    v_mfma_f32_16x16x32_bf16 v[28:31], v[100:103], v[200:203], v[28:31]
    v_mfma_f32_16x16x32_bf16 v[32:35], v[104:107], v[200:203], v[32:35]
    v_mfma_f32_16x16x32_bf16 v[36:39], v[108:111], v[200:203], v[36:39]
    v_mfma_f32_16x16x32_bf16 v[40:43], v[112:115], v[200:203], v[40:43]
    v_mfma_f32_16x16x32_bf16 v[44:47], v[116:119], v[200:203], v[44:47]
    s_waitcnt lgkmcnt(0)
    v_mfma_f32_16x16x32_bf16 v[28:31], v[64:67], v[204:207], v[28:31]
    v_mfma_f32_16x16x32_bf16 v[32:35], v[68:71], v[204:207], v[32:35]
    v_mfma_f32_16x16x32_bf16 v[36:39], v[72:75], v[204:207], v[36:39]
    v_mfma_f32_16x16x32_bf16 v[40:43], v[76:79], v[204:207], v[40:43]
    v_mfma_f32_16x16x32_bf16 v[44:47], v[80:83], v[204:207], v[44:47]
    s_barrier
    buffer_load_dwordx4 v[172:175], v18, s[8:11], 0 offen offset:2880
    buffer_load_dwordx4 v[176:179], v18, s[8:11], 0 offen offset:2944
    buffer_load_dwordx4 v[180:183], v18, s[8:11], 0 offen offset:3008
    buffer_load_dwordx4 v[184:187], v18, s[8:11], 0 offen offset:3072
    buffer_load_dwordx4 v[188:191], v18, s[8:11], 0 offen offset:3136
    buffer_load_dwordx4 v[192:195], v18, s[8:11], 0 offen offset:3200
    buffer_load_dwordx4 v[196:199], v18, s[8:11], 0 offen offset:3264
    buffer_load_dwordx4 v[200:203], v18, s[8:11], 0 offen offset:3328
    buffer_load_dwordx4 v[204:207], v18, s[8:11], 0 offen offset:3392
    s_mov_b64 s[68:69], exec
    s_mov_b32 exec_hi, 0xfffffff
    s_add_u32 m0, s65, 46080
    s_add_u32 s70, s67, 1843200
    buffer_load_dwordx4 v25, s[12:15], s70 offen lds
    s_add_u32 m0, s65, 49920
    s_add_u32 s70, s67, 1873920
    buffer_load_dwordx4 v25, s[12:15], s70 offen lds
    s_add_u32 m0, s65, 53760
    s_add_u32 s70, s67, 1904640
    buffer_load_dwordx4 v25, s[12:15], s70 offen lds
    s_add_u32 m0, s65, 57600
    s_add_u32 s70, s67, 1935360
    buffer_load_dwordx4 v25, s[12:15], s70 offen lds
    s_add_u32 m0, s65, 61440
    s_add_u32 s70, s67, 1966080
    buffer_load_dwordx4 v25, s[12:15], s70 offen lds
    s_add_u32 m0, s65, 65280
    s_add_u32 s70, s67, 1996800
    buffer_load_dwordx4 v25, s[12:15], s70 offen lds
    s_add_u32 m0, s65, 69120
    s_add_u32 s70, s67, 2027520
    buffer_load_dwordx4 v25, s[12:15], s70 offen lds
    s_add_u32 m0, s65, 72960
    s_add_u32 s70, s67, 2058240
    buffer_load_dwordx4 v25, s[12:15], s70 offen lds
    s_add_u32 m0, s65, 76800
    s_add_u32 s70, s67, 2088960
    buffer_load_dwordx4 v25, s[12:15], s70 offen lds
    s_add_u32 m0, s65, 80640
    s_add_u32 s70, s67, 2119680
    buffer_load_dwordx4 v25, s[12:15], s70 offen lds
    s_add_u32 m0, s65, 84480
    s_add_u32 s70, s67, 2150400
    buffer_load_dwordx4 v25, s[12:15], s70 offen lds
    s_add_u32 m0, s65, 88320
    s_add_u32 s70, s67, 2181120
    buffer_load_dwordx4 v25, s[12:15], s70 offen lds
    s_mov_b64 exec, s[68:69]
    s_waitcnt vmcnt(21)
    s_barrier
    v_add_u32 v22, 0, v23
    ds_read_b64_tr_b16 v[64:65], v22 offset:0
    ds_read_b64_tr_b16 v[66:67], v22 offset:640
    ds_read_b64_tr_b16 v[68:69], v22 offset:32
    ds_read_b64_tr_b16 v[70:71], v22 offset:672
    ds_read_b64_tr_b16 v[72:73], v22 offset:64
    ds_read_b64_tr_b16 v[74:75], v22 offset:704
    ds_read_b64_tr_b16 v[76:77], v22 offset:96
    ds_read_b64_tr_b16 v[78:79], v22 offset:736
    ds_read_b64_tr_b16 v[80:81], v22 offset:128
    ds_read_b64_tr_b16 v[82:83], v22 offset:768
    v_add_u32 v22, 5120, v23
    ds_read_b64_tr_b16 v[100:101], v22 offset:0
    ds_read_b64_tr_b16 v[102:103], v22 offset:640
    ds_read_b64_tr_b16 v[104:105], v22 offset:32
    ds_read_b64_tr_b16 v[106:107], v22 offset:672
    ds_read_b64_tr_b16 v[108:109], v22 offset:64
    ds_read_b64_tr_b16 v[110:111], v22 offset:704
    ds_read_b64_tr_b16 v[112:113], v22 offset:96
    ds_read_b64_tr_b16 v[114:115], v22 offset:736
    ds_read_b64_tr_b16 v[116:117], v22 offset:128
    ds_read_b64_tr_b16 v[118:119], v22 offset:768
    s_waitcnt lgkmcnt(10)
    v_mfma_f32_16x16x32_bf16 v[28:31], v[64:67], v[136:139], v[28:31]
    v_mfma_f32_16x16x32_bf16 v[32:35], v[68:71], v[136:139], v[32:35]
    v_mfma_f32_16x16x32_bf16 v[36:39], v[72:75], v[136:139], v[36:39]
    v_mfma_f32_16x16x32_bf16 v[40:43], v[76:79], v[136:139], v[40:43]
    v_mfma_f32_16x16x32_bf16 v[44:47], v[80:83], v[136:139], v[44:47]
    v_add_u32 v22, 10240, v23
    ds_read_b64_tr_b16 v[64:65], v22 offset:0
    ds_read_b64_tr_b16 v[66:67], v22 offset:640
    ds_read_b64_tr_b16 v[68:69], v22 offset:32
    ds_read_b64_tr_b16 v[70:71], v22 offset:672
    ds_read_b64_tr_b16 v[72:73], v22 offset:64
    ds_read_b64_tr_b16 v[74:75], v22 offset:704
    ds_read_b64_tr_b16 v[76:77], v22 offset:96
    ds_read_b64_tr_b16 v[78:79], v22 offset:736
    ds_read_b64_tr_b16 v[80:81], v22 offset:128
    ds_read_b64_tr_b16 v[82:83], v22 offset:768
    s_waitcnt lgkmcnt(10)
    v_mfma_f32_16x16x32_bf16 v[28:31], v[100:103], v[140:143], v[28:31]
    v_mfma_f32_16x16x32_bf16 v[32:35], v[104:107], v[140:143], v[32:35]
    v_mfma_f32_16x16x32_bf16 v[36:39], v[108:111], v[140:143], v[36:39]
    v_mfma_f32_16x16x32_bf16 v[40:43], v[112:115], v[140:143], v[40:43]
    v_mfma_f32_16x16x32_bf16 v[44:47], v[116:119], v[140:143], v[44:47]
    v_add_u32 v22, 15360, v23
    ds_read_b64_tr_b16 v[100:101], v22 offset:0
    ds_read_b64_tr_b16 v[102:103], v22 offset:640
    ds_read_b64_tr_b16 v[104:105], v22 offset:32
    ds_read_b64_tr_b16 v[106:107], v22 offset:672
    ds_read_b64_tr_b16 v[108:109], v22 offset:64
    ds_read_b64_tr_b16 v[110:111], v22 offset:704
    ds_read_b64_tr_b16 v[112:113], v22 offset:96
    ds_read_b64_tr_b16 v[114:115], v22 offset:736
    ds_read_b64_tr_b16 v[116:117], v22 offset:128
    ds_read_b64_tr_b16 v[118:119], v22 offset:768
    s_waitcnt lgkmcnt(10)
    v_mfma_f32_16x16x32_bf16 v[28:31], v[64:67], v[144:147], v[28:31]
    v_mfma_f32_16x16x32_bf16 v[32:35], v[68:71], v[144:147], v[32:35]
    v_mfma_f32_16x16x32_bf16 v[36:39], v[72:75], v[144:147], v[36:39]
    v_mfma_f32_16x16x32_bf16 v[40:43], v[76:79], v[144:147], v[40:43]
    v_mfma_f32_16x16x32_bf16 v[44:47], v[80:83], v[144:147], v[44:47]
    v_add_u32 v22, 20480, v23
    ds_read_b64_tr_b16 v[64:65], v22 offset:0
    ds_read_b64_tr_b16 v[66:67], v22 offset:640
    ds_read_b64_tr_b16 v[68:69], v22 offset:32
    ds_read_b64_tr_b16 v[70:71], v22 offset:672
    ds_read_b64_tr_b16 v[72:73], v22 offset:64
    ds_read_b64_tr_b16 v[74:75], v22 offset:704
    ds_read_b64_tr_b16 v[76:77], v22 offset:96
    ds_read_b64_tr_b16 v[78:79], v22 offset:736
    ds_read_b64_tr_b16 v[80:81], v22 offset:128
    ds_read_b64_tr_b16 v[82:83], v22 offset:768
    s_waitcnt lgkmcnt(10)
    v_mfma_f32_16x16x32_bf16 v[28:31], v[100:103], v[148:151], v[28:31]
    v_mfma_f32_16x16x32_bf16 v[32:35], v[104:107], v[148:151], v[32:35]
    v_mfma_f32_16x16x32_bf16 v[36:39], v[108:111], v[148:151], v[36:39]
    v_mfma_f32_16x16x32_bf16 v[40:43], v[112:115], v[148:151], v[40:43]
    v_mfma_f32_16x16x32_bf16 v[44:47], v[116:119], v[148:151], v[44:47]
    v_add_u32 v22, 25600, v23
    ds_read_b64_tr_b16 v[100:101], v22 offset:0
    ds_read_b64_tr_b16 v[102:103], v22 offset:640
    ds_read_b64_tr_b16 v[104:105], v22 offset:32
    ds_read_b64_tr_b16 v[106:107], v22 offset:672
    ds_read_b64_tr_b16 v[108:109], v22 offset:64
    ds_read_b64_tr_b16 v[110:111], v22 offset:704
    ds_read_b64_tr_b16 v[112:113], v22 offset:96
    ds_read_b64_tr_b16 v[114:115], v22 offset:736
    ds_read_b64_tr_b16 v[116:117], v22 offset:128
    ds_read_b64_tr_b16 v[118:119], v22 offset:768
    s_waitcnt lgkmcnt(10)
    v_mfma_f32_16x16x32_bf16 v[28:31], v[64:67], v[152:155], v[28:31]
    v_mfma_f32_16x16x32_bf16 v[32:35], v[68:71], v[152:155], v[32:35]
    v_mfma_f32_16x16x32_bf16 v[36:39], v[72:75], v[152:155], v[36:39]
    v_mfma_f32_16x16x32_bf16 v[40:43], v[76:79], v[152:155], v[40:43]
    v_mfma_f32_16x16x32_bf16 v[44:47], v[80:83], v[152:155], v[44:47]
    v_add_u32 v22, 30720, v23
    ds_read_b64_tr_b16 v[64:65], v22 offset:0
    ds_read_b64_tr_b16 v[66:67], v22 offset:640
    ds_read_b64_tr_b16 v[68:69], v22 offset:32
    ds_read_b64_tr_b16 v[70:71], v22 offset:672
    ds_read_b64_tr_b16 v[72:73], v22 offset:64
    ds_read_b64_tr_b16 v[74:75], v22 offset:704
    ds_read_b64_tr_b16 v[76:77], v22 offset:96
    ds_read_b64_tr_b16 v[78:79], v22 offset:736
    ds_read_b64_tr_b16 v[80:81], v22 offset:128
    ds_read_b64_tr_b16 v[82:83], v22 offset:768
    s_waitcnt lgkmcnt(10)
    v_mfma_f32_16x16x32_bf16 v[28:31], v[100:103], v[156:159], v[28:31]
    v_mfma_f32_16x16x32_bf16 v[32:35], v[104:107], v[156:159], v[32:35]
    v_mfma_f32_16x16x32_bf16 v[36:39], v[108:111], v[156:159], v[36:39]
    v_mfma_f32_16x16x32_bf16 v[40:43], v[112:115], v[156:159], v[40:43]
    v_mfma_f32_16x16x32_bf16 v[44:47], v[116:119], v[156:159], v[44:47]
    v_add_u32 v22, 35840, v23
    ds_read_b64_tr_b16 v[100:101], v22 offset:0
    ds_read_b64_tr_b16 v[102:103], v22 offset:640
    ds_read_b64_tr_b16 v[104:105], v22 offset:32
    ds_read_b64_tr_b16 v[106:107], v22 offset:672
    ds_read_b64_tr_b16 v[108:109], v22 offset:64
    ds_read_b64_tr_b16 v[110:111], v22 offset:704
    ds_read_b64_tr_b16 v[112:113], v22 offset:96
    ds_read_b64_tr_b16 v[114:115], v22 offset:736
    ds_read_b64_tr_b16 v[116:117], v22 offset:128
    ds_read_b64_tr_b16 v[118:119], v22 offset:768
    s_waitcnt lgkmcnt(10)
    v_mfma_f32_16x16x32_bf16 v[28:31], v[64:67], v[160:163], v[28:31]
    v_mfma_f32_16x16x32_bf16 v[32:35], v[68:71], v[160:163], v[32:35]
    v_mfma_f32_16x16x32_bf16 v[36:39], v[72:75], v[160:163], v[36:39]
    v_mfma_f32_16x16x32_bf16 v[40:43], v[76:79], v[160:163], v[40:43]
    v_mfma_f32_16x16x32_bf16 v[44:47], v[80:83], v[160:163], v[44:47]
    v_add_u32 v22, 40960, v23
    ds_read_b64_tr_b16 v[64:65], v22 offset:0
    ds_read_b64_tr_b16 v[66:67], v22 offset:640
    ds_read_b64_tr_b16 v[68:69], v22 offset:32
    ds_read_b64_tr_b16 v[70:71], v22 offset:672
    ds_read_b64_tr_b16 v[72:73], v22 offset:64
    ds_read_b64_tr_b16 v[74:75], v22 offset:704
    ds_read_b64_tr_b16 v[76:77], v22 offset:96
    ds_read_b64_tr_b16 v[78:79], v22 offset:736
    ds_read_b64_tr_b16 v[80:81], v22 offset:128
    ds_read_b64_tr_b16 v[82:83], v22 offset:768
    s_waitcnt lgkmcnt(10)
    v_mfma_f32_16x16x32_bf16 v[28:31], v[100:103], v[164:167], v[28:31]
    v_mfma_f32_16x16x32_bf16 v[32:35], v[104:107], v[164:167], v[32:35]
    v_mfma_f32_16x16x32_bf16 v[36:39], v[108:111], v[164:167], v[36:39]
    v_mfma_f32_16x16x32_bf16 v[40:43], v[112:115], v[164:167], v[40:43]
    v_mfma_f32_16x16x32_bf16 v[44:47], v[116:119], v[164:167], v[44:47]
    s_waitcnt lgkmcnt(0)
    v_mfma_f32_16x16x32_bf16 v[28:31], v[64:67], v[168:171], v[28:31]
    v_mfma_f32_16x16x32_bf16 v[32:35], v[68:71], v[168:171], v[32:35]
    v_mfma_f32_16x16x32_bf16 v[36:39], v[72:75], v[168:171], v[36:39]
    v_mfma_f32_16x16x32_bf16 v[40:43], v[76:79], v[168:171], v[40:43]
    v_mfma_f32_16x16x32_bf16 v[44:47], v[80:83], v[168:171], v[44:47]
    s_waitcnt vmcnt(0)
    s_barrier
    v_add_u32 v22, 46080, v23
    ds_read_b64_tr_b16 v[64:65], v22 offset:0
    ds_read_b64_tr_b16 v[66:67], v22 offset:640
    ds_read_b64_tr_b16 v[68:69], v22 offset:32
    ds_read_b64_tr_b16 v[70:71], v22 offset:672
    ds_read_b64_tr_b16 v[72:73], v22 offset:64
    ds_read_b64_tr_b16 v[74:75], v22 offset:704
    ds_read_b64_tr_b16 v[76:77], v22 offset:96
    ds_read_b64_tr_b16 v[78:79], v22 offset:736
    ds_read_b64_tr_b16 v[80:81], v22 offset:128
    ds_read_b64_tr_b16 v[82:83], v22 offset:768
    v_add_u32 v22, 51200, v23
    ds_read_b64_tr_b16 v[100:101], v22 offset:0
    ds_read_b64_tr_b16 v[102:103], v22 offset:640
    ds_read_b64_tr_b16 v[104:105], v22 offset:32
    ds_read_b64_tr_b16 v[106:107], v22 offset:672
    ds_read_b64_tr_b16 v[108:109], v22 offset:64
    ds_read_b64_tr_b16 v[110:111], v22 offset:704
    ds_read_b64_tr_b16 v[112:113], v22 offset:96
    ds_read_b64_tr_b16 v[114:115], v22 offset:736
    ds_read_b64_tr_b16 v[116:117], v22 offset:128
    ds_read_b64_tr_b16 v[118:119], v22 offset:768
    s_waitcnt lgkmcnt(10)
    v_mfma_f32_16x16x32_bf16 v[28:31], v[64:67], v[172:175], v[28:31]
    v_mfma_f32_16x16x32_bf16 v[32:35], v[68:71], v[172:175], v[32:35]
    v_mfma_f32_16x16x32_bf16 v[36:39], v[72:75], v[172:175], v[36:39]
    v_mfma_f32_16x16x32_bf16 v[40:43], v[76:79], v[172:175], v[40:43]
    v_mfma_f32_16x16x32_bf16 v[44:47], v[80:83], v[172:175], v[44:47]
    v_add_u32 v22, 56320, v23
    ds_read_b64_tr_b16 v[64:65], v22 offset:0
    ds_read_b64_tr_b16 v[66:67], v22 offset:640
    ds_read_b64_tr_b16 v[68:69], v22 offset:32
    ds_read_b64_tr_b16 v[70:71], v22 offset:672
    ds_read_b64_tr_b16 v[72:73], v22 offset:64
    ds_read_b64_tr_b16 v[74:75], v22 offset:704
    ds_read_b64_tr_b16 v[76:77], v22 offset:96
    ds_read_b64_tr_b16 v[78:79], v22 offset:736
    ds_read_b64_tr_b16 v[80:81], v22 offset:128
    ds_read_b64_tr_b16 v[82:83], v22 offset:768
    s_waitcnt lgkmcnt(10)
    v_mfma_f32_16x16x32_bf16 v[28:31], v[100:103], v[176:179], v[28:31]
    v_mfma_f32_16x16x32_bf16 v[32:35], v[104:107], v[176:179], v[32:35]
    v_mfma_f32_16x16x32_bf16 v[36:39], v[108:111], v[176:179], v[36:39]
    v_mfma_f32_16x16x32_bf16 v[40:43], v[112:115], v[176:179], v[40:43]
    v_mfma_f32_16x16x32_bf16 v[44:47], v[116:119], v[176:179], v[44:47]
    v_add_u32 v22, 61440, v23
    ds_read_b64_tr_b16 v[100:101], v22 offset:0
    ds_read_b64_tr_b16 v[102:103], v22 offset:640
    ds_read_b64_tr_b16 v[104:105], v22 offset:32
    ds_read_b64_tr_b16 v[106:107], v22 offset:672
    ds_read_b64_tr_b16 v[108:109], v22 offset:64
    ds_read_b64_tr_b16 v[110:111], v22 offset:704
    ds_read_b64_tr_b16 v[112:113], v22 offset:96
    ds_read_b64_tr_b16 v[114:115], v22 offset:736
    ds_read_b64_tr_b16 v[116:117], v22 offset:128
    ds_read_b64_tr_b16 v[118:119], v22 offset:768
    s_waitcnt lgkmcnt(10)
    v_mfma_f32_16x16x32_bf16 v[28:31], v[64:67], v[180:183], v[28:31]
    v_mfma_f32_16x16x32_bf16 v[32:35], v[68:71], v[180:183], v[32:35]
    v_mfma_f32_16x16x32_bf16 v[36:39], v[72:75], v[180:183], v[36:39]
    v_mfma_f32_16x16x32_bf16 v[40:43], v[76:79], v[180:183], v[40:43]
    v_mfma_f32_16x16x32_bf16 v[44:47], v[80:83], v[180:183], v[44:47]
    v_add_u32 v22, 66560, v23
    ds_read_b64_tr_b16 v[64:65], v22 offset:0
    ds_read_b64_tr_b16 v[66:67], v22 offset:640
    ds_read_b64_tr_b16 v[68:69], v22 offset:32
    ds_read_b64_tr_b16 v[70:71], v22 offset:672
    ds_read_b64_tr_b16 v[72:73], v22 offset:64
    ds_read_b64_tr_b16 v[74:75], v22 offset:704
    ds_read_b64_tr_b16 v[76:77], v22 offset:96
    ds_read_b64_tr_b16 v[78:79], v22 offset:736
    ds_read_b64_tr_b16 v[80:81], v22 offset:128
    ds_read_b64_tr_b16 v[82:83], v22 offset:768
    s_waitcnt lgkmcnt(10)
    v_mfma_f32_16x16x32_bf16 v[28:31], v[100:103], v[184:187], v[28:31]
    v_mfma_f32_16x16x32_bf16 v[32:35], v[104:107], v[184:187], v[32:35]
    v_mfma_f32_16x16x32_bf16 v[36:39], v[108:111], v[184:187], v[36:39]
    v_mfma_f32_16x16x32_bf16 v[40:43], v[112:115], v[184:187], v[40:43]
    v_mfma_f32_16x16x32_bf16 v[44:47], v[116:119], v[184:187], v[44:47]
    v_add_u32 v22, 71680, v23
    ds_read_b64_tr_b16 v[100:101], v22 offset:0
    ds_read_b64_tr_b16 v[102:103], v22 offset:640
    ds_read_b64_tr_b16 v[104:105], v22 offset:32
    ds_read_b64_tr_b16 v[106:107], v22 offset:672
    ds_read_b64_tr_b16 v[108:109], v22 offset:64
    ds_read_b64_tr_b16 v[110:111], v22 offset:704
    ds_read_b64_tr_b16 v[112:113], v22 offset:96
    ds_read_b64_tr_b16 v[114:115], v22 offset:736
    ds_read_b64_tr_b16 v[116:117], v22 offset:128
    ds_read_b64_tr_b16 v[118:119], v22 offset:768
    s_waitcnt lgkmcnt(10)
    v_mfma_f32_16x16x32_bf16 v[28:31], v[64:67], v[188:191], v[28:31]
    v_mfma_f32_16x16x32_bf16 v[32:35], v[68:71], v[188:191], v[32:35]
    v_mfma_f32_16x16x32_bf16 v[36:39], v[72:75], v[188:191], v[36:39]
    v_mfma_f32_16x16x32_bf16 v[40:43], v[76:79], v[188:191], v[40:43]
    v_mfma_f32_16x16x32_bf16 v[44:47], v[80:83], v[188:191], v[44:47]
    v_add_u32 v22, 76800, v23
    ds_read_b64_tr_b16 v[64:65], v22 offset:0
    ds_read_b64_tr_b16 v[66:67], v22 offset:640
    ds_read_b64_tr_b16 v[68:69], v22 offset:32
    ds_read_b64_tr_b16 v[70:71], v22 offset:672
    ds_read_b64_tr_b16 v[72:73], v22 offset:64
    ds_read_b64_tr_b16 v[74:75], v22 offset:704
    ds_read_b64_tr_b16 v[76:77], v22 offset:96
    ds_read_b64_tr_b16 v[78:79], v22 offset:736
    ds_read_b64_tr_b16 v[80:81], v22 offset:128
    ds_read_b64_tr_b16 v[82:83], v22 offset:768
    s_waitcnt lgkmcnt(10)
    v_mfma_f32_16x16x32_bf16 v[28:31], v[100:103], v[192:195], v[28:31]
    v_mfma_f32_16x16x32_bf16 v[32:35], v[104:107], v[192:195], v[32:35]
    v_mfma_f32_16x16x32_bf16 v[36:39], v[108:111], v[192:195], v[36:39]
    v_mfma_f32_16x16x32_bf16 v[40:43], v[112:115], v[192:195], v[40:43]
    v_mfma_f32_16x16x32_bf16 v[44:47], v[116:119], v[192:195], v[44:47]
    v_add_u32 v22, 81920, v23
    ds_read_b64_tr_b16 v[100:101], v22 offset:0
    ds_read_b64_tr_b16 v[102:103], v22 offset:640
    ds_read_b64_tr_b16 v[104:105], v22 offset:32
    ds_read_b64_tr_b16 v[106:107], v22 offset:672
    ds_read_b64_tr_b16 v[108:109], v22 offset:64
    ds_read_b64_tr_b16 v[110:111], v22 offset:704
    ds_read_b64_tr_b16 v[112:113], v22 offset:96
    ds_read_b64_tr_b16 v[114:115], v22 offset:736
    ds_read_b64_tr_b16 v[116:117], v22 offset:128
    ds_read_b64_tr_b16 v[118:119], v22 offset:768
    s_waitcnt lgkmcnt(10)
    v_mfma_f32_16x16x32_bf16 v[28:31], v[64:67], v[196:199], v[28:31]
    v_mfma_f32_16x16x32_bf16 v[32:35], v[68:71], v[196:199], v[32:35]
    v_mfma_f32_16x16x32_bf16 v[36:39], v[72:75], v[196:199], v[36:39]
    v_mfma_f32_16x16x32_bf16 v[40:43], v[76:79], v[196:199], v[40:43]
    v_mfma_f32_16x16x32_bf16 v[44:47], v[80:83], v[196:199], v[44:47]
    v_add_u32 v22, 87040, v23
    ds_read_b64_tr_b16 v[64:65], v22 offset:0
    ds_read_b64_tr_b16 v[66:67], v22 offset:640
    ds_read_b64_tr_b16 v[68:69], v22 offset:32
    ds_read_b64_tr_b16 v[70:71], v22 offset:672
    ds_read_b64_tr_b16 v[72:73], v22 offset:64
    ds_read_b64_tr_b16 v[74:75], v22 offset:704
    ds_read_b64_tr_b16 v[76:77], v22 offset:96
    ds_read_b64_tr_b16 v[78:79], v22 offset:736
    ds_read_b64_tr_b16 v[80:81], v22 offset:128
    ds_read_b64_tr_b16 v[82:83], v22 offset:768
    s_waitcnt lgkmcnt(10)
    v_mfma_f32_16x16x32_bf16 v[28:31], v[100:103], v[200:203], v[28:31]
    v_mfma_f32_16x16x32_bf16 v[32:35], v[104:107], v[200:203], v[32:35]
    v_mfma_f32_16x16x32_bf16 v[36:39], v[108:111], v[200:203], v[36:39]
    v_mfma_f32_16x16x32_bf16 v[40:43], v[112:115], v[200:203], v[40:43]
    v_mfma_f32_16x16x32_bf16 v[44:47], v[116:119], v[200:203], v[44:47]
    s_waitcnt lgkmcnt(0)
    v_mfma_f32_16x16x32_bf16 v[28:31], v[64:67], v[204:207], v[28:31]
    v_mfma_f32_16x16x32_bf16 v[32:35], v[68:71], v[204:207], v[32:35]
    v_mfma_f32_16x16x32_bf16 v[36:39], v[72:75], v[204:207], v[36:39]
    v_mfma_f32_16x16x32_bf16 v[40:43], v[76:79], v[204:207], v[40:43]
    v_mfma_f32_16x16x32_bf16 v[44:47], v[80:83], v[204:207], v[44:47]
    s_nop 15
    v_lshlrev_b32 v3, 16, v216
    v_add_f32 v28, v28, v3
    v_lshlrev_b32 v3, 16, v218
    v_add_f32 v28, v28, v3
    v_and_b32 v3, 0xffff0000, v216
    v_add_f32 v29, v29, v3
    v_and_b32 v3, 0xffff0000, v218
    v_add_f32 v29, v29, v3
    v_lshlrev_b32 v3, 16, v217
    v_add_f32 v30, v30, v3
    v_lshlrev_b32 v3, 16, v219
    v_add_f32 v30, v30, v3
    v_and_b32 v3, 0xffff0000, v217
    v_add_f32 v31, v31, v3
    v_and_b32 v3, 0xffff0000, v219
    v_add_f32 v31, v31, v3
    v_cvt_pk_bf16_f32 v26, v28, v29
    v_cvt_pk_bf16_f32 v27, v30, v31
    buffer_store_dwordx2 v[26:27], v24, s[16:19], 0 offen offset:0
    s_nop 0
    v_lshlrev_b32 v3, 16, v220
    v_add_f32 v32, v32, v3
    v_lshlrev_b32 v3, 16, v222
    v_add_f32 v32, v32, v3
    v_and_b32 v3, 0xffff0000, v220
    v_add_f32 v33, v33, v3
    v_and_b32 v3, 0xffff0000, v222
    v_add_f32 v33, v33, v3
    v_lshlrev_b32 v3, 16, v221
    v_add_f32 v34, v34, v3
    v_lshlrev_b32 v3, 16, v223
    v_add_f32 v34, v34, v3
    v_and_b32 v3, 0xffff0000, v221
    v_add_f32 v35, v35, v3
    v_and_b32 v3, 0xffff0000, v223
    v_add_f32 v35, v35, v3
    v_cvt_pk_bf16_f32 v26, v32, v33
    v_cvt_pk_bf16_f32 v27, v34, v35
    buffer_store_dwordx2 v[26:27], v24, s[16:19], 0 offen offset:32
    s_nop 0
    v_lshlrev_b32 v3, 16, v224
    v_add_f32 v36, v36, v3
    v_lshlrev_b32 v3, 16, v226
    v_add_f32 v36, v36, v3
    v_and_b32 v3, 0xffff0000, v224
    v_add_f32 v37, v37, v3
    v_and_b32 v3, 0xffff0000, v226
    v_add_f32 v37, v37, v3
    v_lshlrev_b32 v3, 16, v225
    v_add_f32 v38, v38, v3
    v_lshlrev_b32 v3, 16, v227
    v_add_f32 v38, v38, v3
    v_and_b32 v3, 0xffff0000, v225
    v_add_f32 v39, v39, v3
    v_and_b32 v3, 0xffff0000, v227
    v_add_f32 v39, v39, v3
    v_cvt_pk_bf16_f32 v26, v36, v37
    v_cvt_pk_bf16_f32 v27, v38, v39
    buffer_store_dwordx2 v[26:27], v24, s[16:19], 0 offen offset:64
    s_nop 0
    v_lshlrev_b32 v3, 16, v228
    v_add_f32 v40, v40, v3
    v_lshlrev_b32 v3, 16, v230
    v_add_f32 v40, v40, v3
    v_and_b32 v3, 0xffff0000, v228
    v_add_f32 v41, v41, v3
    v_and_b32 v3, 0xffff0000, v230
    v_add_f32 v41, v41, v3
    v_lshlrev_b32 v3, 16, v229
    v_add_f32 v42, v42, v3
    v_lshlrev_b32 v3, 16, v231
    v_add_f32 v42, v42, v3
    v_and_b32 v3, 0xffff0000, v229
    v_add_f32 v43, v43, v3
    v_and_b32 v3, 0xffff0000, v231
    v_add_f32 v43, v43, v3
    v_cvt_pk_bf16_f32 v26, v40, v41
    v_cvt_pk_bf16_f32 v27, v42, v43
    buffer_store_dwordx2 v[26:27], v24, s[16:19], 0 offen offset:96
    s_nop 0
    v_lshlrev_b32 v3, 16, v232
    v_add_f32 v44, v44, v3
    v_lshlrev_b32 v3, 16, v234
    v_add_f32 v44, v44, v3
    v_and_b32 v3, 0xffff0000, v232
    v_add_f32 v45, v45, v3
    v_and_b32 v3, 0xffff0000, v234
    v_add_f32 v45, v45, v3
    v_lshlrev_b32 v3, 16, v233
    v_add_f32 v46, v46, v3
    v_lshlrev_b32 v3, 16, v235
    v_add_f32 v46, v46, v3
    v_and_b32 v3, 0xffff0000, v233
    v_add_f32 v47, v47, v3
    v_and_b32 v3, 0xffff0000, v235
    v_add_f32 v47, v47, v3
    v_cvt_pk_bf16_f32 v26, v44, v45
    v_cvt_pk_bf16_f32 v27, v46, v47
    buffer_store_dwordx2 v[26:27], v24, s[16:19], 0 offen offset:128
    s_nop 0
    s_waitcnt vmcnt(0)
    s_endpgm
L_END_k7_w4_kernel:
    s_endpgm
.section .rodata,"a"
.p2align 6
.amdhsa_kernel k1_qkv_kernel
  .amdhsa_next_free_vgpr 256
  .amdhsa_next_free_sgpr 96
  .amdhsa_accum_offset 256
  .amdhsa_group_segment_fixed_size 0
  .amdhsa_kernarg_size 104
  .amdhsa_user_sgpr_count 2
  .amdhsa_user_sgpr_kernarg_segment_ptr 1
  .amdhsa_system_sgpr_workgroup_id_x 1
.end_amdhsa_kernel
.amdhsa_kernel k2_attn_kernel
  .amdhsa_next_free_vgpr 256
  .amdhsa_next_free_sgpr 96
  .amdhsa_accum_offset 256
  .amdhsa_group_segment_fixed_size 0
  .amdhsa_kernarg_size 104
  .amdhsa_user_sgpr_count 2
  .amdhsa_user_sgpr_kernarg_segment_ptr 1
  .amdhsa_system_sgpr_workgroup_id_x 1
.end_amdhsa_kernel
.amdhsa_kernel k3_wo_kernel
  .amdhsa_next_free_vgpr 256
  .amdhsa_next_free_sgpr 96
  .amdhsa_accum_offset 256
  .amdhsa_group_segment_fixed_size 0
  .amdhsa_kernarg_size 104
  .amdhsa_user_sgpr_count 2
  .amdhsa_user_sgpr_kernarg_segment_ptr 1
  .amdhsa_system_sgpr_workgroup_id_x 1
.end_amdhsa_kernel
.amdhsa_kernel k4_w1_kernel
  .amdhsa_next_free_vgpr 256
  .amdhsa_next_free_sgpr 96
  .amdhsa_accum_offset 256
  .amdhsa_group_segment_fixed_size 0
  .amdhsa_kernarg_size 104
  .amdhsa_user_sgpr_count 2
  .amdhsa_user_sgpr_kernarg_segment_ptr 1
  .amdhsa_system_sgpr_workgroup_id_x 1
.end_amdhsa_kernel
.amdhsa_kernel k5_w2_kernel
  .amdhsa_next_free_vgpr 256
  .amdhsa_next_free_sgpr 96
  .amdhsa_accum_offset 256
  .amdhsa_group_segment_fixed_size 0
  .amdhsa_kernarg_size 104
  .amdhsa_user_sgpr_count 2
  .amdhsa_user_sgpr_kernarg_segment_ptr 1
  .amdhsa_system_sgpr_workgroup_id_x 1
.end_amdhsa_kernel
.amdhsa_kernel k6_w3_kernel
  .amdhsa_next_free_vgpr 256
  .amdhsa_next_free_sgpr 96
  .amdhsa_accum_offset 256
  .amdhsa_group_segment_fixed_size 0
  .amdhsa_kernarg_size 104
  .amdhsa_user_sgpr_count 2
  .amdhsa_user_sgpr_kernarg_segment_ptr 1
  .amdhsa_system_sgpr_workgroup_id_x 1
.end_amdhsa_kernel
.amdhsa_kernel k7_w4_kernel
  .amdhsa_next_free_vgpr 256
  .amdhsa_next_free_sgpr 96
  .amdhsa_accum_offset 256
  .amdhsa_group_segment_fixed_size 0
  .amdhsa_kernarg_size 104
  .amdhsa_user_sgpr_count 2
  .amdhsa_user_sgpr_kernarg_segment_ptr 1
  .amdhsa_system_sgpr_workgroup_id_x 1
.end_amdhsa_kernel
```
